```python
import torch

def _softmax(x, axis=-1):
    return torch.softmax(x, dim=axis)
def _gelu(x):
    return torch.nn.functional.gelu(x, approximate="tanh")
def _silu(x):
    return torch.nn.functional.silu(x)
def _sigmoid(x):
    return torch.sigmoid(x)
def _layernorm(x, axis=-1, eps=1e-5):
    m = x.mean(dim=axis, keepdim=True)
    v = x.var(dim=axis, keepdim=True, unbiased=False)
    return (x - m) / torch.sqrt(v + eps)
def _scatter_add(tgt, idx, src, axis=0):
    return tgt.clone().index_add_(axis, idx, src)
def _segment_sum(src, seg, n):
    out = torch.zeros((n,) + src.shape[1:], dtype=src.dtype)
    return out.index_add_(0, seg, src)
def _pad(x, pw):
    flat = tuple(v for pair in reversed(pw) for v in pair)
    return torch.nn.functional.pad(x, flat)

kernel_name = 'interleave_layers__linear_attn_block__mha_block__prompt'

def setup_inputs():

    _w = (lambda a: (lambda t: t.to(torch.bfloat16) if t.is_floating_point() else t)(torch.as_tensor(a)))
    def _A_setup():
        B, S, D = 1, 2048, 576
        return {
            "x": _w((lambda *s: torch.randn(*s, dtype=torch.bfloat16) * 0.05)(B, S, D)),
            "wqkv": _w((lambda *s: torch.randn(*s, dtype=torch.bfloat16) * 0.05)(D, 3 * D)),
            "wo": _w((lambda *s: torch.randn(*s, dtype=torch.bfloat16) * 0.05)(D, D)),
        }
    _A_in = _A_setup()

    def _B_setup():
        B, S, D, H = 1, 2048, 576, 32
        return {
            "x": _w((lambda *s: torch.randn(*s, dtype=torch.bfloat16) * 0.05)(B, S, D)),
            "wqkv": _w((lambda *s: torch.randn(*s, dtype=torch.bfloat16) * 0.1)(D, 3 * D)),
            "wo": _w((lambda *s: torch.randn(*s, dtype=torch.bfloat16) * 0.05)(D, D)),
        }
    _B_in = _B_setup()

    return {
        "A_x": _A_in["x"],
        "A_wqkv": _A_in["wqkv"],
        "A_wo": _A_in["wo"],
        "B_x": _B_in["x"],
        "B_wqkv": _B_in["wqkv"],
        "B_wo": _B_in["wo"],
    }

def reference(A_x, A_wqkv, A_wo, B_x, B_wqkv, B_wo):
    def _A_ref(x, wqkv, wo):
        B, S, D = x.shape
        H = 32; Dh = D // H
        qkv = (lambda x, *d: x.permute(*d))((x @ wqkv).reshape(B, S, 3, H, Dh), 2, 0, 3, 1, 4)
        q, k, v = qkv[0], qkv[1], qkv[2]
        phi = lambda t: torch.where(t > 0, t + 1, torch.exp(t)) + 1e-6
        pq, pk = phi(q), phi(k)
        kv = torch.einsum("bhsd,bhse->bhde", pk, v)
        z = torch.einsum("bhsd->bhd", pk)
        num = torch.einsum("bhqd,bhde->bhqe", pq, kv)
        den = torch.einsum("bhqd,bhd->bhq", pq, z)[..., None] + 1e-6
        o = num / den
        return (lambda x, *d: x.permute(*d))(o, 0, 2, 1, 3).reshape(B, S, D) @ wo

    def _B_ref(x, wqkv, wo):
        B, S, D = x.shape
        H = 32
        Dh = D // H
        qkv = (lambda x, *d: x.permute(*d))((x @ wqkv).reshape(B, S, 3, H, Dh), 2, 0, 3, 1, 4)
        q, k, v = qkv[0], qkv[1], qkv[2]
        scores = torch.einsum("bhqd,bhkd->bhqk", q, k) * (Dh ** -0.5)
        p = _softmax(scores, axis=-1)
        o = torch.einsum("bhqk,bhkd->bhqd", p, v)
        return (lambda x, *d: x.permute(*d))(o, 0, 2, 1, 3).reshape(B, S, D) @ wo

    x = A_x
    x = x + _A_ref(_layernorm(x, axis=-1), A_wqkv, A_wo)
    x = x + _B_ref(_layernorm(x, axis=-1), B_wqkv, B_wo)
    x = x + _A_ref(_layernorm(x, axis=-1), A_wqkv, A_wo)
    x = x + _B_ref(_layernorm(x, axis=-1), B_wqkv, B_wo)
    return x
```

```asm
; @launch kernel=prep_kernel grid=(464,1,1) block=(256,1,1) lds=36864
; @launch kernel=qkva1_kernel grid=(256,1,1) block=(512,1,1) lds=130048
; @launch kernel=outa1_kernel grid=(192,1,1) block=(256,1,1) lds=151552
; @launch kernel=qkvb1_kernel grid=(256,1,1) block=(512,1,1) lds=130048
; @launch kernel=attn_kernel grid=(256,1,1) block=(1024,1,1) lds=152768
; @launch kernel=outb1_kernel grid=(192,1,1) block=(512,1,1) lds=151552
; @launch kernel=qkva1_kernel grid=(256,1,1) block=(512,1,1) lds=130048
; @launch kernel=outa1_kernel grid=(192,1,1) block=(256,1,1) lds=151552
; @launch kernel=qkvb1_kernel grid=(256,1,1) block=(512,1,1) lds=130048
; @launch kernel=attn_kernel grid=(256,1,1) block=(1024,1,1) lds=152768
; @launch kernel=outb2_kernel grid=(192,1,1) block=(512,1,1) lds=151552
.amdgcn_target "amdgcn-amd-amdhsa--gfx950"
.text
.globl prep_kernel
.p2align 8
.type prep_kernel,@function
prep_kernel:
    s_cmp_ge_u32 s2, 464
    s_cbranch_scc1 prep_kernel_end
    s_load_dwordx4 s[4:7], s[0:1], 0
    s_load_dwordx2 s[8:9], s[0:1], 16
    s_load_dwordx4 s[12:15], s[0:1], 32
    s_load_dwordx2 s[10:11], s[0:1], 64
    v_lshrrev_b32 v1, 6, v0
    v_and_b32 v2, 63, v0
    v_readfirstlane_b32 s16, v1
    v_and_b32 v3, 15, v2
    v_lshrrev_b32 v4, 4, v2
    v_lshlrev_b32 v7, 4, v2
    s_waitcnt lgkmcnt(0)
    s_mov_b32 s24, s10
    s_mov_b32 s25, s11
    s_mov_b32 s26, 0x1480000
    s_mov_b32 s27, 0x00020000
    s_cmp_ge_u32 s2, 192
    s_cbranch_scc1 prep_kernel_w
    s_mov_b32 s20, s4
    s_mov_b32 s21, s5
    s_mov_b32 s22, 0x240000
    s_mov_b32 s23, 0x00020000
    v_mov_b32 v24, 0x3f803f80
    s_lshl_b32 s17, s2, 2
    s_add_u32 s17, s17, s16
    s_mul_i32 s18, s17, 10923
    s_lshr_b32 s18, s18, 16
    s_mul_i32 s19, s18, 6
    s_sub_u32 s19, s17, s19
    v_mul_u32_u24 v5, 1152, v3
    v_lshl_add_u32 v5, v4, 4, v5
    s_mul_i32 s28, s18, 18432
    s_mul_i32 s29, s19, 192
    s_add_u32 s29, s29, s28
    buffer_load_dwordx4 v[8:11], v5, s[20:23], s29 offen offset:0
    buffer_load_dwordx4 v[12:15], v5, s[20:23], s29 offen offset:64
    buffer_load_dwordx4 v[16:19], v5, s[20:23], s29 offen offset:128
    s_mul_i32 s29, s19, 3072
    s_add_u32 s29, s29, s28
    v_mov_b32 v20, 0
    v_mov_b32 v21, 0
    s_waitcnt vmcnt(0)
    buffer_store_dwordx4 v[8:11], v7, s[24:27], s29 offen offset:0 sc1
    buffer_store_dwordx4 v[12:15], v7, s[24:27], s29 offen offset:1024 sc1
    buffer_store_dwordx4 v[16:19], v7, s[24:27], s29 offen offset:2048 sc1
    v_dot2_f32_bf16 v20, v8, v24, v20
    v_dot2_f32_bf16 v21, v8, v8, v21
    v_dot2_f32_bf16 v20, v9, v24, v20
    v_dot2_f32_bf16 v21, v9, v9, v21
    v_dot2_f32_bf16 v20, v10, v24, v20
    v_dot2_f32_bf16 v21, v10, v10, v21
    v_dot2_f32_bf16 v20, v11, v24, v20
    v_dot2_f32_bf16 v21, v11, v11, v21
    v_dot2_f32_bf16 v20, v12, v24, v20
    v_dot2_f32_bf16 v21, v12, v12, v21
    v_dot2_f32_bf16 v20, v13, v24, v20
    v_dot2_f32_bf16 v21, v13, v13, v21
    v_dot2_f32_bf16 v20, v14, v24, v20
    v_dot2_f32_bf16 v21, v14, v14, v21
    v_dot2_f32_bf16 v20, v15, v24, v20
    v_dot2_f32_bf16 v21, v15, v15, v21
    v_dot2_f32_bf16 v20, v16, v24, v20
    v_dot2_f32_bf16 v21, v16, v16, v21
    v_dot2_f32_bf16 v20, v17, v24, v20
    v_dot2_f32_bf16 v21, v17, v17, v21
    v_dot2_f32_bf16 v20, v18, v24, v20
    v_dot2_f32_bf16 v21, v18, v18, v21
    v_dot2_f32_bf16 v20, v19, v24, v20
    v_dot2_f32_bf16 v21, v19, v19, v21
    s_nop 3
    v_mov_b32 v22, v20
    v_mov_b32 v23, v21
    s_nop 1
    v_permlane32_swap_b32 v20, v22
    v_permlane32_swap_b32 v21, v23
    s_nop 1
    v_add_f32 v20, v20, v22
    v_add_f32 v21, v21, v23
    v_mov_b32 v22, v20
    v_mov_b32 v23, v21
    s_nop 1
    v_permlane16_swap_b32 v20, v22
    v_permlane16_swap_b32 v21, v23
    s_nop 1
    v_add_f32 v20, v20, v22
    v_add_f32 v21, v21, v23
    s_lshl_b32 s28, s18, 4
    v_add_u32 v5, s28, v3
    v_mul_u32_u24 v5, 48, v5
    s_lshl_b32 s29, s19, 3
    s_add_u32 s29, s29, 0x13b0000
    v_cmp_gt_u32 vcc, 16, v2
    s_mov_b64 exec, vcc
    buffer_store_dwordx2 v[20:21], v5, s[24:27], s29 offen sc1
    s_endpgm
prep_kernel_w:
    s_cmp_ge_u32 s2, 300
    s_cbranch_scc1 prep_kernel_o
    s_sub_u32 s17, s2, 192
    s_cmp_ge_u32 s17, 54
    s_cselect_b32 s18, 1, 0
    s_cselect_b32 s4, s12, s6
    s_cselect_b32 s5, s13, s7
    s_mul_i32 s19, s18, 54
    s_sub_u32 s17, s17, s19
    s_mul_i32 s19, s17, 21846
    s_lshr_b32 s19, s19, 16
    s_mul_i32 s28, s19, 3
    s_sub_u32 s28, s17, s28
    s_mov_b32 s20, s4
    s_mov_b32 s21, s5
    s_mov_b32 s22, 0x1e6000
    s_mov_b32 s23, 0x00020000
    s_mul_i32 s29, s19, 110592
    s_mul_i32 s30, s28, 1152
    s_add_u32 s30, s30, s29
    s_lshl_b32 s43, s16, 10
    v_add_u32 v8, 0, v0
    v_mul_u32_u24 v9, 3641, v8
    v_lshrrev_b32 v9, 18, v9
    v_mul_u32_u24 v10, 72, v9
    v_sub_u32 v10, v8, v10
    v_mul_u32_u24 v9, 3456, v9
    v_lshl_add_u32 v9, v10, 4, v9
    s_add_u32 s44, s43, 0
    s_mov_b32 m0, s44
    s_nop 0
    buffer_load_dwordx4 v9, s[20:23], s30 offen lds
    v_add_u32 v8, 256, v0
    v_mul_u32_u24 v9, 3641, v8
    v_lshrrev_b32 v9, 18, v9
    v_mul_u32_u24 v10, 72, v9
    v_sub_u32 v10, v8, v10
    v_mul_u32_u24 v9, 3456, v9
    v_lshl_add_u32 v9, v10, 4, v9
    s_add_u32 s44, s43, 4096
    s_mov_b32 m0, s44
    s_nop 0
    buffer_load_dwordx4 v9, s[20:23], s30 offen lds
    v_add_u32 v8, 512, v0
    v_mul_u32_u24 v9, 3641, v8
    v_lshrrev_b32 v9, 18, v9
    v_mul_u32_u24 v10, 72, v9
    v_sub_u32 v10, v8, v10
    v_mul_u32_u24 v9, 3456, v9
    v_lshl_add_u32 v9, v10, 4, v9
    s_add_u32 s44, s43, 8192
    s_mov_b32 m0, s44
    s_nop 0
    buffer_load_dwordx4 v9, s[20:23], s30 offen lds
    v_add_u32 v8, 768, v0
    v_mul_u32_u24 v9, 3641, v8
    v_lshrrev_b32 v9, 18, v9
    v_mul_u32_u24 v10, 72, v9
    v_sub_u32 v10, v8, v10
    v_mul_u32_u24 v9, 3456, v9
    v_lshl_add_u32 v9, v10, 4, v9
    s_add_u32 s44, s43, 12288
    s_mov_b32 m0, s44
    s_nop 0
    buffer_load_dwordx4 v9, s[20:23], s30 offen lds
    v_add_u32 v8, 1024, v0
    v_mul_u32_u24 v9, 3641, v8
    v_lshrrev_b32 v9, 18, v9
    v_mul_u32_u24 v10, 72, v9
    v_sub_u32 v10, v8, v10
    v_mul_u32_u24 v9, 3456, v9
    v_lshl_add_u32 v9, v10, 4, v9
    s_add_u32 s44, s43, 16384
    s_mov_b32 m0, s44
    s_nop 0
    buffer_load_dwordx4 v9, s[20:23], s30 offen lds
    v_add_u32 v8, 1280, v0
    v_mul_u32_u24 v9, 3641, v8
    v_lshrrev_b32 v9, 18, v9
    v_mul_u32_u24 v10, 72, v9
    v_sub_u32 v10, v8, v10
    v_mul_u32_u24 v9, 3456, v9
    v_lshl_add_u32 v9, v10, 4, v9
    s_add_u32 s44, s43, 20480
    s_mov_b32 m0, s44
    s_nop 0
    buffer_load_dwordx4 v9, s[20:23], s30 offen lds
    v_add_u32 v8, 1536, v0
    v_mul_u32_u24 v9, 3641, v8
    v_lshrrev_b32 v9, 18, v9
    v_mul_u32_u24 v10, 72, v9
    v_sub_u32 v10, v8, v10
    v_mul_u32_u24 v9, 3456, v9
    v_lshl_add_u32 v9, v10, 4, v9
    s_add_u32 s44, s43, 24576
    s_mov_b32 m0, s44
    s_nop 0
    buffer_load_dwordx4 v9, s[20:23], s30 offen lds
    v_add_u32 v8, 1792, v0
    v_mul_u32_u24 v9, 3641, v8
    v_lshrrev_b32 v9, 18, v9
    v_mul_u32_u24 v10, 72, v9
    v_sub_u32 v10, v8, v10
    v_mul_u32_u24 v9, 3456, v9
    v_lshl_add_u32 v9, v10, 4, v9
    s_add_u32 s44, s43, 28672
    s_mov_b32 m0, s44
    s_nop 0
    buffer_load_dwordx4 v9, s[20:23], s30 offen lds
    v_add_u32 v8, 2048, v0
    v_mul_u32_u24 v9, 3641, v8
    v_lshrrev_b32 v9, 18, v9
    v_mul_u32_u24 v10, 72, v9
    v_sub_u32 v10, v8, v10
    v_mul_u32_u24 v9, 3456, v9
    v_lshl_add_u32 v9, v10, 4, v9
    s_add_u32 s44, s43, 32768
    s_mov_b32 m0, s44
    s_nop 0
    buffer_load_dwordx4 v9, s[20:23], s30 offen lds
    s_lshl_b32 s33, s18, 4
    s_lshl_b32 s32, s16, 2
    s_add_u32 s32, s32, s33
    s_mul_i32 s32, s32, 129024
    s_mul_i32 s34, s19, 7
    s_add_u32 s36, s34, 6
    s_lshl_b32 s36, s36, 10
    s_add_u32 s36, s36, s32
    s_add_u32 s36, s36, 0xe00000
    s_lshl_b32 s35, s28, 1
    s_add_u32 s35, s35, s34
    s_lshl_b32 s35, s35, 10
    s_add_u32 s32, s32, s35
    s_add_u32 s32, s32, 0xe00000
    v_lshrrev_b32 v8, 2, v3
    v_and_b32 v9, 3, v3
    v_mul_u32_u24 v6, 72, v8
    v_lshrrev_b32 v10, 1, v9
    v_mul_u32_u24 v10, 36, v10
    v_and_b32 v11, 1, v9
    v_lshl_add_u32 v10, v11, 1, v10
    v_add3_u32 v6, v6, v10, 32
    v_mul_u32_u24 v10, 9216, v4
    v_add_u32 v6, v6, v10
    s_mul_i32 s44, s16, 288
    v_add_u32 v6, s44, v6
    v_mul_u32_u24 v12, 129024, v8
    s_lshl_b32 s45, s28, 2
    v_add_u32 v10, s45, v9
    v_lshl_add_u32 v10, v4, 4, v10
    v_lshl_add_u32 v12, v10, 4, v12
    v_mul_u32_u24 v5, 9216, v4
    v_lshl_add_u32 v5, v3, 1, v5
    v_add_u32 v5, s44, v5
    s_waitcnt vmcnt(0)
    s_barrier
    ds_read_u16 v48, v5 offset:0
    ds_read_u16 v49, v5 offset:1152
    ds_read_u16 v50, v5 offset:2304
    ds_read_u16 v51, v5 offset:3456
    ds_read_u16 v52, v5 offset:4608
    ds_read_u16 v53, v5 offset:5760
    ds_read_u16 v54, v5 offset:6912
    ds_read_u16 v55, v5 offset:8064
    ds_read_u16 v56, v5 offset:36
    ds_read_u16 v57, v5 offset:1188
    ds_read_u16 v58, v5 offset:2340
    ds_read_u16 v59, v5 offset:3492
    ds_read_u16 v60, v5 offset:4644
    ds_read_u16 v61, v5 offset:5796
    ds_read_u16 v62, v5 offset:6948
    ds_read_u16 v63, v5 offset:8100
    s_waitcnt lgkmcnt(8)
    v_lshl_or_b32 v16, v49, 16, v48
    v_lshl_or_b32 v17, v51, 16, v50
    v_lshl_or_b32 v18, v53, 16, v52
    v_lshl_or_b32 v19, v55, 16, v54
    s_add_u32 s31, s32, 0
    buffer_store_dwordx4 v[16:19], v7, s[24:27], s31 offen sc1
    ds_read_u16 v64, v5 offset:72
    ds_read_u16 v65, v5 offset:1224
    ds_read_u16 v66, v5 offset:2376
    ds_read_u16 v67, v5 offset:3528
    ds_read_u16 v68, v5 offset:4680
    ds_read_u16 v69, v5 offset:5832
    ds_read_u16 v70, v5 offset:6984
    ds_read_u16 v71, v5 offset:8136
    s_waitcnt lgkmcnt(8)
    v_lshl_or_b32 v20, v57, 16, v56
    v_lshl_or_b32 v21, v59, 16, v58
    v_lshl_or_b32 v22, v61, 16, v60
    v_lshl_or_b32 v23, v63, 16, v62
    s_add_u32 s31, s32, 1024
    buffer_store_dwordx4 v[20:23], v7, s[24:27], s31 offen sc1
    ds_read_u16 v72, v5 offset:108
    ds_read_u16 v73, v5 offset:1260
    ds_read_u16 v74, v5 offset:2412
    ds_read_u16 v75, v5 offset:3564
    ds_read_u16 v76, v5 offset:4716
    ds_read_u16 v77, v5 offset:5868
    ds_read_u16 v78, v5 offset:7020
    ds_read_u16 v79, v5 offset:8172
    s_waitcnt lgkmcnt(8)
    v_lshl_or_b32 v24, v65, 16, v64
    v_lshl_or_b32 v25, v67, 16, v66
    v_lshl_or_b32 v26, v69, 16, v68
    v_lshl_or_b32 v27, v71, 16, v70
    s_add_u32 s31, s32, 129024
    buffer_store_dwordx4 v[24:27], v7, s[24:27], s31 offen sc1
    ds_read_u16 v80, v5 offset:144
    ds_read_u16 v81, v5 offset:1296
    ds_read_u16 v82, v5 offset:2448
    ds_read_u16 v83, v5 offset:3600
    ds_read_u16 v84, v5 offset:4752
    ds_read_u16 v85, v5 offset:5904
    ds_read_u16 v86, v5 offset:7056
    ds_read_u16 v87, v5 offset:8208
    s_waitcnt lgkmcnt(8)
    v_lshl_or_b32 v28, v73, 16, v72
    v_lshl_or_b32 v29, v75, 16, v74
    v_lshl_or_b32 v30, v77, 16, v76
    v_lshl_or_b32 v31, v79, 16, v78
    s_add_u32 s31, s32, 130048
    buffer_store_dwordx4 v[28:31], v7, s[24:27], s31 offen sc1
    ds_read_u16 v88, v5 offset:180
    ds_read_u16 v89, v5 offset:1332
    ds_read_u16 v90, v5 offset:2484
    ds_read_u16 v91, v5 offset:3636
    ds_read_u16 v92, v5 offset:4788
    ds_read_u16 v93, v5 offset:5940
    ds_read_u16 v94, v5 offset:7092
    ds_read_u16 v95, v5 offset:8244
    s_waitcnt lgkmcnt(8)
    v_lshl_or_b32 v16, v81, 16, v80
    v_lshl_or_b32 v17, v83, 16, v82
    v_lshl_or_b32 v18, v85, 16, v84
    v_lshl_or_b32 v19, v87, 16, v86
    s_add_u32 s31, s32, 258048
    buffer_store_dwordx4 v[16:19], v7, s[24:27], s31 offen sc1
    ds_read_u16 v96, v5 offset:216
    ds_read_u16 v97, v5 offset:1368
    ds_read_u16 v98, v5 offset:2520
    ds_read_u16 v99, v5 offset:3672
    ds_read_u16 v100, v5 offset:4824
    ds_read_u16 v101, v5 offset:5976
    ds_read_u16 v102, v5 offset:7128
    ds_read_u16 v103, v5 offset:8280
    s_waitcnt lgkmcnt(8)
    v_lshl_or_b32 v20, v89, 16, v88
    v_lshl_or_b32 v21, v91, 16, v90
    v_lshl_or_b32 v22, v93, 16, v92
    v_lshl_or_b32 v23, v95, 16, v94
    s_add_u32 s31, s32, 259072
    buffer_store_dwordx4 v[20:23], v7, s[24:27], s31 offen sc1
    ds_read_u16 v104, v5 offset:252
    ds_read_u16 v105, v5 offset:1404
    ds_read_u16 v106, v5 offset:2556
    ds_read_u16 v107, v5 offset:3708
    ds_read_u16 v108, v5 offset:4860
    ds_read_u16 v109, v5 offset:6012
    ds_read_u16 v110, v5 offset:7164
    ds_read_u16 v111, v5 offset:8316
    s_waitcnt lgkmcnt(8)
    v_lshl_or_b32 v24, v97, 16, v96
    v_lshl_or_b32 v25, v99, 16, v98
    v_lshl_or_b32 v26, v101, 16, v100
    v_lshl_or_b32 v27, v103, 16, v102
    s_add_u32 s31, s32, 387072
    buffer_store_dwordx4 v[24:27], v7, s[24:27], s31 offen sc1
    ds_read_u16 v112, v6 offset:0
    ds_read_u16 v113, v6 offset:1152
    ds_read_u16 v114, v6 offset:2304
    ds_read_u16 v115, v6 offset:3456
    ds_read_u16 v116, v6 offset:4608
    ds_read_u16 v117, v6 offset:5760
    ds_read_u16 v118, v6 offset:6912
    ds_read_u16 v119, v6 offset:8064
    s_waitcnt lgkmcnt(8)
    v_lshl_or_b32 v28, v105, 16, v104
    v_lshl_or_b32 v29, v107, 16, v106
    v_lshl_or_b32 v30, v109, 16, v108
    v_lshl_or_b32 v31, v111, 16, v110
    s_add_u32 s31, s32, 388096
    buffer_store_dwordx4 v[28:31], v7, s[24:27], s31 offen sc1
    s_waitcnt lgkmcnt(0)
    v_lshl_or_b32 v16, v113, 16, v112
    v_lshl_or_b32 v17, v115, 16, v114
    v_lshl_or_b32 v18, v117, 16, v116
    v_lshl_or_b32 v19, v119, 16, v118
    buffer_store_dwordx4 v[16:19], v12, s[24:27], s36 offen sc1
    s_endpgm
prep_kernel_o:
    s_cmp_ge_u32 s2, 354
    s_cbranch_scc1 prep_kernel_z
    v_and_b32 v3, 31, v2
    v_lshrrev_b32 v4, 5, v2
    s_cmp_ge_u32 s2, 348
    s_cbranch_scc1 prep_kernel_or
    s_sub_u32 s17, s2, 300
    s_lshl_b32 s17, s17, 2
    s_add_u32 s17, s17, s16
    s_cmp_ge_u32 s17, 96
    s_cselect_b32 s18, 1, 0
    s_cselect_b32 s4, s14, s8
    s_cselect_b32 s5, s15, s9
    s_mul_i32 s19, s18, 96
    s_sub_u32 s17, s17, s19
    s_mul_i32 s19, s17, 21846
    s_lshr_b32 s19, s19, 16
    s_mul_i32 s28, s19, 3
    s_sub_u32 s28, s17, s28
    s_mov_b32 s20, s4
    s_mov_b32 s21, s5
    s_mov_b32 s22, 0xa2000
    s_mov_b32 s23, 0x00020000
    v_mul_u32_u24 v5, 4608, v4
    v_lshl_add_u32 v5, v3, 1, v5
    s_mul_i32 s30, s19, 20736
    s_mul_i32 s29, s28, 384
    s_add_u32 s30, s30, s29
    s_mul_i32 s32, s18, 6
    s_lshl_b32 s33, s28, 1
    s_add_u32 s32, s32, s33
    s_mul_i32 s32, s32, 110592
    s_lshr_b32 s33, s19, 4
    s_lshl_b32 s33, s33, 1
    s_add_u32 s33, s33, s19
    s_mul_i32 s33, s33, 3072
    s_add_u32 s32, s32, s33
    s_add_u32 s32, s32, 0x1200000
    s_add_u32 s31, s30, 0
    buffer_load_ushort v48, v5, s[20:23], s31 offen
    s_add_u32 s31, s30, 1152
    buffer_load_ushort v49, v5, s[20:23], s31 offen
    s_add_u32 s31, s30, 2304
    buffer_load_ushort v50, v5, s[20:23], s31 offen
    s_add_u32 s31, s30, 3456
    buffer_load_ushort v51, v5, s[20:23], s31 offen
    s_add_u32 s31, s30, 9216
    buffer_load_ushort v52, v5, s[20:23], s31 offen
    s_add_u32 s31, s30, 10368
    buffer_load_ushort v53, v5, s[20:23], s31 offen
    s_add_u32 s31, s30, 11520
    buffer_load_ushort v54, v5, s[20:23], s31 offen
    s_add_u32 s31, s30, 12672
    buffer_load_ushort v55, v5, s[20:23], s31 offen
    s_add_u32 s31, s30, 64
    buffer_load_ushort v56, v5, s[20:23], s31 offen
    s_add_u32 s31, s30, 1216
    buffer_load_ushort v57, v5, s[20:23], s31 offen
    s_add_u32 s31, s30, 2368
    buffer_load_ushort v58, v5, s[20:23], s31 offen
    s_add_u32 s31, s30, 3520
    buffer_load_ushort v59, v5, s[20:23], s31 offen
    s_add_u32 s31, s30, 9280
    buffer_load_ushort v60, v5, s[20:23], s31 offen
    s_add_u32 s31, s30, 10432
    buffer_load_ushort v61, v5, s[20:23], s31 offen
    s_add_u32 s31, s30, 11584
    buffer_load_ushort v62, v5, s[20:23], s31 offen
    s_add_u32 s31, s30, 12736
    buffer_load_ushort v63, v5, s[20:23], s31 offen
    s_add_u32 s31, s30, 128
    buffer_load_ushort v64, v5, s[20:23], s31 offen
    s_add_u32 s31, s30, 1280
    buffer_load_ushort v65, v5, s[20:23], s31 offen
    s_add_u32 s31, s30, 2432
    buffer_load_ushort v66, v5, s[20:23], s31 offen
    s_add_u32 s31, s30, 3584
    buffer_load_ushort v67, v5, s[20:23], s31 offen
    s_add_u32 s31, s30, 9344
    buffer_load_ushort v68, v5, s[20:23], s31 offen
    s_add_u32 s31, s30, 10496
    buffer_load_ushort v69, v5, s[20:23], s31 offen
    s_add_u32 s31, s30, 11648
    buffer_load_ushort v70, v5, s[20:23], s31 offen
    s_add_u32 s31, s30, 12800
    buffer_load_ushort v71, v5, s[20:23], s31 offen
    s_add_u32 s31, s30, 192
    buffer_load_ushort v72, v5, s[20:23], s31 offen
    s_add_u32 s31, s30, 1344
    buffer_load_ushort v73, v5, s[20:23], s31 offen
    s_add_u32 s31, s30, 2496
    buffer_load_ushort v74, v5, s[20:23], s31 offen
    s_add_u32 s31, s30, 3648
    buffer_load_ushort v75, v5, s[20:23], s31 offen
    s_add_u32 s31, s30, 9408
    buffer_load_ushort v76, v5, s[20:23], s31 offen
    s_add_u32 s31, s30, 10560
    buffer_load_ushort v77, v5, s[20:23], s31 offen
    s_add_u32 s31, s30, 11712
    buffer_load_ushort v78, v5, s[20:23], s31 offen
    s_add_u32 s31, s30, 12864
    buffer_load_ushort v79, v5, s[20:23], s31 offen
    s_add_u32 s31, s30, 256
    buffer_load_ushort v80, v5, s[20:23], s31 offen
    s_add_u32 s31, s30, 1408
    buffer_load_ushort v81, v5, s[20:23], s31 offen
    s_add_u32 s31, s30, 2560
    buffer_load_ushort v82, v5, s[20:23], s31 offen
    s_add_u32 s31, s30, 3712
    buffer_load_ushort v83, v5, s[20:23], s31 offen
    s_add_u32 s31, s30, 9472
    buffer_load_ushort v84, v5, s[20:23], s31 offen
    s_add_u32 s31, s30, 10624
    buffer_load_ushort v85, v5, s[20:23], s31 offen
    s_add_u32 s31, s30, 11776
    buffer_load_ushort v86, v5, s[20:23], s31 offen
    s_add_u32 s31, s30, 12928
    buffer_load_ushort v87, v5, s[20:23], s31 offen
    s_add_u32 s31, s30, 320
    buffer_load_ushort v88, v5, s[20:23], s31 offen
    s_add_u32 s31, s30, 1472
    buffer_load_ushort v89, v5, s[20:23], s31 offen
    s_add_u32 s31, s30, 2624
    buffer_load_ushort v90, v5, s[20:23], s31 offen
    s_add_u32 s31, s30, 3776
    buffer_load_ushort v91, v5, s[20:23], s31 offen
    s_add_u32 s31, s30, 9536
    buffer_load_ushort v92, v5, s[20:23], s31 offen
    s_add_u32 s31, s30, 10688
    buffer_load_ushort v93, v5, s[20:23], s31 offen
    s_add_u32 s31, s30, 11840
    buffer_load_ushort v94, v5, s[20:23], s31 offen
    s_add_u32 s31, s30, 12992
    buffer_load_ushort v95, v5, s[20:23], s31 offen
    s_waitcnt vmcnt(40)
    v_lshl_or_b32 v8, v49, 16, v48
    v_lshl_or_b32 v9, v51, 16, v50
    v_lshl_or_b32 v10, v53, 16, v52
    v_lshl_or_b32 v11, v55, 16, v54
    s_add_u32 s31, s32, 0
    buffer_store_dwordx4 v[8:11], v7, s[24:27], s31 offen sc1
    s_waitcnt vmcnt(33)
    v_lshl_or_b32 v12, v57, 16, v56
    v_lshl_or_b32 v13, v59, 16, v58
    v_lshl_or_b32 v14, v61, 16, v60
    v_lshl_or_b32 v15, v63, 16, v62
    s_add_u32 s31, s32, 1024
    buffer_store_dwordx4 v[12:15], v7, s[24:27], s31 offen sc1
    s_waitcnt vmcnt(26)
    v_lshl_or_b32 v16, v65, 16, v64
    v_lshl_or_b32 v17, v67, 16, v66
    v_lshl_or_b32 v18, v69, 16, v68
    v_lshl_or_b32 v19, v71, 16, v70
    s_add_u32 s31, s32, 2048
    buffer_store_dwordx4 v[16:19], v7, s[24:27], s31 offen sc1
    s_waitcnt vmcnt(19)
    v_lshl_or_b32 v20, v73, 16, v72
    v_lshl_or_b32 v21, v75, 16, v74
    v_lshl_or_b32 v22, v77, 16, v76
    v_lshl_or_b32 v23, v79, 16, v78
    s_add_u32 s31, s32, 110592
    buffer_store_dwordx4 v[20:23], v7, s[24:27], s31 offen sc1
    s_waitcnt vmcnt(12)
    v_lshl_or_b32 v24, v81, 16, v80
    v_lshl_or_b32 v25, v83, 16, v82
    v_lshl_or_b32 v26, v85, 16, v84
    v_lshl_or_b32 v27, v87, 16, v86
    s_add_u32 s31, s32, 111616
    buffer_store_dwordx4 v[24:27], v7, s[24:27], s31 offen sc1
    s_waitcnt vmcnt(5)
    v_lshl_or_b32 v28, v89, 16, v88
    v_lshl_or_b32 v29, v91, 16, v90
    v_lshl_or_b32 v30, v93, 16, v92
    v_lshl_or_b32 v31, v95, 16, v94
    s_add_u32 s31, s32, 112640
    buffer_store_dwordx4 v[28:31], v7, s[24:27], s31 offen sc1
    s_endpgm
prep_kernel_or:
    s_sub_u32 s17, s2, 348
    s_lshl_b32 s17, s17, 2
    s_add_u32 s17, s17, s16
    s_cmp_ge_u32 s17, 12
    s_cselect_b32 s18, 1, 0
    s_cselect_b32 s4, s14, s8
    s_cselect_b32 s5, s15, s9
    s_mul_i32 s19, s18, 12
    s_sub_u32 s17, s17, s19
    s_mul_i32 s19, s17, 21846
    s_lshr_b32 s19, s19, 16
    s_mul_i32 s28, s19, 3
    s_sub_u32 s28, s17, s28
    s_mov_b32 s20, s4
    s_mov_b32 s21, s5
    s_mov_b32 s22, 0xa2000
    s_mov_b32 s23, 0x00020000
    v_mul_u32_u24 v5, 82944, v4
    v_lshl_add_u32 v5, v3, 1, v5
    s_mul_i32 s30, s19, 165888
    s_mul_i32 s29, s28, 384
    s_add_u32 s30, s30, s29
    s_mul_i32 s32, s18, 6
    s_lshl_b32 s33, s28, 1
    s_add_u32 s32, s32, s33
    s_mul_i32 s32, s32, 110592
    s_lshr_b32 s33, s19, 1
    s_mul_i32 s33, s33, 18
    s_and_b32 s34, s19, 1
    s_add_u32 s33, s33, s34
    s_add_u32 s33, s33, 16
    s_mul_i32 s33, s33, 3072
    s_add_u32 s32, s32, s33
    s_add_u32 s32, s32, 0x1200000
    s_add_u32 s31, s30, 18432
    buffer_load_ushort v48, v5, s[20:23], s31 offen
    s_add_u32 s31, s30, 19584
    buffer_load_ushort v49, v5, s[20:23], s31 offen
    s_add_u32 s31, s30, 39168
    buffer_load_ushort v50, v5, s[20:23], s31 offen
    s_add_u32 s31, s30, 40320
    buffer_load_ushort v51, v5, s[20:23], s31 offen
    s_add_u32 s31, s30, 59904
    buffer_load_ushort v52, v5, s[20:23], s31 offen
    s_add_u32 s31, s30, 61056
    buffer_load_ushort v53, v5, s[20:23], s31 offen
    s_add_u32 s31, s30, 80640
    buffer_load_ushort v54, v5, s[20:23], s31 offen
    s_add_u32 s31, s30, 81792
    buffer_load_ushort v55, v5, s[20:23], s31 offen
    s_add_u32 s31, s30, 18496
    buffer_load_ushort v56, v5, s[20:23], s31 offen
    s_add_u32 s31, s30, 19648
    buffer_load_ushort v57, v5, s[20:23], s31 offen
    s_add_u32 s31, s30, 39232
    buffer_load_ushort v58, v5, s[20:23], s31 offen
    s_add_u32 s31, s30, 40384
    buffer_load_ushort v59, v5, s[20:23], s31 offen
    s_add_u32 s31, s30, 59968
    buffer_load_ushort v60, v5, s[20:23], s31 offen
    s_add_u32 s31, s30, 61120
    buffer_load_ushort v61, v5, s[20:23], s31 offen
    s_add_u32 s31, s30, 80704
    buffer_load_ushort v62, v5, s[20:23], s31 offen
    s_add_u32 s31, s30, 81856
    buffer_load_ushort v63, v5, s[20:23], s31 offen
    s_add_u32 s31, s30, 18560
    buffer_load_ushort v64, v5, s[20:23], s31 offen
    s_add_u32 s31, s30, 19712
    buffer_load_ushort v65, v5, s[20:23], s31 offen
    s_add_u32 s31, s30, 39296
    buffer_load_ushort v66, v5, s[20:23], s31 offen
    s_add_u32 s31, s30, 40448
    buffer_load_ushort v67, v5, s[20:23], s31 offen
    s_add_u32 s31, s30, 60032
    buffer_load_ushort v68, v5, s[20:23], s31 offen
    s_add_u32 s31, s30, 61184
    buffer_load_ushort v69, v5, s[20:23], s31 offen
    s_add_u32 s31, s30, 80768
    buffer_load_ushort v70, v5, s[20:23], s31 offen
    s_add_u32 s31, s30, 81920
    buffer_load_ushort v71, v5, s[20:23], s31 offen
    s_add_u32 s31, s30, 18624
    buffer_load_ushort v72, v5, s[20:23], s31 offen
    s_add_u32 s31, s30, 19776
    buffer_load_ushort v73, v5, s[20:23], s31 offen
    s_add_u32 s31, s30, 39360
    buffer_load_ushort v74, v5, s[20:23], s31 offen
    s_add_u32 s31, s30, 40512
    buffer_load_ushort v75, v5, s[20:23], s31 offen
    s_add_u32 s31, s30, 60096
    buffer_load_ushort v76, v5, s[20:23], s31 offen
    s_add_u32 s31, s30, 61248
    buffer_load_ushort v77, v5, s[20:23], s31 offen
    s_add_u32 s31, s30, 80832
    buffer_load_ushort v78, v5, s[20:23], s31 offen
    s_add_u32 s31, s30, 81984
    buffer_load_ushort v79, v5, s[20:23], s31 offen
    s_add_u32 s31, s30, 18688
    buffer_load_ushort v80, v5, s[20:23], s31 offen
    s_add_u32 s31, s30, 19840
    buffer_load_ushort v81, v5, s[20:23], s31 offen
    s_add_u32 s31, s30, 39424
    buffer_load_ushort v82, v5, s[20:23], s31 offen
    s_add_u32 s31, s30, 40576
    buffer_load_ushort v83, v5, s[20:23], s31 offen
    s_add_u32 s31, s30, 60160
    buffer_load_ushort v84, v5, s[20:23], s31 offen
    s_add_u32 s31, s30, 61312
    buffer_load_ushort v85, v5, s[20:23], s31 offen
    s_add_u32 s31, s30, 80896
    buffer_load_ushort v86, v5, s[20:23], s31 offen
    s_add_u32 s31, s30, 82048
    buffer_load_ushort v87, v5, s[20:23], s31 offen
    s_add_u32 s31, s30, 18752
    buffer_load_ushort v88, v5, s[20:23], s31 offen
    s_add_u32 s31, s30, 19904
    buffer_load_ushort v89, v5, s[20:23], s31 offen
    s_add_u32 s31, s30, 39488
    buffer_load_ushort v90, v5, s[20:23], s31 offen
    s_add_u32 s31, s30, 40640
    buffer_load_ushort v91, v5, s[20:23], s31 offen
    s_add_u32 s31, s30, 60224
    buffer_load_ushort v92, v5, s[20:23], s31 offen
    s_add_u32 s31, s30, 61376
    buffer_load_ushort v93, v5, s[20:23], s31 offen
    s_add_u32 s31, s30, 80960
    buffer_load_ushort v94, v5, s[20:23], s31 offen
    s_add_u32 s31, s30, 82112
    buffer_load_ushort v95, v5, s[20:23], s31 offen
    s_waitcnt vmcnt(40)
    v_lshl_or_b32 v8, v49, 16, v48
    v_lshl_or_b32 v9, v51, 16, v50
    v_lshl_or_b32 v10, v53, 16, v52
    v_lshl_or_b32 v11, v55, 16, v54
    s_add_u32 s31, s32, 0
    buffer_store_dwordx4 v[8:11], v7, s[24:27], s31 offen sc1
    s_waitcnt vmcnt(33)
    v_lshl_or_b32 v12, v57, 16, v56
    v_lshl_or_b32 v13, v59, 16, v58
    v_lshl_or_b32 v14, v61, 16, v60
    v_lshl_or_b32 v15, v63, 16, v62
    s_add_u32 s31, s32, 1024
    buffer_store_dwordx4 v[12:15], v7, s[24:27], s31 offen sc1
    s_waitcnt vmcnt(26)
    v_lshl_or_b32 v16, v65, 16, v64
    v_lshl_or_b32 v17, v67, 16, v66
    v_lshl_or_b32 v18, v69, 16, v68
    v_lshl_or_b32 v19, v71, 16, v70
    s_add_u32 s31, s32, 2048
    buffer_store_dwordx4 v[16:19], v7, s[24:27], s31 offen sc1
    s_waitcnt vmcnt(19)
    v_lshl_or_b32 v20, v73, 16, v72
    v_lshl_or_b32 v21, v75, 16, v74
    v_lshl_or_b32 v22, v77, 16, v76
    v_lshl_or_b32 v23, v79, 16, v78
    s_add_u32 s31, s32, 110592
    buffer_store_dwordx4 v[20:23], v7, s[24:27], s31 offen sc1
    s_waitcnt vmcnt(12)
    v_lshl_or_b32 v24, v81, 16, v80
    v_lshl_or_b32 v25, v83, 16, v82
    v_lshl_or_b32 v26, v85, 16, v84
    v_lshl_or_b32 v27, v87, 16, v86
    s_add_u32 s31, s32, 111616
    buffer_store_dwordx4 v[24:27], v7, s[24:27], s31 offen sc1
    s_waitcnt vmcnt(5)
    v_lshl_or_b32 v28, v89, 16, v88
    v_lshl_or_b32 v29, v91, 16, v90
    v_lshl_or_b32 v30, v93, 16, v92
    v_lshl_or_b32 v31, v95, 16, v94
    s_add_u32 s31, s32, 112640
    buffer_store_dwordx4 v[28:31], v7, s[24:27], s31 offen sc1
    s_endpgm
prep_kernel_z:
    s_cmp_ge_u32 s2, 378
    s_cbranch_scc1 prep_kernel_1
    s_add_u32 s20, s10, 0x1390000
    s_addc_u32 s21, s11, 0
    s_mov_b32 s22, 0x17c00
    s_mov_b32 s23, 0x00020000
    s_sub_u32 s17, s2, 354
    s_lshl_b32 s17, s17, 12
    v_lshlrev_b32 v1, 4, v0
    v_mov_b32 v4, 0
    v_mov_b32 v5, 0
    v_mov_b32 v6, 0
    v_mov_b32 v7, 0
    buffer_store_dwordx4 v[4:7], v1, s[20:23], s17 offen sc1
    s_endpgm
prep_kernel_1:
    s_cmp_ge_u32 s2, 410
    s_cbranch_scc1 prep_kernel_c
    s_sub_u32 s17, s2, 378
    s_mul_i32 s17, s17, 77824
    s_add_u32 s17, s17, 0x900120
    v_mul_u32_u24 v1, 304, v0
    v_mov_b32 v4, 0x3f803f80
    v_mov_b32 v5, 0x3f803f80
    v_mov_b32 v6, 0x3f803f80
    v_mov_b32 v7, 0x3f803f80
    buffer_store_dwordx4 v[4:7], v1, s[24:27], s17 offen sc1
    s_endpgm
prep_kernel_c:
    s_sub_u32 s17, s2, 410
    s_cmp_ge_u32 s17, 27
    s_cselect_b32 s18, 1, 0
    s_cselect_b32 s4, s12, s6
    s_cselect_b32 s5, s13, s7
    s_mul_i32 s19, s18, 27
    s_sub_u32 s17, s17, s19
    s_mov_b32 s20, s4
    s_mov_b32 s21, s5
    s_mov_b32 s22, 0x1e6000
    s_mov_b32 s23, 0x00020000
    s_lshl_b32 s19, s17, 5
    v_and_b32 v5, 31, v0
    v_add_u32 v5, s19, v5
    v_lshrrev_b32 v6, 5, v0
    v_mul_u32_u24 v6, 248832, v6
    v_lshl_add_u32 v6, v5, 2, v6
    v_mov_b32 v8, 0
    v_mov_b32 v9, 0
    v_mov_b32 v10, 0x00003f80
    v_mov_b32 v11, 0x3f800000
    s_mov_b32 s31, 0
    buffer_load_dword v16, v6, s[20:23], s31 offen
    s_mov_b32 s31, 3456
    buffer_load_dword v17, v6, s[20:23], s31 offen
    s_mov_b32 s31, 6912
    buffer_load_dword v18, v6, s[20:23], s31 offen
    s_mov_b32 s31, 10368
    buffer_load_dword v19, v6, s[20:23], s31 offen
    s_mov_b32 s31, 13824
    buffer_load_dword v20, v6, s[20:23], s31 offen
    s_mov_b32 s31, 17280
    buffer_load_dword v21, v6, s[20:23], s31 offen
    s_mov_b32 s31, 20736
    buffer_load_dword v22, v6, s[20:23], s31 offen
    s_mov_b32 s31, 24192
    buffer_load_dword v23, v6, s[20:23], s31 offen
    s_mov_b32 s31, 27648
    buffer_load_dword v24, v6, s[20:23], s31 offen
    s_mov_b32 s31, 31104
    buffer_load_dword v25, v6, s[20:23], s31 offen
    s_mov_b32 s31, 34560
    buffer_load_dword v26, v6, s[20:23], s31 offen
    s_mov_b32 s31, 38016
    buffer_load_dword v27, v6, s[20:23], s31 offen
    s_mov_b32 s31, 41472
    buffer_load_dword v28, v6, s[20:23], s31 offen
    s_mov_b32 s31, 44928
    buffer_load_dword v29, v6, s[20:23], s31 offen
    s_mov_b32 s31, 48384
    buffer_load_dword v30, v6, s[20:23], s31 offen
    s_mov_b32 s31, 51840
    buffer_load_dword v31, v6, s[20:23], s31 offen
    s_mov_b32 s31, 55296
    buffer_load_dword v32, v6, s[20:23], s31 offen
    s_mov_b32 s31, 58752
    buffer_load_dword v33, v6, s[20:23], s31 offen
    s_mov_b32 s31, 62208
    buffer_load_dword v34, v6, s[20:23], s31 offen
    s_mov_b32 s31, 65664
    buffer_load_dword v35, v6, s[20:23], s31 offen
    s_mov_b32 s31, 69120
    buffer_load_dword v36, v6, s[20:23], s31 offen
    s_mov_b32 s31, 72576
    buffer_load_dword v37, v6, s[20:23], s31 offen
    s_mov_b32 s31, 76032
    buffer_load_dword v38, v6, s[20:23], s31 offen
    s_mov_b32 s31, 79488
    buffer_load_dword v39, v6, s[20:23], s31 offen
    s_mov_b32 s31, 82944
    buffer_load_dword v40, v6, s[20:23], s31 offen
    s_mov_b32 s31, 86400
    buffer_load_dword v41, v6, s[20:23], s31 offen
    s_mov_b32 s31, 89856
    buffer_load_dword v42, v6, s[20:23], s31 offen
    s_mov_b32 s31, 93312
    buffer_load_dword v43, v6, s[20:23], s31 offen
    s_mov_b32 s31, 96768
    buffer_load_dword v44, v6, s[20:23], s31 offen
    s_mov_b32 s31, 100224
    buffer_load_dword v45, v6, s[20:23], s31 offen
    s_mov_b32 s31, 103680
    buffer_load_dword v46, v6, s[20:23], s31 offen
    s_mov_b32 s31, 107136
    buffer_load_dword v47, v6, s[20:23], s31 offen
    s_mov_b32 s31, 110592
    buffer_load_dword v48, v6, s[20:23], s31 offen
    s_mov_b32 s31, 114048
    buffer_load_dword v49, v6, s[20:23], s31 offen
    s_mov_b32 s31, 117504
    buffer_load_dword v50, v6, s[20:23], s31 offen
    s_mov_b32 s31, 120960
    buffer_load_dword v51, v6, s[20:23], s31 offen
    s_mov_b32 s31, 124416
    buffer_load_dword v52, v6, s[20:23], s31 offen
    s_mov_b32 s31, 127872
    buffer_load_dword v53, v6, s[20:23], s31 offen
    s_mov_b32 s31, 131328
    buffer_load_dword v54, v6, s[20:23], s31 offen
    s_mov_b32 s31, 134784
    buffer_load_dword v55, v6, s[20:23], s31 offen
    s_mov_b32 s31, 138240
    buffer_load_dword v56, v6, s[20:23], s31 offen
    s_mov_b32 s31, 141696
    buffer_load_dword v57, v6, s[20:23], s31 offen
    s_mov_b32 s31, 145152
    buffer_load_dword v58, v6, s[20:23], s31 offen
    s_mov_b32 s31, 148608
    buffer_load_dword v59, v6, s[20:23], s31 offen
    s_mov_b32 s31, 152064
    buffer_load_dword v60, v6, s[20:23], s31 offen
    s_mov_b32 s31, 155520
    buffer_load_dword v61, v6, s[20:23], s31 offen
    s_mov_b32 s31, 158976
    buffer_load_dword v62, v6, s[20:23], s31 offen
    s_mov_b32 s31, 162432
    buffer_load_dword v63, v6, s[20:23], s31 offen
    s_mov_b32 s31, 165888
    buffer_load_dword v64, v6, s[20:23], s31 offen
    s_mov_b32 s31, 169344
    buffer_load_dword v65, v6, s[20:23], s31 offen
    s_mov_b32 s31, 172800
    buffer_load_dword v66, v6, s[20:23], s31 offen
    s_mov_b32 s31, 176256
    buffer_load_dword v67, v6, s[20:23], s31 offen
    s_mov_b32 s31, 179712
    buffer_load_dword v68, v6, s[20:23], s31 offen
    s_mov_b32 s31, 183168
    buffer_load_dword v69, v6, s[20:23], s31 offen
    s_mov_b32 s31, 186624
    buffer_load_dword v70, v6, s[20:23], s31 offen
    s_mov_b32 s31, 190080
    buffer_load_dword v71, v6, s[20:23], s31 offen
    s_mov_b32 s31, 193536
    buffer_load_dword v72, v6, s[20:23], s31 offen
    s_mov_b32 s31, 196992
    buffer_load_dword v73, v6, s[20:23], s31 offen
    s_mov_b32 s31, 200448
    buffer_load_dword v74, v6, s[20:23], s31 offen
    s_mov_b32 s31, 203904
    buffer_load_dword v75, v6, s[20:23], s31 offen
    s_mov_b32 s31, 207360
    buffer_load_dword v76, v6, s[20:23], s31 offen
    s_mov_b32 s31, 210816
    buffer_load_dword v77, v6, s[20:23], s31 offen
    s_mov_b32 s31, 214272
    buffer_load_dword v78, v6, s[20:23], s31 offen
    s_mov_b32 s31, 217728
    buffer_load_dword v79, v6, s[20:23], s31 offen
    s_mov_b32 s31, 221184
    buffer_load_dword v80, v6, s[20:23], s31 offen
    s_mov_b32 s31, 224640
    buffer_load_dword v81, v6, s[20:23], s31 offen
    s_mov_b32 s31, 228096
    buffer_load_dword v82, v6, s[20:23], s31 offen
    s_mov_b32 s31, 231552
    buffer_load_dword v83, v6, s[20:23], s31 offen
    s_mov_b32 s31, 235008
    buffer_load_dword v84, v6, s[20:23], s31 offen
    s_mov_b32 s31, 238464
    buffer_load_dword v85, v6, s[20:23], s31 offen
    s_mov_b32 s31, 241920
    buffer_load_dword v86, v6, s[20:23], s31 offen
    s_mov_b32 s31, 245376
    buffer_load_dword v87, v6, s[20:23], s31 offen
    s_waitcnt vmcnt(48)
    v_dot2_f32_bf16 v8, v16, v10, v8
    v_dot2_f32_bf16 v9, v16, v11, v9
    v_dot2_f32_bf16 v8, v17, v10, v8
    v_dot2_f32_bf16 v9, v17, v11, v9
    v_dot2_f32_bf16 v8, v18, v10, v8
    v_dot2_f32_bf16 v9, v18, v11, v9
    v_dot2_f32_bf16 v8, v19, v10, v8
    v_dot2_f32_bf16 v9, v19, v11, v9
    v_dot2_f32_bf16 v8, v20, v10, v8
    v_dot2_f32_bf16 v9, v20, v11, v9
    v_dot2_f32_bf16 v8, v21, v10, v8
    v_dot2_f32_bf16 v9, v21, v11, v9
    v_dot2_f32_bf16 v8, v22, v10, v8
    v_dot2_f32_bf16 v9, v22, v11, v9
    v_dot2_f32_bf16 v8, v23, v10, v8
    v_dot2_f32_bf16 v9, v23, v11, v9
    v_dot2_f32_bf16 v8, v24, v10, v8
    v_dot2_f32_bf16 v9, v24, v11, v9
    v_dot2_f32_bf16 v8, v25, v10, v8
    v_dot2_f32_bf16 v9, v25, v11, v9
    v_dot2_f32_bf16 v8, v26, v10, v8
    v_dot2_f32_bf16 v9, v26, v11, v9
    v_dot2_f32_bf16 v8, v27, v10, v8
    v_dot2_f32_bf16 v9, v27, v11, v9
    v_dot2_f32_bf16 v8, v28, v10, v8
    v_dot2_f32_bf16 v9, v28, v11, v9
    v_dot2_f32_bf16 v8, v29, v10, v8
    v_dot2_f32_bf16 v9, v29, v11, v9
    v_dot2_f32_bf16 v8, v30, v10, v8
    v_dot2_f32_bf16 v9, v30, v11, v9
    v_dot2_f32_bf16 v8, v31, v10, v8
    v_dot2_f32_bf16 v9, v31, v11, v9
    v_dot2_f32_bf16 v8, v32, v10, v8
    v_dot2_f32_bf16 v9, v32, v11, v9
    v_dot2_f32_bf16 v8, v33, v10, v8
    v_dot2_f32_bf16 v9, v33, v11, v9
    v_dot2_f32_bf16 v8, v34, v10, v8
    v_dot2_f32_bf16 v9, v34, v11, v9
    v_dot2_f32_bf16 v8, v35, v10, v8
    v_dot2_f32_bf16 v9, v35, v11, v9
    v_dot2_f32_bf16 v8, v36, v10, v8
    v_dot2_f32_bf16 v9, v36, v11, v9
    v_dot2_f32_bf16 v8, v37, v10, v8
    v_dot2_f32_bf16 v9, v37, v11, v9
    v_dot2_f32_bf16 v8, v38, v10, v8
    v_dot2_f32_bf16 v9, v38, v11, v9
    v_dot2_f32_bf16 v8, v39, v10, v8
    v_dot2_f32_bf16 v9, v39, v11, v9
    s_waitcnt vmcnt(24)
    v_dot2_f32_bf16 v8, v40, v10, v8
    v_dot2_f32_bf16 v9, v40, v11, v9
    v_dot2_f32_bf16 v8, v41, v10, v8
    v_dot2_f32_bf16 v9, v41, v11, v9
    v_dot2_f32_bf16 v8, v42, v10, v8
    v_dot2_f32_bf16 v9, v42, v11, v9
    v_dot2_f32_bf16 v8, v43, v10, v8
    v_dot2_f32_bf16 v9, v43, v11, v9
    v_dot2_f32_bf16 v8, v44, v10, v8
    v_dot2_f32_bf16 v9, v44, v11, v9
    v_dot2_f32_bf16 v8, v45, v10, v8
    v_dot2_f32_bf16 v9, v45, v11, v9
    v_dot2_f32_bf16 v8, v46, v10, v8
    v_dot2_f32_bf16 v9, v46, v11, v9
    v_dot2_f32_bf16 v8, v47, v10, v8
    v_dot2_f32_bf16 v9, v47, v11, v9
    v_dot2_f32_bf16 v8, v48, v10, v8
    v_dot2_f32_bf16 v9, v48, v11, v9
    v_dot2_f32_bf16 v8, v49, v10, v8
    v_dot2_f32_bf16 v9, v49, v11, v9
    v_dot2_f32_bf16 v8, v50, v10, v8
    v_dot2_f32_bf16 v9, v50, v11, v9
    v_dot2_f32_bf16 v8, v51, v10, v8
    v_dot2_f32_bf16 v9, v51, v11, v9
    v_dot2_f32_bf16 v8, v52, v10, v8
    v_dot2_f32_bf16 v9, v52, v11, v9
    v_dot2_f32_bf16 v8, v53, v10, v8
    v_dot2_f32_bf16 v9, v53, v11, v9
    v_dot2_f32_bf16 v8, v54, v10, v8
    v_dot2_f32_bf16 v9, v54, v11, v9
    v_dot2_f32_bf16 v8, v55, v10, v8
    v_dot2_f32_bf16 v9, v55, v11, v9
    v_dot2_f32_bf16 v8, v56, v10, v8
    v_dot2_f32_bf16 v9, v56, v11, v9
    v_dot2_f32_bf16 v8, v57, v10, v8
    v_dot2_f32_bf16 v9, v57, v11, v9
    v_dot2_f32_bf16 v8, v58, v10, v8
    v_dot2_f32_bf16 v9, v58, v11, v9
    v_dot2_f32_bf16 v8, v59, v10, v8
    v_dot2_f32_bf16 v9, v59, v11, v9
    v_dot2_f32_bf16 v8, v60, v10, v8
    v_dot2_f32_bf16 v9, v60, v11, v9
    v_dot2_f32_bf16 v8, v61, v10, v8
    v_dot2_f32_bf16 v9, v61, v11, v9
    v_dot2_f32_bf16 v8, v62, v10, v8
    v_dot2_f32_bf16 v9, v62, v11, v9
    v_dot2_f32_bf16 v8, v63, v10, v8
    v_dot2_f32_bf16 v9, v63, v11, v9
    s_waitcnt vmcnt(0)
    v_dot2_f32_bf16 v8, v64, v10, v8
    v_dot2_f32_bf16 v9, v64, v11, v9
    v_dot2_f32_bf16 v8, v65, v10, v8
    v_dot2_f32_bf16 v9, v65, v11, v9
    v_dot2_f32_bf16 v8, v66, v10, v8
    v_dot2_f32_bf16 v9, v66, v11, v9
    v_dot2_f32_bf16 v8, v67, v10, v8
    v_dot2_f32_bf16 v9, v67, v11, v9
    v_dot2_f32_bf16 v8, v68, v10, v8
    v_dot2_f32_bf16 v9, v68, v11, v9
    v_dot2_f32_bf16 v8, v69, v10, v8
    v_dot2_f32_bf16 v9, v69, v11, v9
    v_dot2_f32_bf16 v8, v70, v10, v8
    v_dot2_f32_bf16 v9, v70, v11, v9
    v_dot2_f32_bf16 v8, v71, v10, v8
    v_dot2_f32_bf16 v9, v71, v11, v9
    v_dot2_f32_bf16 v8, v72, v10, v8
    v_dot2_f32_bf16 v9, v72, v11, v9
    v_dot2_f32_bf16 v8, v73, v10, v8
    v_dot2_f32_bf16 v9, v73, v11, v9
    v_dot2_f32_bf16 v8, v74, v10, v8
    v_dot2_f32_bf16 v9, v74, v11, v9
    v_dot2_f32_bf16 v8, v75, v10, v8
    v_dot2_f32_bf16 v9, v75, v11, v9
    v_dot2_f32_bf16 v8, v76, v10, v8
    v_dot2_f32_bf16 v9, v76, v11, v9
    v_dot2_f32_bf16 v8, v77, v10, v8
    v_dot2_f32_bf16 v9, v77, v11, v9
    v_dot2_f32_bf16 v8, v78, v10, v8
    v_dot2_f32_bf16 v9, v78, v11, v9
    v_dot2_f32_bf16 v8, v79, v10, v8
    v_dot2_f32_bf16 v9, v79, v11, v9
    v_dot2_f32_bf16 v8, v80, v10, v8
    v_dot2_f32_bf16 v9, v80, v11, v9
    v_dot2_f32_bf16 v8, v81, v10, v8
    v_dot2_f32_bf16 v9, v81, v11, v9
    v_dot2_f32_bf16 v8, v82, v10, v8
    v_dot2_f32_bf16 v9, v82, v11, v9
    v_dot2_f32_bf16 v8, v83, v10, v8
    v_dot2_f32_bf16 v9, v83, v11, v9
    v_dot2_f32_bf16 v8, v84, v10, v8
    v_dot2_f32_bf16 v9, v84, v11, v9
    v_dot2_f32_bf16 v8, v85, v10, v8
    v_dot2_f32_bf16 v9, v85, v11, v9
    v_dot2_f32_bf16 v8, v86, v10, v8
    v_dot2_f32_bf16 v9, v86, v11, v9
    v_dot2_f32_bf16 v8, v87, v10, v8
    v_dot2_f32_bf16 v9, v87, v11, v9
    v_lshlrev_b32 v12, 3, v0
    s_nop 2
    ds_write_b64 v12, v[8:9]
    s_waitcnt lgkmcnt(0)
    s_barrier
    s_cmp_lg_u32 s16, 0
    s_cbranch_scc1 prep_kernel_end
    v_and_b32 v12, 31, v0
    v_lshlrev_b32 v12, 3, v12
    ds_read_b64 v[14:15], v12 offset:0
    ds_read_b64 v[16:17], v12 offset:256
    ds_read_b64 v[18:19], v12 offset:512
    ds_read_b64 v[20:21], v12 offset:768
    ds_read_b64 v[22:23], v12 offset:1024
    ds_read_b64 v[24:25], v12 offset:1280
    ds_read_b64 v[26:27], v12 offset:1536
    ds_read_b64 v[28:29], v12 offset:1792
    s_waitcnt lgkmcnt(0)
    v_add_f32 v8, v14, v16
    v_add_f32 v9, v15, v17
    v_add_f32 v8, v8, v18
    v_add_f32 v9, v9, v19
    v_add_f32 v8, v8, v20
    v_add_f32 v9, v9, v21
    v_add_f32 v8, v8, v22
    v_add_f32 v9, v9, v23
    v_add_f32 v8, v8, v24
    v_add_f32 v9, v9, v25
    v_add_f32 v8, v8, v26
    v_add_f32 v9, v9, v27
    v_add_f32 v8, v8, v28
    v_add_f32 v9, v9, v29
    v_lshlrev_b32 v13, 1, v5
    v_mul_u32_u24 v14, 3641, v13
    v_lshrrev_b32 v14, 16, v14
    v_mul_u32_u24 v15, 18, v14
    v_sub_u32 v15, v13, v15
    v_lshrrev_b32 v16, 5, v14
    v_and_b32 v17, 31, v14
    v_lshrrev_b32 v18, 1, v17
    v_and_b32 v17, 1, v17
    v_lshl_add_u32 v19, v16, 1, v17
    v_lshl_add_u32 v19, v19, 4, v15
    v_lshlrev_b32 v20, 2, v16
    v_lshl_add_u32 v20, v17, 1, v20
    v_add3_u32 v20, v20, v15, 64
    v_add_u32 v20, 16, v20
    v_cmp_gt_u32 vcc, 16, v15
    s_nop 1
    v_cndmask_b32 v19, v20, v19, vcc
    v_mul_u32_u24 v18, 448, v18
    v_lshl_add_u32 v18, v19, 2, v18
    s_mul_i32 s28, s18, 7168
    s_add_u32 s28, s28, 0x1380000
    v_cmp_gt_u32 vcc, 32, v0
    s_mov_b64 exec, vcc
    buffer_store_dwordx2 v[8:9], v18, s[24:27], s28 offen sc1
prep_kernel_end:
    s_endpgm
.text
.globl qkva1_kernel
.p2align 8
.type qkva1_kernel,@function
qkva1_kernel:
    s_cmp_ge_u32 s2, 256
    s_cbranch_scc1 qkva1_kernel_end
    s_load_dwordx2 s[8:9], s[0:1], 64
    s_and_b32 s10, s2, 7
    s_lshr_b32 s11, s2, 3
    s_lshr_b32 s12, s10, 1
    s_lshl_b32 s12, s12, 2
    s_and_b32 s13, s11, 3
    s_add_u32 s12, s12, s13
    s_and_b32 s13, s10, 1
    s_lshl_b32 s13, s13, 3
    s_lshr_b32 s14, s11, 2
    s_add_u32 s13, s13, s14
    v_lshrrev_b32 v1, 6, v0
    v_and_b32 v15, 63, v0
    v_readfirstlane_b32 s22, v1
    s_and_b32 s14, s22, 3
    v_lshlrev_b32 v1, 4, v15
    v_add_u32 v2, 0x10000, v1
    v_and_b32 v13, 15, v15
    v_lshrrev_b32 v14, 4, v15
    s_lshl_b32 s15, s12, 7
    s_lshl_b32 s28, s14, 5
    s_add_u32 s15, s15, s28
    s_lshl_b32 s19, s14, 10
    v_lshlrev_b32 v3, 2, v13
    v_lshlrev_b32 v4, 4, v14
    v_mov_b32 v176, 0x3f803f80
    v_mov_b32 v177, 0x3f803f80
    v_mov_b32 v178, 0x3f803f80
    v_mov_b32 v179, 0x3f803f80
    s_lshr_b32 s16, s15, 4
    s_mul_i32 s16, s16, 18432
    s_add_u32 s16, s16, 0x0
    s_add_u32 s17, s13, 0
    s_mul_i32 s18, s17, 129024
    s_add_u32 s18, s18, 0xe00000
    s_add_u32 s18, s18, s19
    v_add_u32 v5, s15, v13
    v_mul_u32_u24 v5, 48, v5
    s_waitcnt lgkmcnt(0)
    s_mov_b32 s24, s8
    s_mov_b32 s25, s9
    s_mov_b32 s26, 0x1480000
    s_mov_b32 s27, 0x00020000
    s_cmp_lt_u32 s22, 4
    s_cbranch_scc1 qkva1_kernel_comp
    s_add_u32 s20, s19, 0
    s_add_u32 s21, s18, 0
    s_mov_b32 m0, s20
    s_nop 0
    buffer_load_dwordx4 v1, s[24:27], s21 offen lds
    s_add_u32 s20, s19, 4096
    s_add_u32 s21, s18, 4096
    s_mov_b32 m0, s20
    s_nop 0
    buffer_load_dwordx4 v1, s[24:27], s21 offen lds
    s_add_u32 s20, s19, 8192
    s_add_u32 s21, s18, 8192
    s_mov_b32 m0, s20
    s_nop 0
    buffer_load_dwordx4 v1, s[24:27], s21 offen lds
    s_add_u32 s20, s19, 12288
    s_add_u32 s21, s18, 12288
    s_mov_b32 m0, s20
    s_nop 0
    buffer_load_dwordx4 v1, s[24:27], s21 offen lds
    s_add_u32 s20, s19, 16384
    s_add_u32 s21, s18, 16384
    s_mov_b32 m0, s20
    s_nop 0
    buffer_load_dwordx4 v1, s[24:27], s21 offen lds
    s_add_u32 s20, s19, 20480
    s_add_u32 s21, s18, 20480
    s_mov_b32 m0, s20
    s_nop 0
    buffer_load_dwordx4 v1, s[24:27], s21 offen lds
    s_add_u32 s20, s19, 24576
    s_add_u32 s21, s18, 24576
    s_mov_b32 m0, s20
    s_nop 0
    buffer_load_dwordx4 v1, s[24:27], s21 offen lds
    s_add_u32 s20, s19, 28672
    s_add_u32 s21, s18, 28672
    s_mov_b32 m0, s20
    s_nop 0
    buffer_load_dwordx4 v1, s[24:27], s21 offen lds
    s_add_u32 s20, s19, 32768
    s_add_u32 s21, s18, 32768
    s_mov_b32 m0, s20
    s_nop 0
    buffer_load_dwordx4 v1, s[24:27], s21 offen lds
    s_add_u32 s20, s19, 36864
    s_add_u32 s21, s18, 36864
    s_mov_b32 m0, s20
    s_nop 0
    buffer_load_dwordx4 v1, s[24:27], s21 offen lds
    s_add_u32 s20, s19, 40960
    s_add_u32 s21, s18, 40960
    s_mov_b32 m0, s20
    s_nop 0
    buffer_load_dwordx4 v1, s[24:27], s21 offen lds
    s_add_u32 s20, s19, 45056
    s_add_u32 s21, s18, 45056
    s_mov_b32 m0, s20
    s_nop 0
    buffer_load_dwordx4 v1, s[24:27], s21 offen lds
    s_add_u32 s20, s19, 49152
    s_add_u32 s21, s18, 49152
    s_mov_b32 m0, s20
    s_nop 0
    buffer_load_dwordx4 v1, s[24:27], s21 offen lds
    s_add_u32 s20, s19, 53248
    s_add_u32 s21, s18, 53248
    s_mov_b32 m0, s20
    s_nop 0
    buffer_load_dwordx4 v1, s[24:27], s21 offen lds
    s_waitcnt vmcnt(7)
    s_barrier
    s_add_u32 s20, s19, 57344
    s_add_u32 s21, s18, 57344
    s_mov_b32 m0, s20
    s_nop 0
    buffer_load_dwordx4 v1, s[24:27], s21 offen lds
    s_add_u32 s20, s19, 61440
    s_add_u32 s21, s18, 61440
    s_mov_b32 m0, s20
    s_nop 0
    buffer_load_dwordx4 v1, s[24:27], s21 offen lds
    s_add_u32 s20, s19, 65536
    s_add_u32 s21, s18, 65536
    s_mov_b32 m0, s20
    s_nop 0
    buffer_load_dwordx4 v1, s[24:27], s21 offen lds
    s_add_u32 s20, s19, 69632
    s_add_u32 s21, s18, 69632
    s_mov_b32 m0, s20
    s_nop 0
    buffer_load_dwordx4 v1, s[24:27], s21 offen lds
    s_add_u32 s20, s19, 73728
    s_add_u32 s21, s18, 73728
    s_mov_b32 m0, s20
    s_nop 0
    buffer_load_dwordx4 v1, s[24:27], s21 offen lds
    s_add_u32 s20, s19, 77824
    s_add_u32 s21, s18, 77824
    s_mov_b32 m0, s20
    s_nop 0
    buffer_load_dwordx4 v1, s[24:27], s21 offen lds
    s_add_u32 s20, s19, 81920
    s_add_u32 s21, s18, 81920
    s_mov_b32 m0, s20
    s_nop 0
    buffer_load_dwordx4 v1, s[24:27], s21 offen lds
    s_waitcnt vmcnt(7)
    s_barrier
    s_add_u32 s20, s19, 86016
    s_add_u32 s21, s18, 86016
    s_mov_b32 m0, s20
    s_nop 0
    buffer_load_dwordx4 v1, s[24:27], s21 offen lds
    s_add_u32 s20, s19, 90112
    s_add_u32 s21, s18, 90112
    s_mov_b32 m0, s20
    s_nop 0
    buffer_load_dwordx4 v1, s[24:27], s21 offen lds
    s_add_u32 s20, s19, 94208
    s_add_u32 s21, s18, 94208
    s_mov_b32 m0, s20
    s_nop 0
    buffer_load_dwordx4 v1, s[24:27], s21 offen lds
    s_add_u32 s20, s19, 98304
    s_add_u32 s21, s18, 98304
    s_mov_b32 m0, s20
    s_nop 0
    buffer_load_dwordx4 v1, s[24:27], s21 offen lds
    s_add_u32 s20, s19, 102400
    s_add_u32 s21, s18, 102400
    s_mov_b32 m0, s20
    s_nop 0
    buffer_load_dwordx4 v1, s[24:27], s21 offen lds
    s_add_u32 s20, s19, 106496
    s_add_u32 s21, s18, 106496
    s_mov_b32 m0, s20
    s_nop 0
    buffer_load_dwordx4 v1, s[24:27], s21 offen lds
    s_add_u32 s20, s19, 110592
    s_add_u32 s21, s18, 110592
    s_mov_b32 m0, s20
    s_nop 0
    buffer_load_dwordx4 v1, s[24:27], s21 offen lds
    s_waitcnt vmcnt(7)
    s_barrier
    s_add_u32 s20, s19, 114688
    s_add_u32 s21, s18, 114688
    s_mov_b32 m0, s20
    s_nop 0
    buffer_load_dwordx4 v1, s[24:27], s21 offen lds
    s_add_u32 s20, s19, 118784
    s_add_u32 s21, s18, 118784
    s_mov_b32 m0, s20
    s_nop 0
    buffer_load_dwordx4 v1, s[24:27], s21 offen lds
    s_add_u32 s20, s19, 122880
    s_add_u32 s21, s18, 122880
    s_mov_b32 m0, s20
    s_nop 0
    buffer_load_dwordx4 v1, s[24:27], s21 offen lds
    s_and_b32 s20, s19, 0x400
    s_sub_u32 s21, s18, s19
    s_add_u32 s21, s21, s20
    s_add_u32 s21, s21, 126976
    s_add_u32 s20, s20, 126976
    s_mov_b32 m0, s20
    s_nop 0
    buffer_load_dwordx4 v1, s[24:27], s21 offen lds
    s_waitcnt vmcnt(4)
    s_barrier
    s_waitcnt vmcnt(0)
    s_barrier
    s_endpgm
qkva1_kernel_comp:
    s_add_u32 s21, s16, 0
    buffer_load_dwordx4 v[16:19], v1, s[24:27], s21 offen
    s_add_u32 s21, s16, 18432
    buffer_load_dwordx4 v[20:23], v1, s[24:27], s21 offen
    s_add_u32 s21, s16, 1024
    buffer_load_dwordx4 v[24:27], v1, s[24:27], s21 offen
    s_add_u32 s21, s16, 19456
    buffer_load_dwordx4 v[28:31], v1, s[24:27], s21 offen
    s_add_u32 s21, s16, 2048
    buffer_load_dwordx4 v[32:35], v1, s[24:27], s21 offen
    s_add_u32 s21, s16, 20480
    buffer_load_dwordx4 v[36:39], v1, s[24:27], s21 offen
    s_add_u32 s21, s16, 3072
    buffer_load_dwordx4 v[40:43], v1, s[24:27], s21 offen
    s_add_u32 s21, s16, 21504
    buffer_load_dwordx4 v[44:47], v1, s[24:27], s21 offen
    s_add_u32 s21, s16, 4096
    buffer_load_dwordx4 v[48:51], v1, s[24:27], s21 offen
    s_add_u32 s21, s16, 22528
    buffer_load_dwordx4 v[52:55], v1, s[24:27], s21 offen
    s_add_u32 s21, s16, 5120
    buffer_load_dwordx4 v[56:59], v1, s[24:27], s21 offen
    s_add_u32 s21, s16, 23552
    buffer_load_dwordx4 v[60:63], v1, s[24:27], s21 offen
    s_mul_i32 s21, s17, 448
    s_add_u32 s21, s21, 0x1380000
    buffer_load_dwordx4 v[148:151], v4, s[24:27], s21 offen offset:0
    buffer_load_dwordx4 v[152:155], v4, s[24:27], s21 offen offset:64
    buffer_load_dword v156, v3, s[24:27], s21 offen offset:128
    buffer_load_dword v160, v3, s[24:27], s21 offen offset:192
    buffer_load_dword v164, v3, s[24:27], s21 offen offset:256
    buffer_load_dword v168, v3, s[24:27], s21 offen offset:320
    buffer_load_dword v172, v3, s[24:27], s21 offen offset:384
    s_mov_b32 s21, 0x13b0000
    buffer_load_dwordx4 v[180:183], v5, s[24:27], s21 offen offset:0
    buffer_load_dwordx4 v[184:187], v5, s[24:27], s21 offen offset:16
    buffer_load_dwordx4 v[188:191], v5, s[24:27], s21 offen offset:32
    buffer_load_dwordx4 v[192:195], v5, s[24:27], s21 offen offset:768
    buffer_load_dwordx4 v[196:199], v5, s[24:27], s21 offen offset:784
    buffer_load_dwordx4 v[200:203], v5, s[24:27], s21 offen offset:800
    s_mov_b32 s35, 0x3fb8aa3b
    s_mov_b32 s36, 0x358637bd
    s_lshl_b32 s40, s12, 2
    s_add_u32 s40, s40, s14
    s_lshl_b32 s41, s13, 7
    s_add_u32 s41, s41, s40
    s_mul_i32 s41, s41, 1152
    s_add_u32 s41, s41, 0x480000
    s_add_u32 s44, s41, 73728
    v_lshrrev_b32 v240, 1, v14
    v_lshlrev_b32 v240, 9, v240
    v_lshl_add_u32 v240, v13, 4, v240
    v_and_b32 v241, 1, v14
    v_lshl_add_u32 v240, v241, 3, v240
    v_lshrrev_b32 v242, 1, v13
    v_mul_u32_u24 v242, 73728, v242
    v_add3_u32 v242, v242, v4, 0
    v_and_b32 v243, 1, v13
    v_lshl_add_u32 v242, v243, 1, v242
    v_add_u32 v242, 1024, v242
    v_cmp_gt_u32 vcc, 4, v13
    v_mov_b32 v245, 0x40000000
    s_nop 0
    v_cndmask_b32 v242, v245, v242, vcc
    v_add_u32 v204, 0, v0
    v_cmp_le_u32 vcc, 380, v204
    s_nop 1
    v_cndmask_b32 v205, 0, 1, vcc
    v_mul_u32_u24 v206, 380, v205
    v_sub_u32 v206, v204, v206
    v_mul_u32_u24 v207, 3277, v206
    v_lshrrev_b32 v207, 16, v207
    v_mul_u32_u24 v208, 20, v207
    v_sub_u32 v208, v206, v208
    v_lshl_add_u32 v209, v205, 4, v208
    v_lshl_add_u32 v210, v205, 1, v208
    v_add_u32 v210, 20, v210
    v_cmp_gt_u32 vcc, 16, v208
    s_nop 1
    v_cndmask_b32 v210, v210, v209, vcc
    v_lshl_add_u32 v209, v205, 4, v207
    v_lshl_add_u32 v211, v205, 1, v207
    v_add_u32 v211, 24, v211
    v_cmp_gt_u32 vcc, 16, v207
    s_nop 1
    v_cndmask_b32 v211, v211, v209, vcc
    v_cmp_eq_u32 vcc, 18, v207
    s_nop 1
    v_cndmask_b32 v211, v211, 44, vcc
    v_mul_u32_u24 v210, 48, v210
    v_add_lshl_u32 v210, v210, v211, 2
    v_cmp_gt_u32 vcc, 760, v204
    v_cmp_gt_u32 s[38:39], 18, v208
    v_lshlrev_b32 v204, 2, v204
    v_mov_b32 v205, 0x40000000
    s_and_b64 vcc, vcc, s[38:39]
    s_nop 0
    v_cndmask_b32 v246, v205, v204, vcc
    v_cndmask_b32 v247, 0, v210, vcc
    v_add_u32 v204, 256, v0
    v_cmp_le_u32 vcc, 380, v204
    s_nop 1
    v_cndmask_b32 v205, 0, 1, vcc
    v_mul_u32_u24 v206, 380, v205
    v_sub_u32 v206, v204, v206
    v_mul_u32_u24 v207, 3277, v206
    v_lshrrev_b32 v207, 16, v207
    v_mul_u32_u24 v208, 20, v207
    v_sub_u32 v208, v206, v208
    v_lshl_add_u32 v209, v205, 4, v208
    v_lshl_add_u32 v210, v205, 1, v208
    v_add_u32 v210, 20, v210
    v_cmp_gt_u32 vcc, 16, v208
    s_nop 1
    v_cndmask_b32 v210, v210, v209, vcc
    v_lshl_add_u32 v209, v205, 4, v207
    v_lshl_add_u32 v211, v205, 1, v207
    v_add_u32 v211, 24, v211
    v_cmp_gt_u32 vcc, 16, v207
    s_nop 1
    v_cndmask_b32 v211, v211, v209, vcc
    v_cmp_eq_u32 vcc, 18, v207
    s_nop 1
    v_cndmask_b32 v211, v211, 44, vcc
    v_mul_u32_u24 v210, 48, v210
    v_add_lshl_u32 v210, v210, v211, 2
    v_cmp_gt_u32 vcc, 760, v204
    v_cmp_gt_u32 s[38:39], 18, v208
    v_lshlrev_b32 v204, 2, v204
    v_mov_b32 v205, 0x40000000
    s_and_b64 vcc, vcc, s[38:39]
    s_nop 0
    v_cndmask_b32 v248, v205, v204, vcc
    v_cndmask_b32 v249, 0, v210, vcc
    v_add_u32 v204, 512, v0
    v_cmp_le_u32 vcc, 380, v204
    s_nop 1
    v_cndmask_b32 v205, 0, 1, vcc
    v_mul_u32_u24 v206, 380, v205
    v_sub_u32 v206, v204, v206
    v_mul_u32_u24 v207, 3277, v206
    v_lshrrev_b32 v207, 16, v207
    v_mul_u32_u24 v208, 20, v207
    v_sub_u32 v208, v206, v208
    v_lshl_add_u32 v209, v205, 4, v208
    v_lshl_add_u32 v210, v205, 1, v208
    v_add_u32 v210, 20, v210
    v_cmp_gt_u32 vcc, 16, v208
    s_nop 1
    v_cndmask_b32 v210, v210, v209, vcc
    v_lshl_add_u32 v209, v205, 4, v207
    v_lshl_add_u32 v211, v205, 1, v207
    v_add_u32 v211, 24, v211
    v_cmp_gt_u32 vcc, 16, v207
    s_nop 1
    v_cndmask_b32 v211, v211, v209, vcc
    v_cmp_eq_u32 vcc, 18, v207
    s_nop 1
    v_cndmask_b32 v211, v211, 44, vcc
    v_mul_u32_u24 v210, 48, v210
    v_add_lshl_u32 v210, v210, v211, 2
    v_cmp_gt_u32 vcc, 760, v204
    v_cmp_gt_u32 s[38:39], 18, v208
    v_lshlrev_b32 v204, 2, v204
    v_mov_b32 v205, 0x40000000
    s_and_b64 vcc, vcc, s[38:39]
    s_nop 0
    v_cndmask_b32 v250, v205, v204, vcc
    v_cndmask_b32 v251, 0, v210, vcc
    s_waitcnt vmcnt(0)
    v_add_f32 v180, v180, v182
    v_add_f32 v184, v184, v186
    v_add_f32 v188, v188, v190
    v_add_f32 v181, v181, v183
    v_add_f32 v185, v185, v187
    v_add_f32 v189, v189, v191
    v_add_f32 v180, v180, v184
    v_add_f32 v181, v181, v185
    v_add_f32 v180, v180, v188
    v_add_f32 v181, v181, v189
    v_add_f32 v192, v192, v194
    v_add_f32 v196, v196, v198
    v_add_f32 v200, v200, v202
    v_add_f32 v193, v193, v195
    v_add_f32 v197, v197, v199
    v_add_f32 v201, v201, v203
    v_add_f32 v192, v192, v196
    v_add_f32 v193, v193, v197
    v_add_f32 v192, v192, v200
    v_add_f32 v193, v193, v201
    s_mov_b32 s33, 0x3ae38e39
    s_mov_b32 s34, 0x3727c5ac
    v_mul_f32 v208, s33, v180
    v_mul_f32 v210, s33, v181
    v_mul_f32 v209, s33, v192
    v_mul_f32 v211, s33, v193
    v_fma_f32 v210, -v208, v208, v210
    v_fma_f32 v211, -v209, v209, v211
    v_max_f32 v210, 0, v210
    v_max_f32 v211, 0, v211
    v_add_f32 v210, s34, v210
    v_add_f32 v211, s34, v211
    v_rsq_f32 v204, v210
    v_rsq_f32 v205, v211
    s_nop 0
    v_mul_f32 v206, -v208, v204
    v_mul_f32 v207, -v209, v205
    s_lshl_b32 s29, s14, 8
    s_add_u32 s29, s29, 129024
    v_add_u32 v212, s29, v3
    ds_write_b32 v212, v204 offset:0
    ds_write_b32 v212, v206 offset:128
    ds_write_b32 v212, v205 offset:64
    ds_write_b32 v212, v207 offset:192
    v_add_u32 v213, s29, v4
    s_waitcnt lgkmcnt(0)
    ds_read_b128 v[224:227], v213 offset:0
    ds_read_b128 v[232:235], v213 offset:128
    ds_read_b128 v[228:231], v213 offset:64
    ds_read_b128 v[236:239], v213 offset:192
    s_waitcnt lgkmcnt(0)
    s_barrier
    ds_read_b128 v[64:67], v1 offset:0
    ds_read_b128 v[68:71], v1 offset:1024
    ds_read_b128 v[72:75], v1 offset:2048
    ds_read_b128 v[76:79], v1 offset:3072
    ds_read_b128 v[80:83], v1 offset:4096
    ds_read_b128 v[84:87], v1 offset:5120
    ds_read_b128 v[88:91], v1 offset:6144
    s_waitcnt vmcnt(23)
    s_waitcnt lgkmcnt(6)
    v_mfma_f32_16x16x32_bf16 v[92:95], v[64:67], v[16:19], 0
    v_mfma_f32_16x16x32_bf16 v[96:99], v[64:67], v[20:23], 0
    ds_read_b128 v[64:67], v1 offset:7168
    s_waitcnt lgkmcnt(6)
    v_mfma_f32_16x16x32_bf16 v[100:103], v[68:71], v[16:19], 0
    v_mfma_f32_16x16x32_bf16 v[104:107], v[68:71], v[20:23], 0
    ds_read_b128 v[68:71], v1 offset:8192
    s_waitcnt lgkmcnt(6)
    v_mfma_f32_16x16x32_bf16 v[108:111], v[16:19], v[72:75], 0
    v_mfma_f32_16x16x32_bf16 v[112:115], v[20:23], v[72:75], 0
    ds_read_b128 v[72:75], v1 offset:9216
    s_waitcnt lgkmcnt(6)
    v_mfma_f32_16x16x32_bf16 v[116:119], v[16:19], v[76:79], 0
    v_mfma_f32_16x16x32_bf16 v[120:123], v[20:23], v[76:79], 0
    ds_read_b128 v[76:79], v1 offset:10240
    s_waitcnt lgkmcnt(6)
    v_mfma_f32_16x16x32_bf16 v[124:127], v[16:19], v[80:83], 0
    v_mfma_f32_16x16x32_bf16 v[128:131], v[20:23], v[80:83], 0
    ds_read_b128 v[80:83], v1 offset:11264
    s_waitcnt lgkmcnt(6)
    v_mfma_f32_16x16x32_bf16 v[132:135], v[16:19], v[84:87], 0
    v_mfma_f32_16x16x32_bf16 v[136:139], v[20:23], v[84:87], 0
    ds_read_b128 v[84:87], v1 offset:12288
    s_waitcnt lgkmcnt(6)
    v_mfma_f32_16x16x32_bf16 v[140:143], v[16:19], v[88:91], 0
    v_mfma_f32_16x16x32_bf16 v[144:147], v[20:23], v[88:91], 0
    ds_read_b128 v[88:91], v1 offset:13312
    s_add_u32 s21, s16, 6144
    buffer_load_dwordx4 v[16:19], v1, s[24:27], s21 offen
    s_add_u32 s21, s16, 24576
    buffer_load_dwordx4 v[20:23], v1, s[24:27], s21 offen
    s_waitcnt vmcnt(23)
    s_waitcnt lgkmcnt(6)
    v_mfma_f32_16x16x32_bf16 v[92:95], v[64:67], v[24:27], v[92:95]
    v_mfma_f32_16x16x32_bf16 v[96:99], v[64:67], v[28:31], v[96:99]
    ds_read_b128 v[64:67], v1 offset:14336
    s_waitcnt lgkmcnt(6)
    v_mfma_f32_16x16x32_bf16 v[100:103], v[68:71], v[24:27], v[100:103]
    v_mfma_f32_16x16x32_bf16 v[104:107], v[68:71], v[28:31], v[104:107]
    ds_read_b128 v[68:71], v1 offset:15360
    s_waitcnt lgkmcnt(6)
    v_mfma_f32_16x16x32_bf16 v[108:111], v[24:27], v[72:75], v[108:111]
    v_mfma_f32_16x16x32_bf16 v[112:115], v[28:31], v[72:75], v[112:115]
    ds_read_b128 v[72:75], v1 offset:16384
    s_waitcnt lgkmcnt(6)
    v_mfma_f32_16x16x32_bf16 v[116:119], v[24:27], v[76:79], v[116:119]
    v_mfma_f32_16x16x32_bf16 v[120:123], v[28:31], v[76:79], v[120:123]
    ds_read_b128 v[76:79], v1 offset:17408
    s_waitcnt lgkmcnt(6)
    v_mfma_f32_16x16x32_bf16 v[124:127], v[24:27], v[80:83], v[124:127]
    v_mfma_f32_16x16x32_bf16 v[128:131], v[28:31], v[80:83], v[128:131]
    ds_read_b128 v[80:83], v1 offset:18432
    s_waitcnt lgkmcnt(6)
    v_mfma_f32_16x16x32_bf16 v[132:135], v[24:27], v[84:87], v[132:135]
    v_mfma_f32_16x16x32_bf16 v[136:139], v[28:31], v[84:87], v[136:139]
    ds_read_b128 v[84:87], v1 offset:19456
    s_waitcnt lgkmcnt(6)
    v_mfma_f32_16x16x32_bf16 v[140:143], v[24:27], v[88:91], v[140:143]
    v_mfma_f32_16x16x32_bf16 v[144:147], v[28:31], v[88:91], v[144:147]
    ds_read_b128 v[88:91], v1 offset:20480
    s_add_u32 s21, s16, 7168
    buffer_load_dwordx4 v[24:27], v1, s[24:27], s21 offen
    s_add_u32 s21, s16, 25600
    buffer_load_dwordx4 v[28:31], v1, s[24:27], s21 offen
    s_waitcnt vmcnt(23)
    s_waitcnt lgkmcnt(6)
    v_mfma_f32_16x16x32_bf16 v[92:95], v[64:67], v[32:35], v[92:95]
    v_mfma_f32_16x16x32_bf16 v[96:99], v[64:67], v[36:39], v[96:99]
    ds_read_b128 v[64:67], v1 offset:21504
    s_waitcnt lgkmcnt(6)
    v_mfma_f32_16x16x32_bf16 v[100:103], v[68:71], v[32:35], v[100:103]
    v_mfma_f32_16x16x32_bf16 v[104:107], v[68:71], v[36:39], v[104:107]
    ds_read_b128 v[68:71], v1 offset:22528
    s_waitcnt lgkmcnt(6)
    v_mfma_f32_16x16x32_bf16 v[108:111], v[32:35], v[72:75], v[108:111]
    v_mfma_f32_16x16x32_bf16 v[112:115], v[36:39], v[72:75], v[112:115]
    ds_read_b128 v[72:75], v1 offset:23552
    s_waitcnt lgkmcnt(6)
    v_mfma_f32_16x16x32_bf16 v[116:119], v[32:35], v[76:79], v[116:119]
    v_mfma_f32_16x16x32_bf16 v[120:123], v[36:39], v[76:79], v[120:123]
    ds_read_b128 v[76:79], v1 offset:24576
    s_waitcnt lgkmcnt(6)
    v_mfma_f32_16x16x32_bf16 v[124:127], v[32:35], v[80:83], v[124:127]
    v_mfma_f32_16x16x32_bf16 v[128:131], v[36:39], v[80:83], v[128:131]
    ds_read_b128 v[80:83], v1 offset:25600
    s_waitcnt lgkmcnt(6)
    v_mfma_f32_16x16x32_bf16 v[132:135], v[32:35], v[84:87], v[132:135]
    v_mfma_f32_16x16x32_bf16 v[136:139], v[36:39], v[84:87], v[136:139]
    ds_read_b128 v[84:87], v1 offset:26624
    s_waitcnt lgkmcnt(6)
    v_mfma_f32_16x16x32_bf16 v[140:143], v[32:35], v[88:91], v[140:143]
    v_mfma_f32_16x16x32_bf16 v[144:147], v[36:39], v[88:91], v[144:147]
    ds_read_b128 v[88:91], v1 offset:27648
    s_add_u32 s21, s16, 8192
    buffer_load_dwordx4 v[32:35], v1, s[24:27], s21 offen
    s_add_u32 s21, s16, 26624
    buffer_load_dwordx4 v[36:39], v1, s[24:27], s21 offen
    s_waitcnt vmcnt(23)
    s_waitcnt lgkmcnt(6)
    v_mfma_f32_16x16x32_bf16 v[92:95], v[64:67], v[40:43], v[92:95]
    v_mfma_f32_16x16x32_bf16 v[96:99], v[64:67], v[44:47], v[96:99]
    s_waitcnt lgkmcnt(5)
    v_mfma_f32_16x16x32_bf16 v[100:103], v[68:71], v[40:43], v[100:103]
    v_mfma_f32_16x16x32_bf16 v[104:107], v[68:71], v[44:47], v[104:107]
    s_waitcnt lgkmcnt(4)
    v_mfma_f32_16x16x32_bf16 v[108:111], v[40:43], v[72:75], v[108:111]
    v_mfma_f32_16x16x32_bf16 v[112:115], v[44:47], v[72:75], v[112:115]
    s_waitcnt lgkmcnt(3)
    v_mfma_f32_16x16x32_bf16 v[116:119], v[40:43], v[76:79], v[116:119]
    v_mfma_f32_16x16x32_bf16 v[120:123], v[44:47], v[76:79], v[120:123]
    s_waitcnt lgkmcnt(2)
    v_mfma_f32_16x16x32_bf16 v[124:127], v[40:43], v[80:83], v[124:127]
    v_mfma_f32_16x16x32_bf16 v[128:131], v[44:47], v[80:83], v[128:131]
    s_waitcnt lgkmcnt(1)
    v_mfma_f32_16x16x32_bf16 v[132:135], v[40:43], v[84:87], v[132:135]
    v_mfma_f32_16x16x32_bf16 v[136:139], v[44:47], v[84:87], v[136:139]
    s_waitcnt lgkmcnt(0)
    v_mfma_f32_16x16x32_bf16 v[140:143], v[40:43], v[88:91], v[140:143]
    v_mfma_f32_16x16x32_bf16 v[144:147], v[44:47], v[88:91], v[144:147]
    s_add_u32 s21, s16, 9216
    buffer_load_dwordx4 v[40:43], v1, s[24:27], s21 offen
    s_add_u32 s21, s16, 27648
    buffer_load_dwordx4 v[44:47], v1, s[24:27], s21 offen
    s_barrier
    ds_read_b128 v[64:67], v1 offset:28672
    ds_read_b128 v[68:71], v1 offset:29696
    ds_read_b128 v[72:75], v1 offset:30720
    ds_read_b128 v[76:79], v1 offset:31744
    ds_read_b128 v[80:83], v1 offset:32768
    ds_read_b128 v[84:87], v1 offset:33792
    ds_read_b128 v[88:91], v1 offset:34816
    s_waitcnt vmcnt(23)
    s_waitcnt lgkmcnt(6)
    v_mfma_f32_16x16x32_bf16 v[92:95], v[64:67], v[48:51], v[92:95]
    v_mfma_f32_16x16x32_bf16 v[96:99], v[64:67], v[52:55], v[96:99]
    ds_read_b128 v[64:67], v1 offset:35840
    s_waitcnt lgkmcnt(6)
    v_mfma_f32_16x16x32_bf16 v[100:103], v[68:71], v[48:51], v[100:103]
    v_mfma_f32_16x16x32_bf16 v[104:107], v[68:71], v[52:55], v[104:107]
    ds_read_b128 v[68:71], v1 offset:36864
    s_waitcnt lgkmcnt(6)
    v_mfma_f32_16x16x32_bf16 v[108:111], v[48:51], v[72:75], v[108:111]
    v_mfma_f32_16x16x32_bf16 v[112:115], v[52:55], v[72:75], v[112:115]
    ds_read_b128 v[72:75], v1 offset:37888
    s_waitcnt lgkmcnt(6)
    v_mfma_f32_16x16x32_bf16 v[116:119], v[48:51], v[76:79], v[116:119]
    v_mfma_f32_16x16x32_bf16 v[120:123], v[52:55], v[76:79], v[120:123]
    ds_read_b128 v[76:79], v1 offset:38912
    s_waitcnt lgkmcnt(6)
    v_mfma_f32_16x16x32_bf16 v[124:127], v[48:51], v[80:83], v[124:127]
    v_mfma_f32_16x16x32_bf16 v[128:131], v[52:55], v[80:83], v[128:131]
    ds_read_b128 v[80:83], v1 offset:39936
    s_waitcnt lgkmcnt(6)
    v_mfma_f32_16x16x32_bf16 v[132:135], v[48:51], v[84:87], v[132:135]
    v_mfma_f32_16x16x32_bf16 v[136:139], v[52:55], v[84:87], v[136:139]
    ds_read_b128 v[84:87], v1 offset:40960
    s_waitcnt lgkmcnt(6)
    v_mfma_f32_16x16x32_bf16 v[140:143], v[48:51], v[88:91], v[140:143]
    v_mfma_f32_16x16x32_bf16 v[144:147], v[52:55], v[88:91], v[144:147]
    ds_read_b128 v[88:91], v1 offset:41984
    s_add_u32 s21, s16, 10240
    buffer_load_dwordx4 v[48:51], v1, s[24:27], s21 offen
    s_add_u32 s21, s16, 28672
    buffer_load_dwordx4 v[52:55], v1, s[24:27], s21 offen
    s_waitcnt vmcnt(23)
    s_waitcnt lgkmcnt(6)
    v_mfma_f32_16x16x32_bf16 v[92:95], v[64:67], v[56:59], v[92:95]
    v_mfma_f32_16x16x32_bf16 v[96:99], v[64:67], v[60:63], v[96:99]
    ds_read_b128 v[64:67], v1 offset:43008
    s_waitcnt lgkmcnt(6)
    v_mfma_f32_16x16x32_bf16 v[100:103], v[68:71], v[56:59], v[100:103]
    v_mfma_f32_16x16x32_bf16 v[104:107], v[68:71], v[60:63], v[104:107]
    ds_read_b128 v[68:71], v1 offset:44032
    s_waitcnt lgkmcnt(6)
    v_mfma_f32_16x16x32_bf16 v[108:111], v[56:59], v[72:75], v[108:111]
    v_mfma_f32_16x16x32_bf16 v[112:115], v[60:63], v[72:75], v[112:115]
    ds_read_b128 v[72:75], v1 offset:45056
    s_waitcnt lgkmcnt(6)
    v_mfma_f32_16x16x32_bf16 v[116:119], v[56:59], v[76:79], v[116:119]
    v_mfma_f32_16x16x32_bf16 v[120:123], v[60:63], v[76:79], v[120:123]
    ds_read_b128 v[76:79], v1 offset:46080
    s_waitcnt lgkmcnt(6)
    v_mfma_f32_16x16x32_bf16 v[124:127], v[56:59], v[80:83], v[124:127]
    v_mfma_f32_16x16x32_bf16 v[128:131], v[60:63], v[80:83], v[128:131]
    ds_read_b128 v[80:83], v1 offset:47104
    s_waitcnt lgkmcnt(6)
    v_mfma_f32_16x16x32_bf16 v[132:135], v[56:59], v[84:87], v[132:135]
    v_mfma_f32_16x16x32_bf16 v[136:139], v[60:63], v[84:87], v[136:139]
    ds_read_b128 v[84:87], v1 offset:48128
    s_waitcnt lgkmcnt(6)
    v_mfma_f32_16x16x32_bf16 v[140:143], v[56:59], v[88:91], v[140:143]
    v_mfma_f32_16x16x32_bf16 v[144:147], v[60:63], v[88:91], v[144:147]
    ds_read_b128 v[88:91], v1 offset:49152
    s_add_u32 s21, s16, 11264
    buffer_load_dwordx4 v[56:59], v1, s[24:27], s21 offen
    s_add_u32 s21, s16, 29696
    buffer_load_dwordx4 v[60:63], v1, s[24:27], s21 offen
    s_waitcnt vmcnt(10)
    s_waitcnt lgkmcnt(6)
    v_mfma_f32_16x16x32_bf16 v[92:95], v[64:67], v[16:19], v[92:95]
    v_mfma_f32_16x16x32_bf16 v[96:99], v[64:67], v[20:23], v[96:99]
    ds_read_b128 v[64:67], v1 offset:50176
    s_waitcnt lgkmcnt(6)
    v_mfma_f32_16x16x32_bf16 v[100:103], v[68:71], v[16:19], v[100:103]
    v_mfma_f32_16x16x32_bf16 v[104:107], v[68:71], v[20:23], v[104:107]
    ds_read_b128 v[68:71], v1 offset:51200
    s_waitcnt lgkmcnt(6)
    v_mfma_f32_16x16x32_bf16 v[108:111], v[16:19], v[72:75], v[108:111]
    v_mfma_f32_16x16x32_bf16 v[112:115], v[20:23], v[72:75], v[112:115]
    ds_read_b128 v[72:75], v1 offset:52224
    s_waitcnt lgkmcnt(6)
    v_mfma_f32_16x16x32_bf16 v[116:119], v[16:19], v[76:79], v[116:119]
    v_mfma_f32_16x16x32_bf16 v[120:123], v[20:23], v[76:79], v[120:123]
    ds_read_b128 v[76:79], v1 offset:53248
    s_waitcnt lgkmcnt(6)
    v_mfma_f32_16x16x32_bf16 v[124:127], v[16:19], v[80:83], v[124:127]
    v_mfma_f32_16x16x32_bf16 v[128:131], v[20:23], v[80:83], v[128:131]
    ds_read_b128 v[80:83], v1 offset:54272
    s_waitcnt lgkmcnt(6)
    v_mfma_f32_16x16x32_bf16 v[132:135], v[16:19], v[84:87], v[132:135]
    v_mfma_f32_16x16x32_bf16 v[136:139], v[20:23], v[84:87], v[136:139]
    ds_read_b128 v[84:87], v1 offset:55296
    s_waitcnt lgkmcnt(6)
    v_mfma_f32_16x16x32_bf16 v[140:143], v[16:19], v[88:91], v[140:143]
    v_mfma_f32_16x16x32_bf16 v[144:147], v[20:23], v[88:91], v[144:147]
    ds_read_b128 v[88:91], v1 offset:56320
    s_add_u32 s21, s16, 12288
    buffer_load_dwordx4 v[16:19], v1, s[24:27], s21 offen
    s_add_u32 s21, s16, 30720
    buffer_load_dwordx4 v[20:23], v1, s[24:27], s21 offen
    s_waitcnt vmcnt(10)
    s_waitcnt lgkmcnt(6)
    v_mfma_f32_16x16x32_bf16 v[92:95], v[64:67], v[24:27], v[92:95]
    v_mfma_f32_16x16x32_bf16 v[96:99], v[64:67], v[28:31], v[96:99]
    s_waitcnt lgkmcnt(5)
    v_mfma_f32_16x16x32_bf16 v[100:103], v[68:71], v[24:27], v[100:103]
    v_mfma_f32_16x16x32_bf16 v[104:107], v[68:71], v[28:31], v[104:107]
    s_waitcnt lgkmcnt(4)
    v_mfma_f32_16x16x32_bf16 v[108:111], v[24:27], v[72:75], v[108:111]
    v_mfma_f32_16x16x32_bf16 v[112:115], v[28:31], v[72:75], v[112:115]
    s_waitcnt lgkmcnt(3)
    v_mfma_f32_16x16x32_bf16 v[116:119], v[24:27], v[76:79], v[116:119]
    v_mfma_f32_16x16x32_bf16 v[120:123], v[28:31], v[76:79], v[120:123]
    s_waitcnt lgkmcnt(2)
    v_mfma_f32_16x16x32_bf16 v[124:127], v[24:27], v[80:83], v[124:127]
    v_mfma_f32_16x16x32_bf16 v[128:131], v[28:31], v[80:83], v[128:131]
    s_waitcnt lgkmcnt(1)
    v_mfma_f32_16x16x32_bf16 v[132:135], v[24:27], v[84:87], v[132:135]
    v_mfma_f32_16x16x32_bf16 v[136:139], v[28:31], v[84:87], v[136:139]
    s_waitcnt lgkmcnt(0)
    v_mfma_f32_16x16x32_bf16 v[140:143], v[24:27], v[88:91], v[140:143]
    v_mfma_f32_16x16x32_bf16 v[144:147], v[28:31], v[88:91], v[144:147]
    s_add_u32 s21, s16, 13312
    buffer_load_dwordx4 v[24:27], v1, s[24:27], s21 offen
    s_add_u32 s21, s16, 31744
    buffer_load_dwordx4 v[28:31], v1, s[24:27], s21 offen
    s_barrier
    ds_read_b128 v[64:67], v1 offset:57344
    ds_read_b128 v[68:71], v1 offset:58368
    ds_read_b128 v[72:75], v1 offset:59392
    ds_read_b128 v[76:79], v1 offset:60416
    ds_read_b128 v[80:83], v1 offset:61440
    ds_read_b128 v[84:87], v1 offset:62464
    ds_read_b128 v[88:91], v1 offset:63488
    s_waitcnt vmcnt(10)
    s_waitcnt lgkmcnt(6)
    v_mfma_f32_16x16x32_bf16 v[92:95], v[64:67], v[32:35], v[92:95]
    v_mfma_f32_16x16x32_bf16 v[96:99], v[64:67], v[36:39], v[96:99]
    ds_read_b128 v[64:67], v1 offset:64512
    s_waitcnt lgkmcnt(6)
    v_mfma_f32_16x16x32_bf16 v[100:103], v[68:71], v[32:35], v[100:103]
    v_mfma_f32_16x16x32_bf16 v[104:107], v[68:71], v[36:39], v[104:107]
    ds_read_b128 v[68:71], v2 offset:0
    s_waitcnt lgkmcnt(6)
    v_mfma_f32_16x16x32_bf16 v[108:111], v[32:35], v[72:75], v[108:111]
    v_mfma_f32_16x16x32_bf16 v[112:115], v[36:39], v[72:75], v[112:115]
    ds_read_b128 v[72:75], v2 offset:1024
    s_waitcnt lgkmcnt(6)
    v_mfma_f32_16x16x32_bf16 v[116:119], v[32:35], v[76:79], v[116:119]
    v_mfma_f32_16x16x32_bf16 v[120:123], v[36:39], v[76:79], v[120:123]
    ds_read_b128 v[76:79], v2 offset:2048
    s_waitcnt lgkmcnt(6)
    v_mfma_f32_16x16x32_bf16 v[124:127], v[32:35], v[80:83], v[124:127]
    v_mfma_f32_16x16x32_bf16 v[128:131], v[36:39], v[80:83], v[128:131]
    ds_read_b128 v[80:83], v2 offset:3072
    s_waitcnt lgkmcnt(6)
    v_mfma_f32_16x16x32_bf16 v[132:135], v[32:35], v[84:87], v[132:135]
    v_mfma_f32_16x16x32_bf16 v[136:139], v[36:39], v[84:87], v[136:139]
    ds_read_b128 v[84:87], v2 offset:4096
    s_waitcnt lgkmcnt(6)
    v_mfma_f32_16x16x32_bf16 v[140:143], v[32:35], v[88:91], v[140:143]
    v_mfma_f32_16x16x32_bf16 v[144:147], v[36:39], v[88:91], v[144:147]
    ds_read_b128 v[88:91], v2 offset:5120
    s_add_u32 s21, s16, 14336
    buffer_load_dwordx4 v[32:35], v1, s[24:27], s21 offen
    s_add_u32 s21, s16, 32768
    buffer_load_dwordx4 v[36:39], v1, s[24:27], s21 offen
    s_waitcnt vmcnt(10)
    s_waitcnt lgkmcnt(6)
    v_mfma_f32_16x16x32_bf16 v[92:95], v[64:67], v[40:43], v[92:95]
    v_mfma_f32_16x16x32_bf16 v[96:99], v[64:67], v[44:47], v[96:99]
    ds_read_b128 v[64:67], v2 offset:6144
    s_waitcnt lgkmcnt(6)
    v_mfma_f32_16x16x32_bf16 v[100:103], v[68:71], v[40:43], v[100:103]
    v_mfma_f32_16x16x32_bf16 v[104:107], v[68:71], v[44:47], v[104:107]
    ds_read_b128 v[68:71], v2 offset:7168
    s_waitcnt lgkmcnt(6)
    v_mfma_f32_16x16x32_bf16 v[108:111], v[40:43], v[72:75], v[108:111]
    v_mfma_f32_16x16x32_bf16 v[112:115], v[44:47], v[72:75], v[112:115]
    ds_read_b128 v[72:75], v2 offset:8192
    s_waitcnt lgkmcnt(6)
    v_mfma_f32_16x16x32_bf16 v[116:119], v[40:43], v[76:79], v[116:119]
    v_mfma_f32_16x16x32_bf16 v[120:123], v[44:47], v[76:79], v[120:123]
    ds_read_b128 v[76:79], v2 offset:9216
    s_waitcnt lgkmcnt(6)
    v_mfma_f32_16x16x32_bf16 v[124:127], v[40:43], v[80:83], v[124:127]
    v_mfma_f32_16x16x32_bf16 v[128:131], v[44:47], v[80:83], v[128:131]
    ds_read_b128 v[80:83], v2 offset:10240
    s_waitcnt lgkmcnt(6)
    v_mfma_f32_16x16x32_bf16 v[132:135], v[40:43], v[84:87], v[132:135]
    v_mfma_f32_16x16x32_bf16 v[136:139], v[44:47], v[84:87], v[136:139]
    ds_read_b128 v[84:87], v2 offset:11264
    s_waitcnt lgkmcnt(6)
    v_mfma_f32_16x16x32_bf16 v[140:143], v[40:43], v[88:91], v[140:143]
    v_mfma_f32_16x16x32_bf16 v[144:147], v[44:47], v[88:91], v[144:147]
    ds_read_b128 v[88:91], v2 offset:12288
    s_add_u32 s21, s16, 15360
    buffer_load_dwordx4 v[40:43], v1, s[24:27], s21 offen
    s_add_u32 s21, s16, 33792
    buffer_load_dwordx4 v[44:47], v1, s[24:27], s21 offen
    s_waitcnt vmcnt(10)
    s_waitcnt lgkmcnt(6)
    v_mfma_f32_16x16x32_bf16 v[92:95], v[64:67], v[48:51], v[92:95]
    v_mfma_f32_16x16x32_bf16 v[96:99], v[64:67], v[52:55], v[96:99]
    ds_read_b128 v[64:67], v2 offset:13312
    s_waitcnt lgkmcnt(6)
    v_mfma_f32_16x16x32_bf16 v[100:103], v[68:71], v[48:51], v[100:103]
    v_mfma_f32_16x16x32_bf16 v[104:107], v[68:71], v[52:55], v[104:107]
    ds_read_b128 v[68:71], v2 offset:14336
    s_waitcnt lgkmcnt(6)
    v_mfma_f32_16x16x32_bf16 v[108:111], v[48:51], v[72:75], v[108:111]
    v_mfma_f32_16x16x32_bf16 v[112:115], v[52:55], v[72:75], v[112:115]
    ds_read_b128 v[72:75], v2 offset:15360
    s_waitcnt lgkmcnt(6)
    v_mfma_f32_16x16x32_bf16 v[116:119], v[48:51], v[76:79], v[116:119]
    v_mfma_f32_16x16x32_bf16 v[120:123], v[52:55], v[76:79], v[120:123]
    ds_read_b128 v[76:79], v2 offset:16384
    s_waitcnt lgkmcnt(6)
    v_mfma_f32_16x16x32_bf16 v[124:127], v[48:51], v[80:83], v[124:127]
    v_mfma_f32_16x16x32_bf16 v[128:131], v[52:55], v[80:83], v[128:131]
    ds_read_b128 v[80:83], v2 offset:17408
    s_waitcnt lgkmcnt(6)
    v_mfma_f32_16x16x32_bf16 v[132:135], v[48:51], v[84:87], v[132:135]
    v_mfma_f32_16x16x32_bf16 v[136:139], v[52:55], v[84:87], v[136:139]
    ds_read_b128 v[84:87], v2 offset:18432
    s_waitcnt lgkmcnt(6)
    v_mfma_f32_16x16x32_bf16 v[140:143], v[48:51], v[88:91], v[140:143]
    v_mfma_f32_16x16x32_bf16 v[144:147], v[52:55], v[88:91], v[144:147]
    ds_read_b128 v[88:91], v2 offset:19456
    s_add_u32 s21, s16, 16384
    buffer_load_dwordx4 v[48:51], v1, s[24:27], s21 offen
    s_add_u32 s21, s16, 34816
    buffer_load_dwordx4 v[52:55], v1, s[24:27], s21 offen
    s_waitcnt vmcnt(10)
    s_waitcnt lgkmcnt(6)
    v_mfma_f32_16x16x32_bf16 v[92:95], v[64:67], v[56:59], v[92:95]
    v_mfma_f32_16x16x32_bf16 v[96:99], v[64:67], v[60:63], v[96:99]
    s_waitcnt lgkmcnt(5)
    v_mfma_f32_16x16x32_bf16 v[100:103], v[68:71], v[56:59], v[100:103]
    v_mfma_f32_16x16x32_bf16 v[104:107], v[68:71], v[60:63], v[104:107]
    s_waitcnt lgkmcnt(4)
    v_mfma_f32_16x16x32_bf16 v[108:111], v[56:59], v[72:75], v[108:111]
    v_mfma_f32_16x16x32_bf16 v[112:115], v[60:63], v[72:75], v[112:115]
    s_waitcnt lgkmcnt(3)
    v_mfma_f32_16x16x32_bf16 v[116:119], v[56:59], v[76:79], v[116:119]
    v_mfma_f32_16x16x32_bf16 v[120:123], v[60:63], v[76:79], v[120:123]
    s_waitcnt lgkmcnt(2)
    v_mfma_f32_16x16x32_bf16 v[124:127], v[56:59], v[80:83], v[124:127]
    v_mfma_f32_16x16x32_bf16 v[128:131], v[60:63], v[80:83], v[128:131]
    s_waitcnt lgkmcnt(1)
    v_mfma_f32_16x16x32_bf16 v[132:135], v[56:59], v[84:87], v[132:135]
    v_mfma_f32_16x16x32_bf16 v[136:139], v[60:63], v[84:87], v[136:139]
    s_waitcnt lgkmcnt(0)
    v_mfma_f32_16x16x32_bf16 v[140:143], v[56:59], v[88:91], v[140:143]
    v_mfma_f32_16x16x32_bf16 v[144:147], v[60:63], v[88:91], v[144:147]
    s_add_u32 s21, s16, 17408
    buffer_load_dwordx4 v[56:59], v1, s[24:27], s21 offen
    s_add_u32 s21, s16, 35840
    buffer_load_dwordx4 v[60:63], v1, s[24:27], s21 offen
    s_barrier
    ds_read_b128 v[64:67], v2 offset:20480
    ds_read_b128 v[68:71], v2 offset:21504
    ds_read_b128 v[72:75], v2 offset:22528
    ds_read_b128 v[76:79], v2 offset:23552
    ds_read_b128 v[80:83], v2 offset:24576
    ds_read_b128 v[84:87], v2 offset:25600
    ds_read_b128 v[88:91], v2 offset:26624
    s_waitcnt vmcnt(10)
    s_waitcnt lgkmcnt(6)
    v_mfma_f32_16x16x32_bf16 v[92:95], v[64:67], v[16:19], v[92:95]
    v_mfma_f32_16x16x32_bf16 v[96:99], v[64:67], v[20:23], v[96:99]
    ds_read_b128 v[64:67], v2 offset:27648
    s_waitcnt lgkmcnt(6)
    v_mfma_f32_16x16x32_bf16 v[100:103], v[68:71], v[16:19], v[100:103]
    v_mfma_f32_16x16x32_bf16 v[104:107], v[68:71], v[20:23], v[104:107]
    ds_read_b128 v[68:71], v2 offset:28672
    s_waitcnt lgkmcnt(6)
    v_mfma_f32_16x16x32_bf16 v[108:111], v[16:19], v[72:75], v[108:111]
    v_mfma_f32_16x16x32_bf16 v[112:115], v[20:23], v[72:75], v[112:115]
    ds_read_b128 v[72:75], v2 offset:29696
    s_waitcnt lgkmcnt(6)
    v_mfma_f32_16x16x32_bf16 v[116:119], v[16:19], v[76:79], v[116:119]
    v_mfma_f32_16x16x32_bf16 v[120:123], v[20:23], v[76:79], v[120:123]
    ds_read_b128 v[76:79], v2 offset:30720
    s_waitcnt lgkmcnt(6)
    v_mfma_f32_16x16x32_bf16 v[124:127], v[16:19], v[80:83], v[124:127]
    v_mfma_f32_16x16x32_bf16 v[128:131], v[20:23], v[80:83], v[128:131]
    ds_read_b128 v[80:83], v2 offset:31744
    s_waitcnt lgkmcnt(6)
    v_mfma_f32_16x16x32_bf16 v[132:135], v[16:19], v[84:87], v[132:135]
    v_mfma_f32_16x16x32_bf16 v[136:139], v[20:23], v[84:87], v[136:139]
    ds_read_b128 v[84:87], v2 offset:32768
    s_waitcnt lgkmcnt(6)
    v_mfma_f32_16x16x32_bf16 v[140:143], v[16:19], v[88:91], v[140:143]
    v_mfma_f32_16x16x32_bf16 v[144:147], v[20:23], v[88:91], v[144:147]
    ds_read_b128 v[88:91], v2 offset:33792
    s_waitcnt vmcnt(8)
    s_waitcnt lgkmcnt(6)
    v_mfma_f32_16x16x32_bf16 v[92:95], v[64:67], v[24:27], v[92:95]
    v_mfma_f32_16x16x32_bf16 v[96:99], v[64:67], v[28:31], v[96:99]
    ds_read_b128 v[64:67], v2 offset:34816
    s_waitcnt lgkmcnt(6)
    v_mfma_f32_16x16x32_bf16 v[100:103], v[68:71], v[24:27], v[100:103]
    v_mfma_f32_16x16x32_bf16 v[104:107], v[68:71], v[28:31], v[104:107]
    ds_read_b128 v[68:71], v2 offset:35840
    s_waitcnt lgkmcnt(6)
    v_mfma_f32_16x16x32_bf16 v[108:111], v[24:27], v[72:75], v[108:111]
    v_mfma_f32_16x16x32_bf16 v[112:115], v[28:31], v[72:75], v[112:115]
    ds_read_b128 v[72:75], v2 offset:36864
    s_waitcnt lgkmcnt(6)
    v_mfma_f32_16x16x32_bf16 v[116:119], v[24:27], v[76:79], v[116:119]
    v_mfma_f32_16x16x32_bf16 v[120:123], v[28:31], v[76:79], v[120:123]
    ds_read_b128 v[76:79], v2 offset:37888
    s_waitcnt lgkmcnt(6)
    v_mfma_f32_16x16x32_bf16 v[124:127], v[24:27], v[80:83], v[124:127]
    v_mfma_f32_16x16x32_bf16 v[128:131], v[28:31], v[80:83], v[128:131]
    ds_read_b128 v[80:83], v2 offset:38912
    s_waitcnt lgkmcnt(6)
    v_mfma_f32_16x16x32_bf16 v[132:135], v[24:27], v[84:87], v[132:135]
    v_mfma_f32_16x16x32_bf16 v[136:139], v[28:31], v[84:87], v[136:139]
    ds_read_b128 v[84:87], v2 offset:39936
    s_waitcnt lgkmcnt(6)
    v_mfma_f32_16x16x32_bf16 v[140:143], v[24:27], v[88:91], v[140:143]
    v_mfma_f32_16x16x32_bf16 v[144:147], v[28:31], v[88:91], v[144:147]
    ds_read_b128 v[88:91], v2 offset:40960
    s_waitcnt vmcnt(6)
    s_waitcnt lgkmcnt(6)
    v_mfma_f32_16x16x32_bf16 v[92:95], v[64:67], v[32:35], v[92:95]
    v_mfma_f32_16x16x32_bf16 v[96:99], v[64:67], v[36:39], v[96:99]
    ds_read_b128 v[64:67], v2 offset:41984
    s_waitcnt lgkmcnt(6)
    v_mfma_f32_16x16x32_bf16 v[100:103], v[68:71], v[32:35], v[100:103]
    v_mfma_f32_16x16x32_bf16 v[104:107], v[68:71], v[36:39], v[104:107]
    ds_read_b128 v[68:71], v2 offset:43008
    s_waitcnt lgkmcnt(6)
    v_mfma_f32_16x16x32_bf16 v[108:111], v[32:35], v[72:75], v[108:111]
    v_mfma_f32_16x16x32_bf16 v[112:115], v[36:39], v[72:75], v[112:115]
    ds_read_b128 v[72:75], v2 offset:44032
    s_waitcnt lgkmcnt(6)
    v_mfma_f32_16x16x32_bf16 v[116:119], v[32:35], v[76:79], v[116:119]
    v_mfma_f32_16x16x32_bf16 v[120:123], v[36:39], v[76:79], v[120:123]
    ds_read_b128 v[76:79], v2 offset:45056
    s_waitcnt lgkmcnt(6)
    v_mfma_f32_16x16x32_bf16 v[124:127], v[32:35], v[80:83], v[124:127]
    v_mfma_f32_16x16x32_bf16 v[128:131], v[36:39], v[80:83], v[128:131]
    ds_read_b128 v[80:83], v2 offset:46080
    s_waitcnt lgkmcnt(6)
    v_mfma_f32_16x16x32_bf16 v[132:135], v[32:35], v[84:87], v[132:135]
    v_mfma_f32_16x16x32_bf16 v[136:139], v[36:39], v[84:87], v[136:139]
    ds_read_b128 v[84:87], v2 offset:47104
    s_waitcnt lgkmcnt(6)
    v_mfma_f32_16x16x32_bf16 v[140:143], v[32:35], v[88:91], v[140:143]
    v_mfma_f32_16x16x32_bf16 v[144:147], v[36:39], v[88:91], v[144:147]
    ds_read_b128 v[88:91], v2 offset:48128
    s_waitcnt vmcnt(4)
    s_waitcnt lgkmcnt(6)
    v_mfma_f32_16x16x32_bf16 v[92:95], v[64:67], v[40:43], v[92:95]
    v_mfma_f32_16x16x32_bf16 v[96:99], v[64:67], v[44:47], v[96:99]
    s_waitcnt lgkmcnt(5)
    v_mfma_f32_16x16x32_bf16 v[100:103], v[68:71], v[40:43], v[100:103]
    v_mfma_f32_16x16x32_bf16 v[104:107], v[68:71], v[44:47], v[104:107]
    s_waitcnt lgkmcnt(4)
    v_mfma_f32_16x16x32_bf16 v[108:111], v[40:43], v[72:75], v[108:111]
    v_mfma_f32_16x16x32_bf16 v[112:115], v[44:47], v[72:75], v[112:115]
    s_waitcnt lgkmcnt(3)
    v_mfma_f32_16x16x32_bf16 v[116:119], v[40:43], v[76:79], v[116:119]
    v_mfma_f32_16x16x32_bf16 v[120:123], v[44:47], v[76:79], v[120:123]
    s_waitcnt lgkmcnt(2)
    v_mfma_f32_16x16x32_bf16 v[124:127], v[40:43], v[80:83], v[124:127]
    v_mfma_f32_16x16x32_bf16 v[128:131], v[44:47], v[80:83], v[128:131]
    s_waitcnt lgkmcnt(1)
    v_mfma_f32_16x16x32_bf16 v[132:135], v[40:43], v[84:87], v[132:135]
    v_mfma_f32_16x16x32_bf16 v[136:139], v[44:47], v[84:87], v[136:139]
    s_waitcnt lgkmcnt(0)
    v_mfma_f32_16x16x32_bf16 v[140:143], v[40:43], v[88:91], v[140:143]
    v_mfma_f32_16x16x32_bf16 v[144:147], v[44:47], v[88:91], v[144:147]
    s_barrier
    ds_read_b128 v[64:67], v2 offset:49152
    ds_read_b128 v[68:71], v2 offset:50176
    ds_read_b128 v[72:75], v2 offset:51200
    ds_read_b128 v[76:79], v2 offset:52224
    ds_read_b128 v[80:83], v2 offset:53248
    ds_read_b128 v[84:87], v2 offset:54272
    ds_read_b128 v[88:91], v2 offset:55296
    s_waitcnt vmcnt(2)
    s_waitcnt lgkmcnt(6)
    v_mfma_f32_16x16x32_bf16 v[92:95], v[64:67], v[48:51], v[92:95]
    v_mfma_f32_16x16x32_bf16 v[96:99], v[64:67], v[52:55], v[96:99]
    ds_read_b128 v[64:67], v2 offset:56320
    s_waitcnt lgkmcnt(6)
    v_mfma_f32_16x16x32_bf16 v[100:103], v[68:71], v[48:51], v[100:103]
    v_mfma_f32_16x16x32_bf16 v[104:107], v[68:71], v[52:55], v[104:107]
    ds_read_b128 v[68:71], v2 offset:57344
    s_waitcnt lgkmcnt(6)
    v_mfma_f32_16x16x32_bf16 v[108:111], v[48:51], v[72:75], v[108:111]
    v_mfma_f32_16x16x32_bf16 v[112:115], v[52:55], v[72:75], v[112:115]
    ds_read_b128 v[72:75], v2 offset:58368
    s_waitcnt lgkmcnt(6)
    v_mfma_f32_16x16x32_bf16 v[116:119], v[48:51], v[76:79], v[116:119]
    v_mfma_f32_16x16x32_bf16 v[120:123], v[52:55], v[76:79], v[120:123]
    ds_read_b128 v[76:79], v2 offset:59392
    s_waitcnt lgkmcnt(6)
    v_mfma_f32_16x16x32_bf16 v[124:127], v[48:51], v[80:83], v[124:127]
    v_mfma_f32_16x16x32_bf16 v[128:131], v[52:55], v[80:83], v[128:131]
    ds_read_b128 v[80:83], v2 offset:60416
    s_waitcnt lgkmcnt(6)
    v_mfma_f32_16x16x32_bf16 v[132:135], v[48:51], v[84:87], v[132:135]
    v_mfma_f32_16x16x32_bf16 v[136:139], v[52:55], v[84:87], v[136:139]
    ds_read_b128 v[84:87], v2 offset:61440
    s_waitcnt lgkmcnt(6)
    v_mfma_f32_16x16x32_bf16 v[140:143], v[48:51], v[88:91], v[140:143]
    v_mfma_f32_16x16x32_bf16 v[144:147], v[52:55], v[88:91], v[144:147]
    ds_read_b128 v[88:91], v2 offset:62464
    s_waitcnt vmcnt(0)
    s_waitcnt lgkmcnt(6)
    v_mfma_f32_16x16x32_bf16 v[92:95], v[64:67], v[56:59], v[92:95]
    v_mfma_f32_16x16x32_bf16 v[96:99], v[64:67], v[60:63], v[96:99]
    s_waitcnt lgkmcnt(5)
    v_mfma_f32_16x16x32_bf16 v[100:103], v[68:71], v[56:59], v[100:103]
    v_mfma_f32_16x16x32_bf16 v[104:107], v[68:71], v[60:63], v[104:107]
    s_waitcnt lgkmcnt(4)
    v_mfma_f32_16x16x32_bf16 v[108:111], v[56:59], v[72:75], v[108:111]
    v_mfma_f32_16x16x32_bf16 v[112:115], v[60:63], v[72:75], v[112:115]
    s_waitcnt lgkmcnt(3)
    v_mfma_f32_16x16x32_bf16 v[116:119], v[56:59], v[76:79], v[116:119]
    v_mfma_f32_16x16x32_bf16 v[120:123], v[60:63], v[76:79], v[120:123]
    s_waitcnt lgkmcnt(2)
    v_mfma_f32_16x16x32_bf16 v[124:127], v[56:59], v[80:83], v[124:127]
    v_mfma_f32_16x16x32_bf16 v[128:131], v[60:63], v[80:83], v[128:131]
    s_waitcnt lgkmcnt(1)
    v_mfma_f32_16x16x32_bf16 v[132:135], v[56:59], v[84:87], v[132:135]
    v_mfma_f32_16x16x32_bf16 v[136:139], v[60:63], v[84:87], v[136:139]
    s_waitcnt lgkmcnt(0)
    v_mfma_f32_16x16x32_bf16 v[140:143], v[56:59], v[88:91], v[140:143]
    v_mfma_f32_16x16x32_bf16 v[144:147], v[60:63], v[88:91], v[144:147]
    s_nop 7
    v_cmp_gt_u32 s[38:39], 8, v13
    v_mul_f32 v108, v224, v108
    v_mul_f32 v109, v225, v109
    v_mul_f32 v110, v226, v110
    v_mul_f32 v111, v227, v111
    v_mul_f32 v112, v228, v112
    v_mul_f32 v113, v229, v113
    v_mul_f32 v114, v230, v114
    v_mul_f32 v115, v231, v115
    v_fma_f32 v108, v232, v156, v108
    v_fma_f32 v109, v233, v156, v109
    v_fma_f32 v110, v234, v156, v110
    v_fma_f32 v111, v235, v156, v111
    v_fma_f32 v112, v236, v156, v112
    v_fma_f32 v113, v237, v156, v113
    v_fma_f32 v114, v238, v156, v114
    v_fma_f32 v115, v239, v156, v115
    v_mul_f32 v64, s35, v108
    v_mul_f32 v65, s35, v109
    v_mul_f32 v66, s35, v110
    v_mul_f32 v67, s35, v111
    v_mul_f32 v68, s35, v112
    v_mul_f32 v69, s35, v113
    v_mul_f32 v70, s35, v114
    v_mul_f32 v71, s35, v115
    v_min_f32 v64, 0, v64
    v_min_f32 v65, 0, v65
    v_min_f32 v66, 0, v66
    v_min_f32 v67, 0, v67
    v_min_f32 v68, 0, v68
    v_min_f32 v69, 0, v69
    v_min_f32 v70, 0, v70
    v_min_f32 v71, 0, v71
    v_exp_f32 v64, v64
    v_exp_f32 v65, v65
    v_exp_f32 v66, v66
    v_exp_f32 v67, v67
    v_exp_f32 v68, v68
    v_exp_f32 v69, v69
    v_exp_f32 v70, v70
    v_exp_f32 v71, v71
    v_max_f32 v72, 0, v108
    v_max_f32 v73, 0, v109
    v_max_f32 v74, 0, v110
    v_max_f32 v75, 0, v111
    v_max_f32 v76, 0, v112
    v_max_f32 v77, 0, v113
    v_max_f32 v78, 0, v114
    v_max_f32 v79, 0, v115
    v_add_f32 v64, v64, v72
    v_add_f32 v65, v65, v73
    v_add_f32 v66, v66, v74
    v_add_f32 v67, v67, v75
    v_add_f32 v68, v68, v76
    v_add_f32 v69, v69, v77
    v_add_f32 v70, v70, v78
    v_add_f32 v71, v71, v79
    v_add_f32 v108, s36, v64
    v_add_f32 v109, s36, v65
    v_add_f32 v110, s36, v66
    v_add_f32 v111, s36, v67
    v_add_f32 v112, s36, v68
    v_add_f32 v113, s36, v69
    v_add_f32 v114, s36, v70
    v_add_f32 v115, s36, v71
    v_cvt_pk_bf16_f32 v40, v108, v109
    v_cvt_pk_bf16_f32 v41, v110, v111
    v_cvt_pk_bf16_f32 v42, v112, v113
    v_cvt_pk_bf16_f32 v43, v114, v115
    v_mul_f32 v116, v224, v116
    v_mul_f32 v117, v225, v117
    v_mul_f32 v118, v226, v118
    v_mul_f32 v119, v227, v119
    v_mul_f32 v120, v228, v120
    v_mul_f32 v121, v229, v121
    v_mul_f32 v122, v230, v122
    v_mul_f32 v123, v231, v123
    v_fma_f32 v116, v232, v160, v116
    v_fma_f32 v117, v233, v160, v117
    v_fma_f32 v118, v234, v160, v118
    v_fma_f32 v119, v235, v160, v119
    v_fma_f32 v120, v236, v160, v120
    v_fma_f32 v121, v237, v160, v121
    v_fma_f32 v122, v238, v160, v122
    v_fma_f32 v123, v239, v160, v123
    v_mul_f32 v64, s35, v116
    v_mul_f32 v65, s35, v117
    v_mul_f32 v66, s35, v118
    v_mul_f32 v67, s35, v119
    v_mul_f32 v68, s35, v120
    v_mul_f32 v69, s35, v121
    v_mul_f32 v70, s35, v122
    v_mul_f32 v71, s35, v123
    v_min_f32 v64, 0, v64
    v_min_f32 v65, 0, v65
    v_min_f32 v66, 0, v66
    v_min_f32 v67, 0, v67
    v_min_f32 v68, 0, v68
    v_min_f32 v69, 0, v69
    v_min_f32 v70, 0, v70
    v_min_f32 v71, 0, v71
    v_exp_f32 v64, v64
    v_exp_f32 v65, v65
    v_exp_f32 v66, v66
    v_exp_f32 v67, v67
    v_exp_f32 v68, v68
    v_exp_f32 v69, v69
    v_exp_f32 v70, v70
    v_exp_f32 v71, v71
    v_max_f32 v72, 0, v116
    v_max_f32 v73, 0, v117
    v_max_f32 v74, 0, v118
    v_max_f32 v75, 0, v119
    v_max_f32 v76, 0, v120
    v_max_f32 v77, 0, v121
    v_max_f32 v78, 0, v122
    v_max_f32 v79, 0, v123
    v_add_f32 v64, v64, v72
    v_add_f32 v65, v65, v73
    v_add_f32 v66, v66, v74
    v_add_f32 v67, v67, v75
    v_add_f32 v68, v68, v76
    v_add_f32 v69, v69, v77
    v_add_f32 v70, v70, v78
    v_add_f32 v71, v71, v79
    v_add_f32 v116, s36, v64
    v_add_f32 v117, s36, v65
    v_add_f32 v118, s36, v66
    v_add_f32 v119, s36, v67
    v_add_f32 v120, s36, v68
    v_add_f32 v121, s36, v69
    v_add_f32 v122, s36, v70
    v_add_f32 v123, s36, v71
    v_cvt_pk_bf16_f32 v44, v116, v117
    v_cvt_pk_bf16_f32 v45, v118, v119
    v_cvt_pk_bf16_f32 v46, v120, v121
    v_cvt_pk_bf16_f32 v47, v122, v123
    v_mul_f32 v124, v224, v124
    v_mul_f32 v125, v225, v125
    v_mul_f32 v126, v226, v126
    v_mul_f32 v127, v227, v127
    v_mul_f32 v128, v228, v128
    v_mul_f32 v129, v229, v129
    v_mul_f32 v130, v230, v130
    v_mul_f32 v131, v231, v131
    v_fma_f32 v124, v232, v164, v124
    v_fma_f32 v125, v233, v164, v125
    v_fma_f32 v126, v234, v164, v126
    v_fma_f32 v127, v235, v164, v127
    v_fma_f32 v128, v236, v164, v128
    v_fma_f32 v129, v237, v164, v129
    v_fma_f32 v130, v238, v164, v130
    v_fma_f32 v131, v239, v164, v131
    v_cvt_pk_bf16_f32 v48, v124, v125
    v_cvt_pk_bf16_f32 v49, v126, v127
    v_cvt_pk_bf16_f32 v50, v128, v129
    v_cvt_pk_bf16_f32 v51, v130, v131
    v_mul_f32 v132, v224, v132
    v_mul_f32 v133, v225, v133
    v_mul_f32 v134, v226, v134
    v_mul_f32 v135, v227, v135
    v_mul_f32 v136, v228, v136
    v_mul_f32 v137, v229, v137
    v_mul_f32 v138, v230, v138
    v_mul_f32 v139, v231, v139
    v_fma_f32 v132, v232, v168, v132
    v_fma_f32 v133, v233, v168, v133
    v_fma_f32 v134, v234, v168, v134
    v_fma_f32 v135, v235, v168, v135
    v_fma_f32 v136, v236, v168, v136
    v_fma_f32 v137, v237, v168, v137
    v_fma_f32 v138, v238, v168, v138
    v_fma_f32 v139, v239, v168, v139
    v_cvt_pk_bf16_f32 v52, v132, v133
    v_cvt_pk_bf16_f32 v53, v134, v135
    v_cvt_pk_bf16_f32 v54, v136, v137
    v_cvt_pk_bf16_f32 v55, v138, v139
    v_mul_f32 v140, v224, v140
    v_mul_f32 v141, v225, v141
    v_mul_f32 v142, v226, v142
    v_mul_f32 v143, v227, v143
    v_mul_f32 v144, v228, v144
    v_mul_f32 v145, v229, v145
    v_mul_f32 v146, v230, v146
    v_mul_f32 v147, v231, v147
    v_fma_f32 v140, v232, v172, v140
    v_fma_f32 v141, v233, v172, v141
    v_fma_f32 v142, v234, v172, v142
    v_fma_f32 v143, v235, v172, v143
    v_fma_f32 v144, v236, v172, v144
    v_fma_f32 v145, v237, v172, v145
    v_fma_f32 v146, v238, v172, v146
    v_fma_f32 v147, v239, v172, v147
    v_mul_f32 v64, s35, v140
    v_mul_f32 v65, s35, v141
    v_mul_f32 v66, s35, v142
    v_mul_f32 v67, s35, v143
    v_mul_f32 v68, s35, v144
    v_mul_f32 v69, s35, v145
    v_mul_f32 v70, s35, v146
    v_mul_f32 v71, s35, v147
    v_min_f32 v64, 0, v64
    v_min_f32 v65, 0, v65
    v_min_f32 v66, 0, v66
    v_min_f32 v67, 0, v67
    v_min_f32 v68, 0, v68
    v_min_f32 v69, 0, v69
    v_min_f32 v70, 0, v70
    v_min_f32 v71, 0, v71
    v_exp_f32 v64, v64
    v_exp_f32 v65, v65
    v_exp_f32 v66, v66
    v_exp_f32 v67, v67
    v_exp_f32 v68, v68
    v_exp_f32 v69, v69
    v_exp_f32 v70, v70
    v_exp_f32 v71, v71
    v_max_f32 v72, 0, v140
    v_max_f32 v73, 0, v141
    v_max_f32 v74, 0, v142
    v_max_f32 v75, 0, v143
    v_max_f32 v76, 0, v144
    v_max_f32 v77, 0, v145
    v_max_f32 v78, 0, v146
    v_max_f32 v79, 0, v147
    v_add_f32 v64, v64, v72
    v_add_f32 v65, v65, v73
    v_add_f32 v66, v66, v74
    v_add_f32 v67, v67, v75
    v_add_f32 v68, v68, v76
    v_add_f32 v69, v69, v77
    v_add_f32 v70, v70, v78
    v_add_f32 v71, v71, v79
    v_add_f32 v64, s36, v64
    v_add_f32 v65, s36, v65
    v_add_f32 v66, s36, v66
    v_add_f32 v67, s36, v67
    v_add_f32 v68, s36, v68
    v_add_f32 v69, s36, v69
    v_add_f32 v70, s36, v70
    v_add_f32 v71, s36, v71
    v_cndmask_b32 v140, v140, v64, s[38:39]
    v_cndmask_b32 v141, v141, v65, s[38:39]
    v_cndmask_b32 v142, v142, v66, s[38:39]
    v_cndmask_b32 v143, v143, v67, s[38:39]
    v_cndmask_b32 v144, v144, v68, s[38:39]
    v_cndmask_b32 v145, v145, v69, s[38:39]
    v_cndmask_b32 v146, v146, v70, s[38:39]
    v_cndmask_b32 v147, v147, v71, s[38:39]
    v_cvt_pk_bf16_f32 v56, v140, v141
    v_cvt_pk_bf16_f32 v57, v142, v143
    v_cvt_pk_bf16_f32 v58, v144, v145
    v_cvt_pk_bf16_f32 v59, v146, v147
    v_cmp_eq_u32 vcc, 12, v13
    s_nop 1
    v_cndmask_b32 v56, v56, v176, vcc
    v_cndmask_b32 v57, v57, v176, vcc
    v_cndmask_b32 v58, v58, v176, vcc
    v_cndmask_b32 v59, v59, v176, vcc
    s_barrier
    v_mfma_f32_16x16x32_bf16 v[108:111], v[40:43], v[48:51], 0
    v_mfma_f32_16x16x32_bf16 v[112:115], v[40:43], v[56:59], 0
    v_mfma_f32_16x16x32_bf16 v[116:119], v[44:47], v[52:55], 0
    v_mfma_f32_16x16x32_bf16 v[120:123], v[44:47], v[56:59], 0
    v_mfma_f32_16x16x32_bf16 v[124:127], v[56:59], v[48:51], 0
    v_mfma_f32_16x16x32_bf16 v[128:131], v[56:59], v[52:55], 0
    v_mfma_f32_16x16x32_bf16 v[132:135], v[56:59], v[56:59], 0
    buffer_store_short v56, v242, s[24:27], s41 offen offset:0 sc1
    buffer_store_short_d16_hi v56, v242, s[24:27], s41 offen offset:4 sc1
    buffer_store_short v57, v242, s[24:27], s41 offen offset:8 sc1
    buffer_store_short_d16_hi v57, v242, s[24:27], s41 offen offset:12 sc1
    buffer_store_short v58, v242, s[24:27], s41 offen offset:64 sc1
    buffer_store_short_d16_hi v58, v242, s[24:27], s41 offen offset:68 sc1
    buffer_store_short v59, v242, s[24:27], s41 offen offset:72 sc1
    buffer_store_short_d16_hi v59, v242, s[24:27], s41 offen offset:76 sc1
    v_mul_f32 v92, v204, v92
    v_mul_f32 v93, v204, v93
    v_mul_f32 v94, v204, v94
    v_mul_f32 v95, v204, v95
    v_mul_f32 v96, v205, v96
    v_mul_f32 v97, v205, v97
    v_mul_f32 v98, v205, v98
    v_mul_f32 v99, v205, v99
    v_fma_f32 v92, v206, v148, v92
    v_fma_f32 v93, v206, v149, v93
    v_fma_f32 v94, v206, v150, v94
    v_fma_f32 v95, v206, v151, v95
    v_fma_f32 v96, v207, v148, v96
    v_fma_f32 v97, v207, v149, v97
    v_fma_f32 v98, v207, v150, v98
    v_fma_f32 v99, v207, v151, v99
    v_mul_f32 v64, s35, v92
    v_mul_f32 v65, s35, v93
    v_mul_f32 v66, s35, v94
    v_mul_f32 v67, s35, v95
    v_mul_f32 v68, s35, v96
    v_mul_f32 v69, s35, v97
    v_mul_f32 v70, s35, v98
    v_mul_f32 v71, s35, v99
    v_min_f32 v64, 0, v64
    v_min_f32 v65, 0, v65
    v_min_f32 v66, 0, v66
    v_min_f32 v67, 0, v67
    v_min_f32 v68, 0, v68
    v_min_f32 v69, 0, v69
    v_min_f32 v70, 0, v70
    v_min_f32 v71, 0, v71
    v_exp_f32 v64, v64
    v_exp_f32 v65, v65
    v_exp_f32 v66, v66
    v_exp_f32 v67, v67
    v_exp_f32 v68, v68
    v_exp_f32 v69, v69
    v_exp_f32 v70, v70
    v_exp_f32 v71, v71
    v_max_f32 v72, 0, v92
    v_max_f32 v73, 0, v93
    v_max_f32 v74, 0, v94
    v_max_f32 v75, 0, v95
    v_max_f32 v76, 0, v96
    v_max_f32 v77, 0, v97
    v_max_f32 v78, 0, v98
    v_max_f32 v79, 0, v99
    v_add_f32 v64, v64, v72
    v_add_f32 v65, v65, v73
    v_add_f32 v66, v66, v74
    v_add_f32 v67, v67, v75
    v_add_f32 v68, v68, v76
    v_add_f32 v69, v69, v77
    v_add_f32 v70, v70, v78
    v_add_f32 v71, v71, v79
    v_add_f32 v92, s36, v64
    v_add_f32 v93, s36, v65
    v_add_f32 v94, s36, v66
    v_add_f32 v95, s36, v67
    v_add_f32 v96, s36, v68
    v_add_f32 v97, s36, v69
    v_add_f32 v98, s36, v70
    v_add_f32 v99, s36, v71
    v_cvt_pk_bf16_f32 v32, v92, v93
    v_cvt_pk_bf16_f32 v33, v94, v95
    v_cvt_pk_bf16_f32 v34, v96, v97
    v_cvt_pk_bf16_f32 v35, v98, v99
    buffer_store_dwordx2 v[32:33], v240, s[24:27], s41 offen offset:0 sc1
    buffer_store_dwordx2 v[34:35], v240, s[24:27], s41 offen offset:256 sc1
    v_mul_f32 v100, v204, v100
    v_mul_f32 v101, v204, v101
    v_mul_f32 v102, v204, v102
    v_mul_f32 v103, v204, v103
    v_mul_f32 v104, v205, v104
    v_mul_f32 v105, v205, v105
    v_mul_f32 v106, v205, v106
    v_mul_f32 v107, v205, v107
    v_fma_f32 v100, v206, v152, v100
    v_fma_f32 v101, v206, v153, v101
    v_fma_f32 v102, v206, v154, v102
    v_fma_f32 v103, v206, v155, v103
    v_fma_f32 v104, v207, v152, v104
    v_fma_f32 v105, v207, v153, v105
    v_fma_f32 v106, v207, v154, v106
    v_fma_f32 v107, v207, v155, v107
    v_mul_f32 v64, s35, v100
    v_mul_f32 v65, s35, v101
    v_mul_f32 v66, s35, v102
    v_mul_f32 v67, s35, v103
    v_mul_f32 v68, s35, v104
    v_mul_f32 v69, s35, v105
    v_mul_f32 v70, s35, v106
    v_mul_f32 v71, s35, v107
    v_min_f32 v64, 0, v64
    v_min_f32 v65, 0, v65
    v_min_f32 v66, 0, v66
    v_min_f32 v67, 0, v67
    v_min_f32 v68, 0, v68
    v_min_f32 v69, 0, v69
    v_min_f32 v70, 0, v70
    v_min_f32 v71, 0, v71
    v_exp_f32 v64, v64
    v_exp_f32 v65, v65
    v_exp_f32 v66, v66
    v_exp_f32 v67, v67
    v_exp_f32 v68, v68
    v_exp_f32 v69, v69
    v_exp_f32 v70, v70
    v_exp_f32 v71, v71
    v_max_f32 v72, 0, v100
    v_max_f32 v73, 0, v101
    v_max_f32 v74, 0, v102
    v_max_f32 v75, 0, v103
    v_max_f32 v76, 0, v104
    v_max_f32 v77, 0, v105
    v_max_f32 v78, 0, v106
    v_max_f32 v79, 0, v107
    v_add_f32 v64, v64, v72
    v_add_f32 v65, v65, v73
    v_add_f32 v66, v66, v74
    v_add_f32 v67, v67, v75
    v_add_f32 v68, v68, v76
    v_add_f32 v69, v69, v77
    v_add_f32 v70, v70, v78
    v_add_f32 v71, v71, v79
    v_add_f32 v100, s36, v64
    v_add_f32 v101, s36, v65
    v_add_f32 v102, s36, v66
    v_add_f32 v103, s36, v67
    v_add_f32 v104, s36, v68
    v_add_f32 v105, s36, v69
    v_add_f32 v106, s36, v70
    v_add_f32 v107, s36, v71
    v_cvt_pk_bf16_f32 v36, v100, v101
    v_cvt_pk_bf16_f32 v37, v102, v103
    v_cvt_pk_bf16_f32 v38, v104, v105
    v_cvt_pk_bf16_f32 v39, v106, v107
    buffer_store_dwordx2 v[36:37], v240, s[24:27], s44 offen offset:0 sc1
    buffer_store_dwordx2 v[38:39], v240, s[24:27], s44 offen offset:256 sc1
    v_mul_u32_u24 v64, 768, v14
    v_lshl_add_u32 v64, v13, 2, v64
    s_mul_i32 s29, s14, 9216
    v_add_u32 v64, s29, v64
    ds_write_b32 v64, v108 offset:0
    ds_write_b32 v64, v109 offset:192
    ds_write_b32 v64, v110 offset:384
    ds_write_b32 v64, v111 offset:576
    ds_write_b32 v64, v112 offset:128
    ds_write_b32 v64, v113 offset:320
    ds_write_b32 v64, v114 offset:512
    ds_write_b32 v64, v115 offset:704
    ds_write_b32 v64, v116 offset:3136
    ds_write_b32 v64, v117 offset:3328
    ds_write_b32 v64, v118 offset:3520
    ds_write_b32 v64, v119 offset:3712
    ds_write_b32 v64, v120 offset:3200
    ds_write_b32 v64, v121 offset:3392
    ds_write_b32 v64, v122 offset:3584
    ds_write_b32 v64, v123 offset:3776
    ds_write_b32 v64, v124 offset:6144
    ds_write_b32 v64, v125 offset:6336
    ds_write_b32 v64, v126 offset:6528
    ds_write_b32 v64, v127 offset:6720
    ds_write_b32 v64, v128 offset:6208
    ds_write_b32 v64, v129 offset:6400
    ds_write_b32 v64, v130 offset:6592
    ds_write_b32 v64, v131 offset:6784
    ds_write_b32 v64, v132 offset:6272
    ds_write_b32 v64, v133 offset:6464
    ds_write_b32 v64, v134 offset:6656
    ds_write_b32 v64, v135 offset:6848
    s_waitcnt lgkmcnt(0)
    s_barrier
    s_mul_i32 s29, s13, 3040
    s_add_u32 s29, s29, 0x1390000
    ds_read_b32 v156, v247 offset:0
    ds_read_b32 v157, v247 offset:9216
    ds_read_b32 v158, v247 offset:18432
    ds_read_b32 v159, v247 offset:27648
    ds_read_b32 v168, v249 offset:0
    ds_read_b32 v169, v249 offset:9216
    ds_read_b32 v170, v249 offset:18432
    ds_read_b32 v171, v249 offset:27648
    ds_read_b32 v180, v251 offset:0
    ds_read_b32 v181, v251 offset:9216
    ds_read_b32 v182, v251 offset:18432
    ds_read_b32 v183, v251 offset:27648
    s_waitcnt lgkmcnt(8)
    v_add_f32 v156, v156, v157
    v_add_f32 v158, v158, v159
    v_add_f32 v156, v156, v158
    buffer_atomic_add_f32 v156, v246, s[24:27], s29 offen
    s_waitcnt lgkmcnt(4)
    v_add_f32 v168, v168, v169
    v_add_f32 v170, v170, v171
    v_add_f32 v168, v168, v170
    buffer_atomic_add_f32 v168, v248, s[24:27], s29 offen
    s_waitcnt lgkmcnt(0)
    v_add_f32 v180, v180, v181
    v_add_f32 v182, v182, v183
    v_add_f32 v180, v180, v182
    buffer_atomic_add_f32 v180, v250, s[24:27], s29 offen
qkva1_kernel_end:
    s_endpgm
.text
.globl outa1_kernel
.p2align 8
.type outa1_kernel,@function
outa1_kernel:
    s_cmp_ge_u32 s2, 192
    s_cbranch_scc1 outa1_kernel_end
    s_load_dwordx2 s[8:9], s[0:1], 64
    s_and_b32 s40, s2, 7
    s_lshr_b32 s41, s2, 3
    s_lshl_b32 s12, s40, 2
    s_and_b32 s13, s41, 3
    s_add_u32 s12, s12, s13
    s_lshr_b32 s13, s41, 2
    v_lshrrev_b32 v1, 6, v0
    v_and_b32 v2, 63, v0
    v_readfirstlane_b32 s14, v1
    v_and_b32 v3, 31, v2
    v_lshrrev_b32 v4, 5, v2
    v_lshlrev_b32 v5, 4, v2
    s_and_b32 s15, s14, 1
    s_lshr_b32 s16, s14, 1
    s_lshl_b32 s17, s12, 1
    s_add_u32 s17, s17, s15
    v_lshrrev_b32 v6, 4, v3
    v_mul_u32_u24 v6, 18432, v6
    v_and_b32 v7, 15, v3
    v_lshl_add_u32 v6, v7, 4, v6
    v_lshl_add_u32 v6, v4, 3, v6
    s_mul_i32 s18, s17, 36864
    s_mul_i32 s19, s13, 3072
    s_add_u32 s18, s18, s19
    s_add_u32 s19, s18, 0x0
    s_add_u32 s42, s13, 0
    s_mul_i32 s42, s42, 110592
    s_add_u32 s42, s42, 0x1200000
    s_mul_i32 s43, s16, 55296
    s_mul_i32 s44, s15, 9216
    s_add_u32 s43, s43, s44
    s_add_u32 s42, s42, s43
    s_mul_i32 s44, s16, 55296
    v_add_u32 v14, s44, v5
    s_waitcnt lgkmcnt(0)
    s_mov_b32 s28, s8
    s_mov_b32 s29, s9
    s_mov_b32 s30, 0x1480000
    s_mov_b32 s31, 0x00020000
    s_add_u32 s36, s8, 0x1390000
    s_addc_u32 s37, s9, 0
    s_mov_b32 s38, 0xbe00
    s_mov_b32 s39, 0x00020000
    v_cmp_eq_u32 vcc, 0, v4
    v_mov_b32 v248, 0x40000000
    v_lshl_add_u32 v10, v3, 2, 0
    v_add_u32 v10, 1024, v10
    v_cndmask_b32 v11, v248, v10, vcc
    v_mul_u32_u24 v12, 80, v3
    v_lshl_add_u32 v13, v4, 5, v12
    v_cmp_gt_u32 s[48:49], 19, v3
    v_add_u32 v12, 64, v12
    s_and_b64 vcc, vcc, s[48:49]
    v_cndmask_b32 v13, v248, v13, s[48:49]
    v_cndmask_b32 v12, v248, v12, vcc
    s_mul_i32 s50, s14, 12160
    s_add_u32 s51, s50, 0
    buffer_load_dwordx4 v[144:147], v13, s[36:39], s51 offen
    buffer_load_dwordx4 v[148:151], v13, s[36:39], s51 offen offset:16
    buffer_load_dwordx2 v[152:153], v12, s[36:39], s51 offen
    s_add_u32 s51, s50, 1520
    buffer_load_dwordx4 v[154:157], v13, s[36:39], s51 offen
    buffer_load_dwordx4 v[158:161], v13, s[36:39], s51 offen offset:16
    buffer_load_dwordx2 v[162:163], v12, s[36:39], s51 offen
    s_add_u32 s51, s50, 3040
    buffer_load_dwordx4 v[164:167], v13, s[36:39], s51 offen
    buffer_load_dwordx4 v[168:171], v13, s[36:39], s51 offen offset:16
    buffer_load_dwordx2 v[172:173], v12, s[36:39], s51 offen
    s_add_u32 s51, s50, 4560
    buffer_load_dwordx4 v[174:177], v13, s[36:39], s51 offen
    buffer_load_dwordx4 v[178:181], v13, s[36:39], s51 offen offset:16
    buffer_load_dwordx2 v[182:183], v12, s[36:39], s51 offen
    s_add_u32 s51, s50, 6080
    buffer_load_dwordx4 v[184:187], v13, s[36:39], s51 offen
    buffer_load_dwordx4 v[188:191], v13, s[36:39], s51 offen offset:16
    buffer_load_dwordx2 v[192:193], v12, s[36:39], s51 offen
    s_add_u32 s51, s50, 7600
    buffer_load_dwordx4 v[194:197], v13, s[36:39], s51 offen
    buffer_load_dwordx4 v[198:201], v13, s[36:39], s51 offen offset:16
    buffer_load_dwordx2 v[202:203], v12, s[36:39], s51 offen
    s_add_u32 s51, s50, 9120
    buffer_load_dwordx4 v[204:207], v13, s[36:39], s51 offen
    buffer_load_dwordx4 v[208:211], v13, s[36:39], s51 offen offset:16
    buffer_load_dwordx2 v[212:213], v12, s[36:39], s51 offen
    s_add_u32 s51, s50, 10640
    buffer_load_dwordx4 v[214:217], v13, s[36:39], s51 offen
    buffer_load_dwordx4 v[218:221], v13, s[36:39], s51 offen offset:16
    buffer_load_dwordx2 v[222:223], v12, s[36:39], s51 offen
    s_lshl_b32 s45, s16, 10
    s_add_u32 s45, s45, s17
    s_mul_i32 s45, s45, 1152
    s_add_u32 s45, s45, 0x480000
    s_add_u32 s46, s45, 0
    buffer_load_dwordx4 a[0:3], v5, s[28:31], s46 offen
    buffer_load_dword a64, v11, s[28:31], s46 offen
    s_add_u32 s46, s45, 73728
    buffer_load_dwordx4 a[4:7], v5, s[28:31], s46 offen
    buffer_load_dword a68, v11, s[28:31], s46 offen
    s_add_u32 s46, s45, 147456
    buffer_load_dwordx4 a[8:11], v5, s[28:31], s46 offen
    buffer_load_dword a72, v11, s[28:31], s46 offen
    s_add_u32 s46, s45, 221184
    buffer_load_dwordx4 a[12:15], v5, s[28:31], s46 offen
    buffer_load_dword a76, v11, s[28:31], s46 offen
    s_add_u32 s46, s45, 294912
    buffer_load_dwordx4 a[16:19], v5, s[28:31], s46 offen
    buffer_load_dword a80, v11, s[28:31], s46 offen
    s_add_u32 s46, s45, 368640
    buffer_load_dwordx4 a[20:23], v5, s[28:31], s46 offen
    buffer_load_dword a84, v11, s[28:31], s46 offen
    s_add_u32 s46, s45, 442368
    buffer_load_dwordx4 a[24:27], v5, s[28:31], s46 offen
    buffer_load_dword a88, v11, s[28:31], s46 offen
    s_add_u32 s46, s45, 516096
    buffer_load_dwordx4 a[28:31], v5, s[28:31], s46 offen
    buffer_load_dword a92, v11, s[28:31], s46 offen
    s_add_u32 s46, s45, 589824
    buffer_load_dwordx4 a[32:35], v5, s[28:31], s46 offen
    buffer_load_dword a96, v11, s[28:31], s46 offen
    s_add_u32 s46, s45, 663552
    buffer_load_dwordx4 a[36:39], v5, s[28:31], s46 offen
    buffer_load_dword a100, v11, s[28:31], s46 offen
    s_add_u32 s46, s45, 737280
    buffer_load_dwordx4 a[40:43], v5, s[28:31], s46 offen
    buffer_load_dword a104, v11, s[28:31], s46 offen
    s_add_u32 s46, s45, 811008
    buffer_load_dwordx4 a[44:47], v5, s[28:31], s46 offen
    buffer_load_dword a108, v11, s[28:31], s46 offen
    s_add_u32 s46, s45, 884736
    buffer_load_dwordx4 a[48:51], v5, s[28:31], s46 offen
    buffer_load_dword a112, v11, s[28:31], s46 offen
    s_add_u32 s46, s45, 958464
    buffer_load_dwordx4 a[52:55], v5, s[28:31], s46 offen
    buffer_load_dword a116, v11, s[28:31], s46 offen
    s_add_u32 s46, s45, 1032192
    buffer_load_dwordx4 a[56:59], v5, s[28:31], s46 offen
    buffer_load_dword a120, v11, s[28:31], s46 offen
    s_add_u32 s46, s45, 1105920
    buffer_load_dwordx4 a[60:63], v5, s[28:31], s46 offen
    buffer_load_dword a124, v11, s[28:31], s46 offen
    v_accvgpr_write_b32 a65, 0
    v_accvgpr_write_b32 a66, 0
    v_accvgpr_write_b32 a67, 0
    v_accvgpr_write_b32 a69, 0
    v_accvgpr_write_b32 a70, 0
    v_accvgpr_write_b32 a71, 0
    v_accvgpr_write_b32 a73, 0
    v_accvgpr_write_b32 a74, 0
    v_accvgpr_write_b32 a75, 0
    v_accvgpr_write_b32 a77, 0
    v_accvgpr_write_b32 a78, 0
    v_accvgpr_write_b32 a79, 0
    v_accvgpr_write_b32 a81, 0
    v_accvgpr_write_b32 a82, 0
    v_accvgpr_write_b32 a83, 0
    v_accvgpr_write_b32 a85, 0
    v_accvgpr_write_b32 a86, 0
    v_accvgpr_write_b32 a87, 0
    v_accvgpr_write_b32 a89, 0
    v_accvgpr_write_b32 a90, 0
    v_accvgpr_write_b32 a91, 0
    v_accvgpr_write_b32 a93, 0
    v_accvgpr_write_b32 a94, 0
    v_accvgpr_write_b32 a95, 0
    v_accvgpr_write_b32 a97, 0
    v_accvgpr_write_b32 a98, 0
    v_accvgpr_write_b32 a99, 0
    v_accvgpr_write_b32 a101, 0
    v_accvgpr_write_b32 a102, 0
    v_accvgpr_write_b32 a103, 0
    v_accvgpr_write_b32 a105, 0
    v_accvgpr_write_b32 a106, 0
    v_accvgpr_write_b32 a107, 0
    v_accvgpr_write_b32 a109, 0
    v_accvgpr_write_b32 a110, 0
    v_accvgpr_write_b32 a111, 0
    v_accvgpr_write_b32 a113, 0
    v_accvgpr_write_b32 a114, 0
    v_accvgpr_write_b32 a115, 0
    v_accvgpr_write_b32 a117, 0
    v_accvgpr_write_b32 a118, 0
    v_accvgpr_write_b32 a119, 0
    v_accvgpr_write_b32 a121, 0
    v_accvgpr_write_b32 a122, 0
    v_accvgpr_write_b32 a123, 0
    v_accvgpr_write_b32 a125, 0
    v_accvgpr_write_b32 a126, 0
    v_accvgpr_write_b32 a127, 0
    s_mov_b32 s52, 0x358637bd
    s_mul_i32 s51, s14, 10240
    s_add_u32 s51, s51, 110592
    v_add_u32 v10, s51, v5
    v_lshlrev_b32 v11, 2, v2
    v_add_u32 v11, s51, v11
    s_waitcnt vmcnt(32)
    v_cvt_pk_bf16_f32 v16, v144, v145
    v_cvt_pk_bf16_f32 v17, v146, v147
    v_cvt_pk_bf16_f32 v18, v148, v149
    v_cvt_pk_bf16_f32 v19, v150, v151
    v_cvt_pk_bf16_f32 v20, v152, v153
    ds_write_b128 v10, v[16:19] offset:0
    ds_write_b32 v11, v20 offset:1024
    v_cvt_pk_bf16_f32 v24, v154, v155
    v_cvt_pk_bf16_f32 v25, v156, v157
    v_cvt_pk_bf16_f32 v26, v158, v159
    v_cvt_pk_bf16_f32 v27, v160, v161
    v_cvt_pk_bf16_f32 v28, v162, v163
    ds_write_b128 v10, v[24:27] offset:1280
    ds_write_b32 v11, v28 offset:2304
    v_cvt_pk_bf16_f32 v32, v164, v165
    v_cvt_pk_bf16_f32 v33, v166, v167
    v_cvt_pk_bf16_f32 v34, v168, v169
    v_cvt_pk_bf16_f32 v35, v170, v171
    v_cvt_pk_bf16_f32 v36, v172, v173
    ds_write_b128 v10, v[32:35] offset:2560
    ds_write_b32 v11, v36 offset:3584
    v_cvt_pk_bf16_f32 v40, v174, v175
    v_cvt_pk_bf16_f32 v41, v176, v177
    v_cvt_pk_bf16_f32 v42, v178, v179
    v_cvt_pk_bf16_f32 v43, v180, v181
    v_cvt_pk_bf16_f32 v44, v182, v183
    ds_write_b128 v10, v[40:43] offset:3840
    ds_write_b32 v11, v44 offset:4864
    v_cvt_pk_bf16_f32 v48, v184, v185
    v_cvt_pk_bf16_f32 v49, v186, v187
    v_cvt_pk_bf16_f32 v50, v188, v189
    v_cvt_pk_bf16_f32 v51, v190, v191
    v_cvt_pk_bf16_f32 v52, v192, v193
    ds_write_b128 v10, v[48:51] offset:5120
    ds_write_b32 v11, v52 offset:6144
    v_cvt_pk_bf16_f32 v56, v194, v195
    v_cvt_pk_bf16_f32 v57, v196, v197
    v_cvt_pk_bf16_f32 v58, v198, v199
    v_cvt_pk_bf16_f32 v59, v200, v201
    v_cvt_pk_bf16_f32 v60, v202, v203
    ds_write_b128 v10, v[56:59] offset:6400
    ds_write_b32 v11, v60 offset:7424
    v_cvt_pk_bf16_f32 v64, v204, v205
    v_cvt_pk_bf16_f32 v65, v206, v207
    v_cvt_pk_bf16_f32 v66, v208, v209
    v_cvt_pk_bf16_f32 v67, v210, v211
    v_cvt_pk_bf16_f32 v68, v212, v213
    ds_write_b128 v10, v[64:67] offset:7680
    ds_write_b32 v11, v68 offset:8704
    v_cvt_pk_bf16_f32 v72, v214, v215
    v_cvt_pk_bf16_f32 v73, v216, v217
    v_cvt_pk_bf16_f32 v74, v218, v219
    v_cvt_pk_bf16_f32 v75, v220, v221
    v_cvt_pk_bf16_f32 v76, v222, v223
    ds_write_b128 v10, v[72:75] offset:8960
    ds_write_b32 v11, v76 offset:9984
    s_waitcnt lgkmcnt(0)
    s_barrier
    s_mul_i32 s51, s16, 20480
    s_add_u32 s51, s51, 110592
    v_add_u32 v10, s51, v5
    v_lshlrev_b32 v11, 2, v2
    v_add_u32 v11, s51, v11
    v_mov_b32 v149, 0
    v_mov_b32 v150, 0
    v_mov_b32 v151, 0
    v_mov_b32 v157, 0
    v_mov_b32 v158, 0
    v_mov_b32 v159, 0
    v_mov_b32 v165, 0
    v_mov_b32 v166, 0
    v_mov_b32 v167, 0
    v_mov_b32 v173, 0
    v_mov_b32 v174, 0
    v_mov_b32 v175, 0
    ds_read_b128 v[144:147], v10 offset:0
    ds_read_b32 v148, v11 offset:1024
    ds_read_b128 v[152:155], v10 offset:1280
    ds_read_b32 v156, v11 offset:2304
    ds_read_b128 v[160:163], v10 offset:2560
    ds_read_b32 v164, v11 offset:3584
    ds_read_b128 v[168:171], v10 offset:3840
    ds_read_b32 v172, v11 offset:4864
    s_waitcnt lgkmcnt(4)
    s_waitcnt vmcnt(28)
    v_mfma_f32_32x32x16_bf16 v[176:191], v[144:147], a[0:3], 0
    v_mfma_f32_32x32x16_bf16 v[176:191], v[148:151], a[64:67], v[176:191]
    v_mfma_f32_32x32x16_bf16 v[192:207], v[152:155], a[4:7], 0
    v_mfma_f32_32x32x16_bf16 v[192:207], v[156:159], a[68:71], v[192:207]
    s_waitcnt lgkmcnt(0)
    s_waitcnt vmcnt(24)
    v_mfma_f32_32x32x16_bf16 v[208:223], v[160:163], a[8:11], 0
    v_mfma_f32_32x32x16_bf16 v[208:223], v[164:167], a[72:75], v[208:223]
    v_mfma_f32_32x32x16_bf16 v[224:239], v[168:171], a[12:15], 0
    v_mfma_f32_32x32x16_bf16 v[224:239], v[172:175], a[76:79], v[224:239]
    s_add_u32 s44, s43, 0
    s_mov_b32 m0, s44
    s_add_u32 s46, s42, 0
    buffer_load_dwordx4 v5, s[28:31], s46 offen lds
    s_add_u32 s44, s43, 1024
    s_mov_b32 m0, s44
    s_add_u32 s46, s42, 1024
    buffer_load_dwordx4 v5, s[28:31], s46 offen lds
    s_add_u32 s44, s43, 2048
    s_mov_b32 m0, s44
    s_add_u32 s46, s42, 2048
    buffer_load_dwordx4 v5, s[28:31], s46 offen lds
    s_add_u32 s44, s43, 3072
    s_mov_b32 m0, s44
    s_add_u32 s46, s42, 3072
    buffer_load_dwordx4 v5, s[28:31], s46 offen lds
    v_mov_b32 v8, v186
    v_mov_b32 v9, v202
    s_nop 1
    v_permlane32_swap_b32 v8, v186
    v_permlane32_swap_b32 v9, v202
    s_nop 1
    v_add_f32 v8, s52, v8
    v_add_f32 v9, s52, v9
    v_rcp_f32 v8, v8
    v_rcp_f32 v9, v9
    s_nop 0
    v_mul_f32 v176, v176, v8
    v_mul_f32 v177, v177, v8
    v_mul_f32 v178, v178, v8
    v_mul_f32 v179, v179, v8
    v_mul_f32 v180, v180, v8
    v_mul_f32 v181, v181, v8
    v_mul_f32 v182, v182, v8
    v_mul_f32 v183, v183, v8
    v_mul_f32 v184, v184, v8
    v_mul_f32 v185, v185, v8
    v_cvt_pk_bf16_f32 v16, v176, v177
    v_cvt_pk_bf16_f32 v17, v178, v179
    v_cvt_pk_bf16_f32 v18, v180, v181
    v_cvt_pk_bf16_f32 v19, v182, v183
    v_cvt_pk_bf16_f32 v80, v184, v185
    v_mul_f32 v192, v192, v9
    v_mul_f32 v193, v193, v9
    v_mul_f32 v194, v194, v9
    v_mul_f32 v195, v195, v9
    v_mul_f32 v196, v196, v9
    v_mul_f32 v197, v197, v9
    v_mul_f32 v198, v198, v9
    v_mul_f32 v199, v199, v9
    v_mul_f32 v200, v200, v9
    v_mul_f32 v201, v201, v9
    v_cvt_pk_bf16_f32 v20, v192, v193
    v_cvt_pk_bf16_f32 v21, v194, v195
    v_cvt_pk_bf16_f32 v22, v196, v197
    v_cvt_pk_bf16_f32 v23, v198, v199
    v_cvt_pk_bf16_f32 v81, v200, v201
    ds_read_b128 v[144:147], v10 offset:5120
    ds_read_b32 v148, v11 offset:6144
    ds_read_b128 v[152:155], v10 offset:6400
    ds_read_b32 v156, v11 offset:7424
    s_waitcnt lgkmcnt(0)
    s_waitcnt vmcnt(24)
    v_mfma_f32_32x32x16_bf16 v[176:191], v[144:147], a[16:19], 0
    v_mfma_f32_32x32x16_bf16 v[176:191], v[148:151], a[80:83], v[176:191]
    v_mfma_f32_32x32x16_bf16 v[192:207], v[152:155], a[20:23], 0
    v_mfma_f32_32x32x16_bf16 v[192:207], v[156:159], a[84:87], v[192:207]
    s_add_u32 s44, s43, 4096
    s_mov_b32 m0, s44
    s_add_u32 s46, s42, 4096
    buffer_load_dwordx4 v5, s[28:31], s46 offen lds
    s_add_u32 s44, s43, 5120
    s_mov_b32 m0, s44
    s_add_u32 s46, s42, 5120
    buffer_load_dwordx4 v5, s[28:31], s46 offen lds
    s_add_u32 s44, s43, 6144
    s_mov_b32 m0, s44
    s_add_u32 s46, s42, 6144
    buffer_load_dwordx4 v5, s[28:31], s46 offen lds
    s_add_u32 s44, s43, 7168
    s_mov_b32 m0, s44
    s_add_u32 s46, s42, 7168
    buffer_load_dwordx4 v5, s[28:31], s46 offen lds
    v_mov_b32 v8, v218
    v_mov_b32 v9, v234
    s_nop 1
    v_permlane32_swap_b32 v8, v218
    v_permlane32_swap_b32 v9, v234
    s_nop 1
    v_add_f32 v8, s52, v8
    v_add_f32 v9, s52, v9
    v_rcp_f32 v8, v8
    v_rcp_f32 v9, v9
    s_nop 0
    v_mul_f32 v208, v208, v8
    v_mul_f32 v209, v209, v8
    v_mul_f32 v210, v210, v8
    v_mul_f32 v211, v211, v8
    v_mul_f32 v212, v212, v8
    v_mul_f32 v213, v213, v8
    v_mul_f32 v214, v214, v8
    v_mul_f32 v215, v215, v8
    v_mul_f32 v216, v216, v8
    v_mul_f32 v217, v217, v8
    v_cvt_pk_bf16_f32 v24, v208, v209
    v_cvt_pk_bf16_f32 v25, v210, v211
    v_cvt_pk_bf16_f32 v26, v212, v213
    v_cvt_pk_bf16_f32 v27, v214, v215
    v_cvt_pk_bf16_f32 v82, v216, v217
    v_mul_f32 v224, v224, v9
    v_mul_f32 v225, v225, v9
    v_mul_f32 v226, v226, v9
    v_mul_f32 v227, v227, v9
    v_mul_f32 v228, v228, v9
    v_mul_f32 v229, v229, v9
    v_mul_f32 v230, v230, v9
    v_mul_f32 v231, v231, v9
    v_mul_f32 v232, v232, v9
    v_mul_f32 v233, v233, v9
    v_cvt_pk_bf16_f32 v28, v224, v225
    v_cvt_pk_bf16_f32 v29, v226, v227
    v_cvt_pk_bf16_f32 v30, v228, v229
    v_cvt_pk_bf16_f32 v31, v230, v231
    v_cvt_pk_bf16_f32 v83, v232, v233
    ds_read_b128 v[160:163], v10 offset:7680
    ds_read_b32 v164, v11 offset:8704
    ds_read_b128 v[168:171], v10 offset:8960
    ds_read_b32 v172, v11 offset:9984
    s_waitcnt lgkmcnt(0)
    s_waitcnt vmcnt(24)
    v_mfma_f32_32x32x16_bf16 v[208:223], v[160:163], a[24:27], 0
    v_mfma_f32_32x32x16_bf16 v[208:223], v[164:167], a[88:91], v[208:223]
    v_mfma_f32_32x32x16_bf16 v[224:239], v[168:171], a[28:31], 0
    v_mfma_f32_32x32x16_bf16 v[224:239], v[172:175], a[92:95], v[224:239]
    s_add_u32 s44, s43, 8192
    s_mov_b32 m0, s44
    s_add_u32 s46, s42, 8192
    buffer_load_dwordx4 v5, s[28:31], s46 offen lds
    s_add_u32 s44, s43, 18432
    s_mov_b32 m0, s44
    s_add_u32 s46, s42, 18432
    buffer_load_dwordx4 v5, s[28:31], s46 offen lds
    s_add_u32 s44, s43, 19456
    s_mov_b32 m0, s44
    s_add_u32 s46, s42, 19456
    buffer_load_dwordx4 v5, s[28:31], s46 offen lds
    s_add_u32 s44, s43, 20480
    s_mov_b32 m0, s44
    s_add_u32 s46, s42, 20480
    buffer_load_dwordx4 v5, s[28:31], s46 offen lds
    v_mov_b32 v8, v186
    v_mov_b32 v9, v202
    s_nop 1
    v_permlane32_swap_b32 v8, v186
    v_permlane32_swap_b32 v9, v202
    s_nop 1
    v_add_f32 v8, s52, v8
    v_add_f32 v9, s52, v9
    v_rcp_f32 v8, v8
    v_rcp_f32 v9, v9
    s_nop 0
    v_mul_f32 v176, v176, v8
    v_mul_f32 v177, v177, v8
    v_mul_f32 v178, v178, v8
    v_mul_f32 v179, v179, v8
    v_mul_f32 v180, v180, v8
    v_mul_f32 v181, v181, v8
    v_mul_f32 v182, v182, v8
    v_mul_f32 v183, v183, v8
    v_mul_f32 v184, v184, v8
    v_mul_f32 v185, v185, v8
    v_cvt_pk_bf16_f32 v32, v176, v177
    v_cvt_pk_bf16_f32 v33, v178, v179
    v_cvt_pk_bf16_f32 v34, v180, v181
    v_cvt_pk_bf16_f32 v35, v182, v183
    v_cvt_pk_bf16_f32 v84, v184, v185
    v_mul_f32 v192, v192, v9
    v_mul_f32 v193, v193, v9
    v_mul_f32 v194, v194, v9
    v_mul_f32 v195, v195, v9
    v_mul_f32 v196, v196, v9
    v_mul_f32 v197, v197, v9
    v_mul_f32 v198, v198, v9
    v_mul_f32 v199, v199, v9
    v_mul_f32 v200, v200, v9
    v_mul_f32 v201, v201, v9
    v_cvt_pk_bf16_f32 v36, v192, v193
    v_cvt_pk_bf16_f32 v37, v194, v195
    v_cvt_pk_bf16_f32 v38, v196, v197
    v_cvt_pk_bf16_f32 v39, v198, v199
    v_cvt_pk_bf16_f32 v85, v200, v201
    ds_read_b128 v[144:147], v10 offset:10240
    ds_read_b32 v148, v11 offset:11264
    ds_read_b128 v[152:155], v10 offset:11520
    ds_read_b32 v156, v11 offset:12544
    s_waitcnt lgkmcnt(0)
    s_waitcnt vmcnt(24)
    v_mfma_f32_32x32x16_bf16 v[176:191], v[144:147], a[32:35], 0
    v_mfma_f32_32x32x16_bf16 v[176:191], v[148:151], a[96:99], v[176:191]
    v_mfma_f32_32x32x16_bf16 v[192:207], v[152:155], a[36:39], 0
    v_mfma_f32_32x32x16_bf16 v[192:207], v[156:159], a[100:103], v[192:207]
    s_add_u32 s44, s43, 21504
    s_mov_b32 m0, s44
    s_add_u32 s46, s42, 21504
    buffer_load_dwordx4 v5, s[28:31], s46 offen lds
    s_add_u32 s44, s43, 22528
    s_mov_b32 m0, s44
    s_add_u32 s46, s42, 22528
    buffer_load_dwordx4 v5, s[28:31], s46 offen lds
    s_add_u32 s44, s43, 23552
    s_mov_b32 m0, s44
    s_add_u32 s46, s42, 23552
    buffer_load_dwordx4 v5, s[28:31], s46 offen lds
    s_add_u32 s44, s43, 24576
    s_mov_b32 m0, s44
    s_add_u32 s46, s42, 24576
    buffer_load_dwordx4 v5, s[28:31], s46 offen lds
    v_mov_b32 v8, v218
    v_mov_b32 v9, v234
    s_nop 1
    v_permlane32_swap_b32 v8, v218
    v_permlane32_swap_b32 v9, v234
    s_nop 1
    v_add_f32 v8, s52, v8
    v_add_f32 v9, s52, v9
    v_rcp_f32 v8, v8
    v_rcp_f32 v9, v9
    s_nop 0
    v_mul_f32 v208, v208, v8
    v_mul_f32 v209, v209, v8
    v_mul_f32 v210, v210, v8
    v_mul_f32 v211, v211, v8
    v_mul_f32 v212, v212, v8
    v_mul_f32 v213, v213, v8
    v_mul_f32 v214, v214, v8
    v_mul_f32 v215, v215, v8
    v_mul_f32 v216, v216, v8
    v_mul_f32 v217, v217, v8
    v_cvt_pk_bf16_f32 v40, v208, v209
    v_cvt_pk_bf16_f32 v41, v210, v211
    v_cvt_pk_bf16_f32 v42, v212, v213
    v_cvt_pk_bf16_f32 v43, v214, v215
    v_cvt_pk_bf16_f32 v86, v216, v217
    v_mul_f32 v224, v224, v9
    v_mul_f32 v225, v225, v9
    v_mul_f32 v226, v226, v9
    v_mul_f32 v227, v227, v9
    v_mul_f32 v228, v228, v9
    v_mul_f32 v229, v229, v9
    v_mul_f32 v230, v230, v9
    v_mul_f32 v231, v231, v9
    v_mul_f32 v232, v232, v9
    v_mul_f32 v233, v233, v9
    v_cvt_pk_bf16_f32 v44, v224, v225
    v_cvt_pk_bf16_f32 v45, v226, v227
    v_cvt_pk_bf16_f32 v46, v228, v229
    v_cvt_pk_bf16_f32 v47, v230, v231
    v_cvt_pk_bf16_f32 v87, v232, v233
    ds_read_b128 v[160:163], v10 offset:12800
    ds_read_b32 v164, v11 offset:13824
    ds_read_b128 v[168:171], v10 offset:14080
    ds_read_b32 v172, v11 offset:15104
    s_waitcnt lgkmcnt(0)
    s_waitcnt vmcnt(24)
    v_mfma_f32_32x32x16_bf16 v[208:223], v[160:163], a[40:43], 0
    v_mfma_f32_32x32x16_bf16 v[208:223], v[164:167], a[104:107], v[208:223]
    v_mfma_f32_32x32x16_bf16 v[224:239], v[168:171], a[44:47], 0
    v_mfma_f32_32x32x16_bf16 v[224:239], v[172:175], a[108:111], v[224:239]
    s_add_u32 s44, s43, 25600
    s_mov_b32 m0, s44
    s_add_u32 s46, s42, 25600
    buffer_load_dwordx4 v5, s[28:31], s46 offen lds
    s_add_u32 s44, s43, 26624
    s_mov_b32 m0, s44
    s_add_u32 s46, s42, 26624
    buffer_load_dwordx4 v5, s[28:31], s46 offen lds
    s_add_u32 s44, s43, 36864
    s_mov_b32 m0, s44
    s_add_u32 s46, s42, 36864
    buffer_load_dwordx4 v5, s[28:31], s46 offen lds
    s_add_u32 s44, s43, 37888
    s_mov_b32 m0, s44
    s_add_u32 s46, s42, 37888
    buffer_load_dwordx4 v5, s[28:31], s46 offen lds
    v_mov_b32 v8, v186
    v_mov_b32 v9, v202
    s_nop 1
    v_permlane32_swap_b32 v8, v186
    v_permlane32_swap_b32 v9, v202
    s_nop 1
    v_add_f32 v8, s52, v8
    v_add_f32 v9, s52, v9
    v_rcp_f32 v8, v8
    v_rcp_f32 v9, v9
    s_nop 0
    v_mul_f32 v176, v176, v8
    v_mul_f32 v177, v177, v8
    v_mul_f32 v178, v178, v8
    v_mul_f32 v179, v179, v8
    v_mul_f32 v180, v180, v8
    v_mul_f32 v181, v181, v8
    v_mul_f32 v182, v182, v8
    v_mul_f32 v183, v183, v8
    v_mul_f32 v184, v184, v8
    v_mul_f32 v185, v185, v8
    v_cvt_pk_bf16_f32 v48, v176, v177
    v_cvt_pk_bf16_f32 v49, v178, v179
    v_cvt_pk_bf16_f32 v50, v180, v181
    v_cvt_pk_bf16_f32 v51, v182, v183
    v_cvt_pk_bf16_f32 v88, v184, v185
    v_mul_f32 v192, v192, v9
    v_mul_f32 v193, v193, v9
    v_mul_f32 v194, v194, v9
    v_mul_f32 v195, v195, v9
    v_mul_f32 v196, v196, v9
    v_mul_f32 v197, v197, v9
    v_mul_f32 v198, v198, v9
    v_mul_f32 v199, v199, v9
    v_mul_f32 v200, v200, v9
    v_mul_f32 v201, v201, v9
    v_cvt_pk_bf16_f32 v52, v192, v193
    v_cvt_pk_bf16_f32 v53, v194, v195
    v_cvt_pk_bf16_f32 v54, v196, v197
    v_cvt_pk_bf16_f32 v55, v198, v199
    v_cvt_pk_bf16_f32 v89, v200, v201
    ds_read_b128 v[144:147], v10 offset:15360
    ds_read_b32 v148, v11 offset:16384
    ds_read_b128 v[152:155], v10 offset:16640
    ds_read_b32 v156, v11 offset:17664
    s_waitcnt lgkmcnt(0)
    s_waitcnt vmcnt(24)
    v_mfma_f32_32x32x16_bf16 v[176:191], v[144:147], a[48:51], 0
    v_mfma_f32_32x32x16_bf16 v[176:191], v[148:151], a[112:115], v[176:191]
    v_mfma_f32_32x32x16_bf16 v[192:207], v[152:155], a[52:55], 0
    v_mfma_f32_32x32x16_bf16 v[192:207], v[156:159], a[116:119], v[192:207]
    s_add_u32 s44, s43, 38912
    s_mov_b32 m0, s44
    s_add_u32 s46, s42, 38912
    buffer_load_dwordx4 v5, s[28:31], s46 offen lds
    s_add_u32 s44, s43, 39936
    s_mov_b32 m0, s44
    s_add_u32 s46, s42, 39936
    buffer_load_dwordx4 v5, s[28:31], s46 offen lds
    s_add_u32 s44, s43, 40960
    s_mov_b32 m0, s44
    s_add_u32 s46, s42, 40960
    buffer_load_dwordx4 v5, s[28:31], s46 offen lds
    s_add_u32 s44, s43, 41984
    s_mov_b32 m0, s44
    s_add_u32 s46, s42, 41984
    buffer_load_dwordx4 v5, s[28:31], s46 offen lds
    v_mov_b32 v8, v218
    v_mov_b32 v9, v234
    s_nop 1
    v_permlane32_swap_b32 v8, v218
    v_permlane32_swap_b32 v9, v234
    s_nop 1
    v_add_f32 v8, s52, v8
    v_add_f32 v9, s52, v9
    v_rcp_f32 v8, v8
    v_rcp_f32 v9, v9
    s_nop 0
    v_mul_f32 v208, v208, v8
    v_mul_f32 v209, v209, v8
    v_mul_f32 v210, v210, v8
    v_mul_f32 v211, v211, v8
    v_mul_f32 v212, v212, v8
    v_mul_f32 v213, v213, v8
    v_mul_f32 v214, v214, v8
    v_mul_f32 v215, v215, v8
    v_mul_f32 v216, v216, v8
    v_mul_f32 v217, v217, v8
    v_cvt_pk_bf16_f32 v56, v208, v209
    v_cvt_pk_bf16_f32 v57, v210, v211
    v_cvt_pk_bf16_f32 v58, v212, v213
    v_cvt_pk_bf16_f32 v59, v214, v215
    v_cvt_pk_bf16_f32 v90, v216, v217
    v_mul_f32 v224, v224, v9
    v_mul_f32 v225, v225, v9
    v_mul_f32 v226, v226, v9
    v_mul_f32 v227, v227, v9
    v_mul_f32 v228, v228, v9
    v_mul_f32 v229, v229, v9
    v_mul_f32 v230, v230, v9
    v_mul_f32 v231, v231, v9
    v_mul_f32 v232, v232, v9
    v_mul_f32 v233, v233, v9
    v_cvt_pk_bf16_f32 v60, v224, v225
    v_cvt_pk_bf16_f32 v61, v226, v227
    v_cvt_pk_bf16_f32 v62, v228, v229
    v_cvt_pk_bf16_f32 v63, v230, v231
    v_cvt_pk_bf16_f32 v91, v232, v233
    ds_read_b128 v[160:163], v10 offset:17920
    ds_read_b32 v164, v11 offset:18944
    ds_read_b128 v[168:171], v10 offset:19200
    ds_read_b32 v172, v11 offset:20224
    s_waitcnt lgkmcnt(0)
    s_waitcnt vmcnt(24)
    v_mfma_f32_32x32x16_bf16 v[208:223], v[160:163], a[56:59], 0
    v_mfma_f32_32x32x16_bf16 v[208:223], v[164:167], a[120:123], v[208:223]
    v_mfma_f32_32x32x16_bf16 v[224:239], v[168:171], a[60:63], 0
    v_mfma_f32_32x32x16_bf16 v[224:239], v[172:175], a[124:127], v[224:239]
    s_add_u32 s44, s43, 43008
    s_mov_b32 m0, s44
    s_add_u32 s46, s42, 43008
    buffer_load_dwordx4 v5, s[28:31], s46 offen lds
    s_add_u32 s44, s43, 44032
    s_mov_b32 m0, s44
    s_add_u32 s46, s42, 44032
    buffer_load_dwordx4 v5, s[28:31], s46 offen lds
    s_add_u32 s44, s43, 45056
    s_mov_b32 m0, s44
    s_add_u32 s46, s42, 45056
    buffer_load_dwordx4 v5, s[28:31], s46 offen lds
    v_mov_b32 v8, v186
    v_mov_b32 v9, v202
    s_nop 1
    v_permlane32_swap_b32 v8, v186
    v_permlane32_swap_b32 v9, v202
    s_nop 1
    v_add_f32 v8, s52, v8
    v_add_f32 v9, s52, v9
    v_rcp_f32 v8, v8
    v_rcp_f32 v9, v9
    s_nop 0
    v_mul_f32 v176, v176, v8
    v_mul_f32 v177, v177, v8
    v_mul_f32 v178, v178, v8
    v_mul_f32 v179, v179, v8
    v_mul_f32 v180, v180, v8
    v_mul_f32 v181, v181, v8
    v_mul_f32 v182, v182, v8
    v_mul_f32 v183, v183, v8
    v_mul_f32 v184, v184, v8
    v_mul_f32 v185, v185, v8
    v_cvt_pk_bf16_f32 v64, v176, v177
    v_cvt_pk_bf16_f32 v65, v178, v179
    v_cvt_pk_bf16_f32 v66, v180, v181
    v_cvt_pk_bf16_f32 v67, v182, v183
    v_cvt_pk_bf16_f32 v92, v184, v185
    v_mul_f32 v192, v192, v9
    v_mul_f32 v193, v193, v9
    v_mul_f32 v194, v194, v9
    v_mul_f32 v195, v195, v9
    v_mul_f32 v196, v196, v9
    v_mul_f32 v197, v197, v9
    v_mul_f32 v198, v198, v9
    v_mul_f32 v199, v199, v9
    v_mul_f32 v200, v200, v9
    v_mul_f32 v201, v201, v9
    v_cvt_pk_bf16_f32 v68, v192, v193
    v_cvt_pk_bf16_f32 v69, v194, v195
    v_cvt_pk_bf16_f32 v70, v196, v197
    v_cvt_pk_bf16_f32 v71, v198, v199
    v_cvt_pk_bf16_f32 v93, v200, v201
    s_nop 11
    v_mov_b32 v8, v218
    v_mov_b32 v9, v234
    s_nop 1
    v_permlane32_swap_b32 v8, v218
    v_permlane32_swap_b32 v9, v234
    s_nop 1
    v_add_f32 v8, s52, v8
    v_add_f32 v9, s52, v9
    v_rcp_f32 v8, v8
    v_rcp_f32 v9, v9
    s_nop 0
    v_mul_f32 v208, v208, v8
    v_mul_f32 v209, v209, v8
    v_mul_f32 v210, v210, v8
    v_mul_f32 v211, v211, v8
    v_mul_f32 v212, v212, v8
    v_mul_f32 v213, v213, v8
    v_mul_f32 v214, v214, v8
    v_mul_f32 v215, v215, v8
    v_mul_f32 v216, v216, v8
    v_mul_f32 v217, v217, v8
    v_cvt_pk_bf16_f32 v72, v208, v209
    v_cvt_pk_bf16_f32 v73, v210, v211
    v_cvt_pk_bf16_f32 v74, v212, v213
    v_cvt_pk_bf16_f32 v75, v214, v215
    v_cvt_pk_bf16_f32 v94, v216, v217
    v_mul_f32 v224, v224, v9
    v_mul_f32 v225, v225, v9
    v_mul_f32 v226, v226, v9
    v_mul_f32 v227, v227, v9
    v_mul_f32 v228, v228, v9
    v_mul_f32 v229, v229, v9
    v_mul_f32 v230, v230, v9
    v_mul_f32 v231, v231, v9
    v_mul_f32 v232, v232, v9
    v_mul_f32 v233, v233, v9
    v_cvt_pk_bf16_f32 v76, v224, v225
    v_cvt_pk_bf16_f32 v77, v226, v227
    v_cvt_pk_bf16_f32 v78, v228, v229
    v_cvt_pk_bf16_f32 v79, v230, v231
    v_cvt_pk_bf16_f32 v95, v232, v233
    s_nop 1
    v_permlane32_swap_b32 v80, v84
    v_permlane32_swap_b32 v81, v85
    v_permlane32_swap_b32 v82, v86
    v_permlane32_swap_b32 v83, v87
    v_permlane32_swap_b32 v88, v92
    v_permlane32_swap_b32 v89, v93
    v_permlane32_swap_b32 v90, v94
    v_permlane32_swap_b32 v91, v95
    s_waitcnt vmcnt(18)
    s_barrier
    ds_read_b128 v[120:123], v14 offset:0
    ds_read_b128 v[124:127], v14 offset:1024
    ds_read_b128 v[128:131], v14 offset:2048
    ds_read_b128 v[132:135], v14 offset:3072
    ds_read_b128 v[136:139], v14 offset:4096
    ds_read_b128 v[140:143], v14 offset:5120
    s_waitcnt lgkmcnt(5)
    v_mfma_f32_32x32x16_bf16 v[144:159], v[120:123], v[16:19], 0
    ds_read_b128 v[120:123], v14 offset:6144
    buffer_load_dwordx2 v[96:97], v6, s[28:31], s19 offen offset:0
    buffer_load_dwordx2 v[98:99], v6, s[28:31], s19 offen offset:256
    s_waitcnt lgkmcnt(5)
    v_mfma_f32_32x32x16_bf16 v[160:175], v[124:127], v[16:19], 0
    ds_read_b128 v[124:127], v14 offset:7168
    buffer_load_dwordx2 v[100:101], v6, s[28:31], s19 offen offset:512
    buffer_load_dwordx2 v[102:103], v6, s[28:31], s19 offen offset:768
    s_waitcnt lgkmcnt(5)
    v_mfma_f32_32x32x16_bf16 v[176:191], v[128:131], v[16:19], 0
    ds_read_b128 v[128:131], v14 offset:8192
    buffer_load_dwordx2 v[104:105], v6, s[28:31], s19 offen offset:1024
    buffer_load_dwordx2 v[106:107], v6, s[28:31], s19 offen offset:1280
    s_waitcnt lgkmcnt(5)
    v_mfma_f32_32x32x16_bf16 v[144:159], v[132:135], v[20:23], v[144:159]
    ds_read_b128 v[132:135], v14 offset:9216
    buffer_load_dwordx2 v[108:109], v6, s[28:31], s19 offen offset:1536
    buffer_load_dwordx2 v[110:111], v6, s[28:31], s19 offen offset:1792
    s_waitcnt lgkmcnt(5)
    v_mfma_f32_32x32x16_bf16 v[160:175], v[136:139], v[20:23], v[160:175]
    ds_read_b128 v[136:139], v14 offset:10240
    buffer_load_dwordx2 v[112:113], v6, s[28:31], s19 offen offset:2048
    buffer_load_dwordx2 v[114:115], v6, s[28:31], s19 offen offset:2304
    s_waitcnt lgkmcnt(5)
    v_mfma_f32_32x32x16_bf16 v[176:191], v[140:143], v[20:23], v[176:191]
    ds_read_b128 v[140:143], v14 offset:11264
    buffer_load_dwordx2 v[116:117], v6, s[28:31], s19 offen offset:2560
    buffer_load_dwordx2 v[118:119], v6, s[28:31], s19 offen offset:2816
    s_waitcnt lgkmcnt(5)
    v_mfma_f32_32x32x16_bf16 v[144:159], v[120:123], v[24:27], v[144:159]
    ds_read_b128 v[120:123], v14 offset:12288
    s_waitcnt lgkmcnt(5)
    v_mfma_f32_32x32x16_bf16 v[160:175], v[124:127], v[24:27], v[160:175]
    ds_read_b128 v[124:127], v14 offset:13312
    s_waitcnt lgkmcnt(5)
    v_mfma_f32_32x32x16_bf16 v[176:191], v[128:131], v[24:27], v[176:191]
    ds_read_b128 v[128:131], v14 offset:14336
    s_waitcnt lgkmcnt(5)
    v_mfma_f32_32x32x16_bf16 v[144:159], v[132:135], v[28:31], v[144:159]
    ds_read_b128 v[132:135], v14 offset:15360
    s_waitcnt lgkmcnt(5)
    v_mfma_f32_32x32x16_bf16 v[160:175], v[136:139], v[28:31], v[160:175]
    ds_read_b128 v[136:139], v14 offset:16384
    s_waitcnt lgkmcnt(5)
    v_mfma_f32_32x32x16_bf16 v[176:191], v[140:143], v[28:31], v[176:191]
    ds_read_b128 v[140:143], v14 offset:17408
    s_waitcnt lgkmcnt(5)
    v_mfma_f32_32x32x16_bf16 v[144:159], v[120:123], v[32:35], v[144:159]
    s_waitcnt lgkmcnt(4)
    v_mfma_f32_32x32x16_bf16 v[160:175], v[124:127], v[32:35], v[160:175]
    s_waitcnt lgkmcnt(3)
    v_mfma_f32_32x32x16_bf16 v[176:191], v[128:131], v[32:35], v[176:191]
    s_waitcnt lgkmcnt(2)
    v_mfma_f32_32x32x16_bf16 v[144:159], v[132:135], v[36:39], v[144:159]
    s_waitcnt lgkmcnt(1)
    v_mfma_f32_32x32x16_bf16 v[160:175], v[136:139], v[36:39], v[160:175]
    s_waitcnt lgkmcnt(0)
    v_mfma_f32_32x32x16_bf16 v[176:191], v[140:143], v[36:39], v[176:191]
    s_waitcnt vmcnt(21)
    s_barrier
    ds_read_b128 v[120:123], v14 offset:18432
    ds_read_b128 v[124:127], v14 offset:19456
    ds_read_b128 v[128:131], v14 offset:20480
    ds_read_b128 v[132:135], v14 offset:21504
    ds_read_b128 v[136:139], v14 offset:22528
    ds_read_b128 v[140:143], v14 offset:23552
    s_waitcnt lgkmcnt(5)
    v_mfma_f32_32x32x16_bf16 v[144:159], v[120:123], v[40:43], v[144:159]
    ds_read_b128 v[120:123], v14 offset:24576
    s_waitcnt lgkmcnt(5)
    v_mfma_f32_32x32x16_bf16 v[160:175], v[124:127], v[40:43], v[160:175]
    ds_read_b128 v[124:127], v14 offset:25600
    s_waitcnt lgkmcnt(5)
    v_mfma_f32_32x32x16_bf16 v[176:191], v[128:131], v[40:43], v[176:191]
    ds_read_b128 v[128:131], v14 offset:26624
    s_waitcnt lgkmcnt(5)
    v_mfma_f32_32x32x16_bf16 v[144:159], v[132:135], v[44:47], v[144:159]
    ds_read_b128 v[132:135], v14 offset:27648
    s_waitcnt lgkmcnt(5)
    v_mfma_f32_32x32x16_bf16 v[160:175], v[136:139], v[44:47], v[160:175]
    ds_read_b128 v[136:139], v14 offset:28672
    s_waitcnt lgkmcnt(5)
    v_mfma_f32_32x32x16_bf16 v[176:191], v[140:143], v[44:47], v[176:191]
    ds_read_b128 v[140:143], v14 offset:29696
    s_waitcnt lgkmcnt(5)
    v_mfma_f32_32x32x16_bf16 v[144:159], v[120:123], v[48:51], v[144:159]
    ds_read_b128 v[120:123], v14 offset:30720
    s_waitcnt lgkmcnt(5)
    v_mfma_f32_32x32x16_bf16 v[160:175], v[124:127], v[48:51], v[160:175]
    ds_read_b128 v[124:127], v14 offset:31744
    s_waitcnt lgkmcnt(5)
    v_mfma_f32_32x32x16_bf16 v[176:191], v[128:131], v[48:51], v[176:191]
    ds_read_b128 v[128:131], v14 offset:32768
    s_waitcnt lgkmcnt(5)
    v_mfma_f32_32x32x16_bf16 v[144:159], v[132:135], v[52:55], v[144:159]
    ds_read_b128 v[132:135], v14 offset:33792
    s_waitcnt lgkmcnt(5)
    v_mfma_f32_32x32x16_bf16 v[160:175], v[136:139], v[52:55], v[160:175]
    ds_read_b128 v[136:139], v14 offset:34816
    s_waitcnt lgkmcnt(5)
    v_mfma_f32_32x32x16_bf16 v[176:191], v[140:143], v[52:55], v[176:191]
    ds_read_b128 v[140:143], v14 offset:35840
    s_waitcnt lgkmcnt(5)
    v_mfma_f32_32x32x16_bf16 v[144:159], v[120:123], v[56:59], v[144:159]
    s_waitcnt lgkmcnt(4)
    v_mfma_f32_32x32x16_bf16 v[160:175], v[124:127], v[56:59], v[160:175]
    s_waitcnt lgkmcnt(3)
    v_mfma_f32_32x32x16_bf16 v[176:191], v[128:131], v[56:59], v[176:191]
    s_waitcnt lgkmcnt(2)
    v_mfma_f32_32x32x16_bf16 v[144:159], v[132:135], v[60:63], v[144:159]
    s_waitcnt lgkmcnt(1)
    v_mfma_f32_32x32x16_bf16 v[160:175], v[136:139], v[60:63], v[160:175]
    s_waitcnt lgkmcnt(0)
    v_mfma_f32_32x32x16_bf16 v[176:191], v[140:143], v[60:63], v[176:191]
    s_waitcnt vmcnt(12)
    s_barrier
    ds_read_b128 v[120:123], v14 offset:36864
    ds_read_b128 v[124:127], v14 offset:37888
    ds_read_b128 v[128:131], v14 offset:38912
    ds_read_b128 v[132:135], v14 offset:39936
    ds_read_b128 v[136:139], v14 offset:40960
    ds_read_b128 v[140:143], v14 offset:41984
    s_waitcnt lgkmcnt(5)
    v_mfma_f32_32x32x16_bf16 v[144:159], v[120:123], v[64:67], v[144:159]
    ds_read_b128 v[120:123], v14 offset:43008
    s_waitcnt lgkmcnt(5)
    v_mfma_f32_32x32x16_bf16 v[160:175], v[124:127], v[64:67], v[160:175]
    ds_read_b128 v[124:127], v14 offset:44032
    s_waitcnt lgkmcnt(5)
    v_mfma_f32_32x32x16_bf16 v[176:191], v[128:131], v[64:67], v[176:191]
    ds_read_b128 v[128:131], v14 offset:45056
    s_waitcnt lgkmcnt(5)
    v_mfma_f32_32x32x16_bf16 v[144:159], v[132:135], v[68:71], v[144:159]
    ds_read_b128 v[132:135], v14 offset:46080
    s_waitcnt lgkmcnt(5)
    v_mfma_f32_32x32x16_bf16 v[160:175], v[136:139], v[68:71], v[160:175]
    ds_read_b128 v[136:139], v14 offset:47104
    s_waitcnt lgkmcnt(5)
    v_mfma_f32_32x32x16_bf16 v[176:191], v[140:143], v[68:71], v[176:191]
    ds_read_b128 v[140:143], v14 offset:48128
    s_waitcnt lgkmcnt(5)
    v_mfma_f32_32x32x16_bf16 v[144:159], v[120:123], v[72:75], v[144:159]
    ds_read_b128 v[120:123], v14 offset:49152
    s_waitcnt lgkmcnt(5)
    v_mfma_f32_32x32x16_bf16 v[160:175], v[124:127], v[72:75], v[160:175]
    ds_read_b128 v[124:127], v14 offset:50176
    s_waitcnt lgkmcnt(5)
    v_mfma_f32_32x32x16_bf16 v[176:191], v[128:131], v[72:75], v[176:191]
    ds_read_b128 v[128:131], v14 offset:51200
    s_waitcnt lgkmcnt(5)
    v_mfma_f32_32x32x16_bf16 v[144:159], v[132:135], v[76:79], v[144:159]
    ds_read_b128 v[132:135], v14 offset:52224
    s_waitcnt lgkmcnt(5)
    v_mfma_f32_32x32x16_bf16 v[160:175], v[136:139], v[76:79], v[160:175]
    ds_read_b128 v[136:139], v14 offset:53248
    s_waitcnt lgkmcnt(5)
    v_mfma_f32_32x32x16_bf16 v[176:191], v[140:143], v[76:79], v[176:191]
    ds_read_b128 v[140:143], v14 offset:54272
    s_waitcnt lgkmcnt(5)
    v_mfma_f32_32x32x16_bf16 v[144:159], v[120:123], v[80:83], v[144:159]
    s_waitcnt lgkmcnt(4)
    v_mfma_f32_32x32x16_bf16 v[160:175], v[124:127], v[80:83], v[160:175]
    s_waitcnt lgkmcnt(3)
    v_mfma_f32_32x32x16_bf16 v[176:191], v[128:131], v[80:83], v[176:191]
    s_waitcnt lgkmcnt(2)
    v_mfma_f32_32x32x16_bf16 v[144:159], v[132:135], v[88:91], v[144:159]
    s_waitcnt lgkmcnt(1)
    v_mfma_f32_32x32x16_bf16 v[160:175], v[136:139], v[88:91], v[160:175]
    s_waitcnt lgkmcnt(0)
    v_mfma_f32_32x32x16_bf16 v[176:191], v[140:143], v[88:91], v[176:191]
    s_mul_i32 s44, s15, 12288
    s_add_u32 s44, s44, 110592
    v_add_u32 v10, s44, v5
    s_cmp_eq_u32 s16, 0
    s_cbranch_scc1 outa1_kernel_k0
    s_nop 11
    ds_write_b128 v10, v[144:147] offset:0
    ds_write_b128 v10, v[148:151] offset:1024
    ds_write_b128 v10, v[152:155] offset:2048
    ds_write_b128 v10, v[156:159] offset:3072
    ds_write_b128 v10, v[160:163] offset:4096
    ds_write_b128 v10, v[164:167] offset:5120
    ds_write_b128 v10, v[168:171] offset:6144
    ds_write_b128 v10, v[172:175] offset:7168
    ds_write_b128 v10, v[176:179] offset:8192
    ds_write_b128 v10, v[180:183] offset:9216
    ds_write_b128 v10, v[184:187] offset:10240
    ds_write_b128 v10, v[188:191] offset:11264
    s_waitcnt lgkmcnt(0)
    s_barrier
    s_endpgm
outa1_kernel_k0:
    s_add_u32 s44, s18, 0x240000
    s_waitcnt vmcnt(0)
    v_lshlrev_b32 v16, 16, v96
    v_and_b32 v17, 0xffff0000, v96
    v_lshlrev_b32 v18, 16, v97
    v_and_b32 v19, 0xffff0000, v97
    v_lshlrev_b32 v20, 16, v98
    v_and_b32 v21, 0xffff0000, v98
    v_lshlrev_b32 v22, 16, v99
    v_and_b32 v23, 0xffff0000, v99
    v_lshlrev_b32 v24, 16, v100
    v_and_b32 v25, 0xffff0000, v100
    v_lshlrev_b32 v26, 16, v101
    v_and_b32 v27, 0xffff0000, v101
    v_lshlrev_b32 v28, 16, v102
    v_and_b32 v29, 0xffff0000, v102
    v_lshlrev_b32 v30, 16, v103
    v_and_b32 v31, 0xffff0000, v103
    v_lshlrev_b32 v32, 16, v104
    v_and_b32 v33, 0xffff0000, v104
    v_lshlrev_b32 v34, 16, v105
    v_and_b32 v35, 0xffff0000, v105
    v_lshlrev_b32 v36, 16, v106
    v_and_b32 v37, 0xffff0000, v106
    v_lshlrev_b32 v38, 16, v107
    v_and_b32 v39, 0xffff0000, v107
    v_lshlrev_b32 v40, 16, v108
    v_and_b32 v41, 0xffff0000, v108
    v_lshlrev_b32 v42, 16, v109
    v_and_b32 v43, 0xffff0000, v109
    v_lshlrev_b32 v44, 16, v110
    v_and_b32 v45, 0xffff0000, v110
    v_lshlrev_b32 v46, 16, v111
    v_and_b32 v47, 0xffff0000, v111
    v_lshlrev_b32 v48, 16, v112
    v_and_b32 v49, 0xffff0000, v112
    v_lshlrev_b32 v50, 16, v113
    v_and_b32 v51, 0xffff0000, v113
    v_lshlrev_b32 v52, 16, v114
    v_and_b32 v53, 0xffff0000, v114
    v_lshlrev_b32 v54, 16, v115
    v_and_b32 v55, 0xffff0000, v115
    v_lshlrev_b32 v56, 16, v116
    v_and_b32 v57, 0xffff0000, v116
    v_lshlrev_b32 v58, 16, v117
    v_and_b32 v59, 0xffff0000, v117
    v_lshlrev_b32 v60, 16, v118
    v_and_b32 v61, 0xffff0000, v118
    v_lshlrev_b32 v62, 16, v119
    v_and_b32 v63, 0xffff0000, v119
    v_add_f32 v144, v144, v16
    v_add_f32 v145, v145, v17
    v_add_f32 v146, v146, v18
    v_add_f32 v147, v147, v19
    v_add_f32 v148, v148, v20
    v_add_f32 v149, v149, v21
    v_add_f32 v150, v150, v22
    v_add_f32 v151, v151, v23
    v_add_f32 v152, v152, v24
    v_add_f32 v153, v153, v25
    v_add_f32 v154, v154, v26
    v_add_f32 v155, v155, v27
    v_add_f32 v156, v156, v28
    v_add_f32 v157, v157, v29
    v_add_f32 v158, v158, v30
    v_add_f32 v159, v159, v31
    v_add_f32 v160, v160, v32
    v_add_f32 v161, v161, v33
    v_add_f32 v162, v162, v34
    v_add_f32 v163, v163, v35
    v_add_f32 v164, v164, v36
    v_add_f32 v165, v165, v37
    v_add_f32 v166, v166, v38
    v_add_f32 v167, v167, v39
    v_add_f32 v168, v168, v40
    v_add_f32 v169, v169, v41
    v_add_f32 v170, v170, v42
    v_add_f32 v171, v171, v43
    v_add_f32 v172, v172, v44
    v_add_f32 v173, v173, v45
    v_add_f32 v174, v174, v46
    v_add_f32 v175, v175, v47
    v_add_f32 v176, v176, v48
    v_add_f32 v177, v177, v49
    v_add_f32 v178, v178, v50
    v_add_f32 v179, v179, v51
    v_add_f32 v180, v180, v52
    v_add_f32 v181, v181, v53
    v_add_f32 v182, v182, v54
    v_add_f32 v183, v183, v55
    v_add_f32 v184, v184, v56
    v_add_f32 v185, v185, v57
    v_add_f32 v186, v186, v58
    v_add_f32 v187, v187, v59
    v_add_f32 v188, v188, v60
    v_add_f32 v189, v189, v61
    v_add_f32 v190, v190, v62
    v_add_f32 v191, v191, v63
    s_barrier
    ds_read_b128 v[192:195], v10 offset:0
    ds_read_b128 v[196:199], v10 offset:1024
    ds_read_b128 v[200:203], v10 offset:2048
    ds_read_b128 v[204:207], v10 offset:3072
    ds_read_b128 v[208:211], v10 offset:4096
    ds_read_b128 v[212:215], v10 offset:5120
    ds_read_b128 v[216:219], v10 offset:6144
    ds_read_b128 v[220:223], v10 offset:7168
    ds_read_b128 v[224:227], v10 offset:8192
    ds_read_b128 v[228:231], v10 offset:9216
    ds_read_b128 v[232:235], v10 offset:10240
    ds_read_b128 v[236:239], v10 offset:11264
    v_mov_b32 v8, 0
    v_mov_b32 v9, 0
    v_mov_b32 v11, 0x3f803f80
    s_waitcnt lgkmcnt(11)
    v_add_f32 v144, v144, v192
    v_add_f32 v145, v145, v193
    v_add_f32 v146, v146, v194
    v_add_f32 v147, v147, v195
    v_cvt_pk_bf16_f32 v96, v144, v145
    v_cvt_pk_bf16_f32 v97, v146, v147
    buffer_store_dwordx2 v[96:97], v6, s[28:31], s44 offen offset:0 sc1
    v_dot2_f32_bf16 v8, v96, v11, v8
    v_dot2_f32_bf16 v9, v96, v96, v9
    v_dot2_f32_bf16 v8, v97, v11, v8
    v_dot2_f32_bf16 v9, v97, v97, v9
    s_waitcnt lgkmcnt(10)
    v_add_f32 v148, v148, v196
    v_add_f32 v149, v149, v197
    v_add_f32 v150, v150, v198
    v_add_f32 v151, v151, v199
    v_cvt_pk_bf16_f32 v98, v148, v149
    v_cvt_pk_bf16_f32 v99, v150, v151
    buffer_store_dwordx2 v[98:99], v6, s[28:31], s44 offen offset:256 sc1
    v_dot2_f32_bf16 v8, v98, v11, v8
    v_dot2_f32_bf16 v9, v98, v98, v9
    v_dot2_f32_bf16 v8, v99, v11, v8
    v_dot2_f32_bf16 v9, v99, v99, v9
    s_waitcnt lgkmcnt(9)
    v_add_f32 v152, v152, v200
    v_add_f32 v153, v153, v201
    v_add_f32 v154, v154, v202
    v_add_f32 v155, v155, v203
    v_cvt_pk_bf16_f32 v100, v152, v153
    v_cvt_pk_bf16_f32 v101, v154, v155
    buffer_store_dwordx2 v[100:101], v6, s[28:31], s44 offen offset:512 sc1
    v_dot2_f32_bf16 v8, v100, v11, v8
    v_dot2_f32_bf16 v9, v100, v100, v9
    v_dot2_f32_bf16 v8, v101, v11, v8
    v_dot2_f32_bf16 v9, v101, v101, v9
    s_waitcnt lgkmcnt(8)
    v_add_f32 v156, v156, v204
    v_add_f32 v157, v157, v205
    v_add_f32 v158, v158, v206
    v_add_f32 v159, v159, v207
    v_cvt_pk_bf16_f32 v102, v156, v157
    v_cvt_pk_bf16_f32 v103, v158, v159
    buffer_store_dwordx2 v[102:103], v6, s[28:31], s44 offen offset:768 sc1
    v_dot2_f32_bf16 v8, v102, v11, v8
    v_dot2_f32_bf16 v9, v102, v102, v9
    v_dot2_f32_bf16 v8, v103, v11, v8
    v_dot2_f32_bf16 v9, v103, v103, v9
    s_waitcnt lgkmcnt(7)
    v_add_f32 v160, v160, v208
    v_add_f32 v161, v161, v209
    v_add_f32 v162, v162, v210
    v_add_f32 v163, v163, v211
    v_cvt_pk_bf16_f32 v104, v160, v161
    v_cvt_pk_bf16_f32 v105, v162, v163
    buffer_store_dwordx2 v[104:105], v6, s[28:31], s44 offen offset:1024 sc1
    v_dot2_f32_bf16 v8, v104, v11, v8
    v_dot2_f32_bf16 v9, v104, v104, v9
    v_dot2_f32_bf16 v8, v105, v11, v8
    v_dot2_f32_bf16 v9, v105, v105, v9
    s_waitcnt lgkmcnt(6)
    v_add_f32 v164, v164, v212
    v_add_f32 v165, v165, v213
    v_add_f32 v166, v166, v214
    v_add_f32 v167, v167, v215
    v_cvt_pk_bf16_f32 v106, v164, v165
    v_cvt_pk_bf16_f32 v107, v166, v167
    buffer_store_dwordx2 v[106:107], v6, s[28:31], s44 offen offset:1280 sc1
    v_dot2_f32_bf16 v8, v106, v11, v8
    v_dot2_f32_bf16 v9, v106, v106, v9
    v_dot2_f32_bf16 v8, v107, v11, v8
    v_dot2_f32_bf16 v9, v107, v107, v9
    s_waitcnt lgkmcnt(5)
    v_add_f32 v168, v168, v216
    v_add_f32 v169, v169, v217
    v_add_f32 v170, v170, v218
    v_add_f32 v171, v171, v219
    v_cvt_pk_bf16_f32 v108, v168, v169
    v_cvt_pk_bf16_f32 v109, v170, v171
    buffer_store_dwordx2 v[108:109], v6, s[28:31], s44 offen offset:1536 sc1
    v_dot2_f32_bf16 v8, v108, v11, v8
    v_dot2_f32_bf16 v9, v108, v108, v9
    v_dot2_f32_bf16 v8, v109, v11, v8
    v_dot2_f32_bf16 v9, v109, v109, v9
    s_waitcnt lgkmcnt(4)
    v_add_f32 v172, v172, v220
    v_add_f32 v173, v173, v221
    v_add_f32 v174, v174, v222
    v_add_f32 v175, v175, v223
    v_cvt_pk_bf16_f32 v110, v172, v173
    v_cvt_pk_bf16_f32 v111, v174, v175
    buffer_store_dwordx2 v[110:111], v6, s[28:31], s44 offen offset:1792 sc1
    v_dot2_f32_bf16 v8, v110, v11, v8
    v_dot2_f32_bf16 v9, v110, v110, v9
    v_dot2_f32_bf16 v8, v111, v11, v8
    v_dot2_f32_bf16 v9, v111, v111, v9
    s_waitcnt lgkmcnt(3)
    v_add_f32 v176, v176, v224
    v_add_f32 v177, v177, v225
    v_add_f32 v178, v178, v226
    v_add_f32 v179, v179, v227
    v_cvt_pk_bf16_f32 v112, v176, v177
    v_cvt_pk_bf16_f32 v113, v178, v179
    buffer_store_dwordx2 v[112:113], v6, s[28:31], s44 offen offset:2048 sc1
    v_dot2_f32_bf16 v8, v112, v11, v8
    v_dot2_f32_bf16 v9, v112, v112, v9
    v_dot2_f32_bf16 v8, v113, v11, v8
    v_dot2_f32_bf16 v9, v113, v113, v9
    s_waitcnt lgkmcnt(2)
    v_add_f32 v180, v180, v228
    v_add_f32 v181, v181, v229
    v_add_f32 v182, v182, v230
    v_add_f32 v183, v183, v231
    v_cvt_pk_bf16_f32 v114, v180, v181
    v_cvt_pk_bf16_f32 v115, v182, v183
    buffer_store_dwordx2 v[114:115], v6, s[28:31], s44 offen offset:2304 sc1
    v_dot2_f32_bf16 v8, v114, v11, v8
    v_dot2_f32_bf16 v9, v114, v114, v9
    v_dot2_f32_bf16 v8, v115, v11, v8
    v_dot2_f32_bf16 v9, v115, v115, v9
    s_waitcnt lgkmcnt(1)
    v_add_f32 v184, v184, v232
    v_add_f32 v185, v185, v233
    v_add_f32 v186, v186, v234
    v_add_f32 v187, v187, v235
    v_cvt_pk_bf16_f32 v116, v184, v185
    v_cvt_pk_bf16_f32 v117, v186, v187
    buffer_store_dwordx2 v[116:117], v6, s[28:31], s44 offen offset:2560 sc1
    v_dot2_f32_bf16 v8, v116, v11, v8
    v_dot2_f32_bf16 v9, v116, v116, v9
    v_dot2_f32_bf16 v8, v117, v11, v8
    v_dot2_f32_bf16 v9, v117, v117, v9
    s_waitcnt lgkmcnt(0)
    v_add_f32 v188, v188, v236
    v_add_f32 v189, v189, v237
    v_add_f32 v190, v190, v238
    v_add_f32 v191, v191, v239
    v_cvt_pk_bf16_f32 v118, v188, v189
    v_cvt_pk_bf16_f32 v119, v190, v191
    buffer_store_dwordx2 v[118:119], v6, s[28:31], s44 offen offset:2816 sc1
    v_dot2_f32_bf16 v8, v118, v11, v8
    v_dot2_f32_bf16 v9, v118, v118, v9
    v_dot2_f32_bf16 v8, v119, v11, v8
    v_dot2_f32_bf16 v9, v119, v119, v9
    s_nop 3
    v_mov_b32 v12, v8
    v_mov_b32 v13, v9
    s_nop 1
    v_permlane32_swap_b32 v8, v12
    v_permlane32_swap_b32 v9, v13
    s_nop 1
    v_add_f32 v8, v8, v12
    v_add_f32 v9, v9, v13
    s_lshl_b32 s44, s17, 5
    v_add_u32 v7, s44, v3
    v_mul_u32_u24 v7, 48, v7
    s_lshl_b32 s44, s13, 3
    s_add_u32 s44, s44, 0x13c8000
    v_cmp_gt_u32 vcc, 32, v2
    s_mov_b64 exec, vcc
    buffer_store_dwordx2 v[8:9], v7, s[28:31], s44 offen sc1
    s_mov_b64 exec, -1
outa1_kernel_end:
    s_endpgm
.text
.globl qkvb1_kernel
.p2align 8
.type qkvb1_kernel,@function
qkvb1_kernel:
    s_cmp_ge_u32 s2, 256
    s_cbranch_scc1 qkvb1_kernel_end
    s_load_dwordx2 s[8:9], s[0:1], 64
    s_and_b32 s10, s2, 7
    s_lshr_b32 s11, s2, 3
    s_lshr_b32 s12, s10, 1
    s_lshl_b32 s12, s12, 2
    s_and_b32 s13, s11, 3
    s_add_u32 s12, s12, s13
    s_and_b32 s13, s10, 1
    s_lshl_b32 s13, s13, 3
    s_lshr_b32 s14, s11, 2
    s_add_u32 s13, s13, s14
    v_lshrrev_b32 v1, 6, v0
    v_and_b32 v15, 63, v0
    v_readfirstlane_b32 s22, v1
    s_and_b32 s14, s22, 3
    v_lshlrev_b32 v1, 4, v15
    v_add_u32 v2, 0x10000, v1
    v_and_b32 v13, 15, v15
    v_lshrrev_b32 v14, 4, v15
    s_lshl_b32 s15, s12, 7
    s_lshl_b32 s28, s14, 5
    s_add_u32 s15, s15, s28
    s_lshl_b32 s19, s14, 10
    v_lshlrev_b32 v3, 2, v13
    v_lshlrev_b32 v4, 4, v14
    v_mov_b32 v176, 0x3f803f80
    v_mov_b32 v177, 0x3f803f80
    v_mov_b32 v178, 0x3f803f80
    v_mov_b32 v179, 0x3f803f80
    s_lshr_b32 s16, s15, 4
    s_mul_i32 s16, s16, 18432
    s_add_u32 s16, s16, 0x240000
    s_add_u32 s17, s13, 16
    s_mul_i32 s18, s17, 129024
    s_add_u32 s18, s18, 0xe00000
    s_add_u32 s18, s18, s19
    v_add_u32 v5, s15, v13
    v_mul_u32_u24 v5, 48, v5
    s_waitcnt lgkmcnt(0)
    s_mov_b32 s24, s8
    s_mov_b32 s25, s9
    s_mov_b32 s26, 0x1480000
    s_mov_b32 s27, 0x00020000
    s_cmp_lt_u32 s22, 4
    s_cbranch_scc1 qkvb1_kernel_comp
    s_add_u32 s20, s19, 0
    s_add_u32 s21, s18, 0
    s_mov_b32 m0, s20
    s_nop 0
    buffer_load_dwordx4 v1, s[24:27], s21 offen lds
    s_add_u32 s20, s19, 4096
    s_add_u32 s21, s18, 4096
    s_mov_b32 m0, s20
    s_nop 0
    buffer_load_dwordx4 v1, s[24:27], s21 offen lds
    s_add_u32 s20, s19, 8192
    s_add_u32 s21, s18, 8192
    s_mov_b32 m0, s20
    s_nop 0
    buffer_load_dwordx4 v1, s[24:27], s21 offen lds
    s_add_u32 s20, s19, 12288
    s_add_u32 s21, s18, 12288
    s_mov_b32 m0, s20
    s_nop 0
    buffer_load_dwordx4 v1, s[24:27], s21 offen lds
    s_add_u32 s20, s19, 16384
    s_add_u32 s21, s18, 16384
    s_mov_b32 m0, s20
    s_nop 0
    buffer_load_dwordx4 v1, s[24:27], s21 offen lds
    s_add_u32 s20, s19, 20480
    s_add_u32 s21, s18, 20480
    s_mov_b32 m0, s20
    s_nop 0
    buffer_load_dwordx4 v1, s[24:27], s21 offen lds
    s_add_u32 s20, s19, 24576
    s_add_u32 s21, s18, 24576
    s_mov_b32 m0, s20
    s_nop 0
    buffer_load_dwordx4 v1, s[24:27], s21 offen lds
    s_add_u32 s20, s19, 28672
    s_add_u32 s21, s18, 28672
    s_mov_b32 m0, s20
    s_nop 0
    buffer_load_dwordx4 v1, s[24:27], s21 offen lds
    s_add_u32 s20, s19, 32768
    s_add_u32 s21, s18, 32768
    s_mov_b32 m0, s20
    s_nop 0
    buffer_load_dwordx4 v1, s[24:27], s21 offen lds
    s_add_u32 s20, s19, 36864
    s_add_u32 s21, s18, 36864
    s_mov_b32 m0, s20
    s_nop 0
    buffer_load_dwordx4 v1, s[24:27], s21 offen lds
    s_add_u32 s20, s19, 40960
    s_add_u32 s21, s18, 40960
    s_mov_b32 m0, s20
    s_nop 0
    buffer_load_dwordx4 v1, s[24:27], s21 offen lds
    s_add_u32 s20, s19, 45056
    s_add_u32 s21, s18, 45056
    s_mov_b32 m0, s20
    s_nop 0
    buffer_load_dwordx4 v1, s[24:27], s21 offen lds
    s_add_u32 s20, s19, 49152
    s_add_u32 s21, s18, 49152
    s_mov_b32 m0, s20
    s_nop 0
    buffer_load_dwordx4 v1, s[24:27], s21 offen lds
    s_add_u32 s20, s19, 53248
    s_add_u32 s21, s18, 53248
    s_mov_b32 m0, s20
    s_nop 0
    buffer_load_dwordx4 v1, s[24:27], s21 offen lds
    s_waitcnt vmcnt(7)
    s_barrier
    s_add_u32 s20, s19, 57344
    s_add_u32 s21, s18, 57344
    s_mov_b32 m0, s20
    s_nop 0
    buffer_load_dwordx4 v1, s[24:27], s21 offen lds
    s_add_u32 s20, s19, 61440
    s_add_u32 s21, s18, 61440
    s_mov_b32 m0, s20
    s_nop 0
    buffer_load_dwordx4 v1, s[24:27], s21 offen lds
    s_add_u32 s20, s19, 65536
    s_add_u32 s21, s18, 65536
    s_mov_b32 m0, s20
    s_nop 0
    buffer_load_dwordx4 v1, s[24:27], s21 offen lds
    s_add_u32 s20, s19, 69632
    s_add_u32 s21, s18, 69632
    s_mov_b32 m0, s20
    s_nop 0
    buffer_load_dwordx4 v1, s[24:27], s21 offen lds
    s_add_u32 s20, s19, 73728
    s_add_u32 s21, s18, 73728
    s_mov_b32 m0, s20
    s_nop 0
    buffer_load_dwordx4 v1, s[24:27], s21 offen lds
    s_add_u32 s20, s19, 77824
    s_add_u32 s21, s18, 77824
    s_mov_b32 m0, s20
    s_nop 0
    buffer_load_dwordx4 v1, s[24:27], s21 offen lds
    s_add_u32 s20, s19, 81920
    s_add_u32 s21, s18, 81920
    s_mov_b32 m0, s20
    s_nop 0
    buffer_load_dwordx4 v1, s[24:27], s21 offen lds
    s_waitcnt vmcnt(7)
    s_barrier
    s_add_u32 s20, s19, 86016
    s_add_u32 s21, s18, 86016
    s_mov_b32 m0, s20
    s_nop 0
    buffer_load_dwordx4 v1, s[24:27], s21 offen lds
    s_add_u32 s20, s19, 90112
    s_add_u32 s21, s18, 90112
    s_mov_b32 m0, s20
    s_nop 0
    buffer_load_dwordx4 v1, s[24:27], s21 offen lds
    s_add_u32 s20, s19, 94208
    s_add_u32 s21, s18, 94208
    s_mov_b32 m0, s20
    s_nop 0
    buffer_load_dwordx4 v1, s[24:27], s21 offen lds
    s_add_u32 s20, s19, 98304
    s_add_u32 s21, s18, 98304
    s_mov_b32 m0, s20
    s_nop 0
    buffer_load_dwordx4 v1, s[24:27], s21 offen lds
    s_add_u32 s20, s19, 102400
    s_add_u32 s21, s18, 102400
    s_mov_b32 m0, s20
    s_nop 0
    buffer_load_dwordx4 v1, s[24:27], s21 offen lds
    s_add_u32 s20, s19, 106496
    s_add_u32 s21, s18, 106496
    s_mov_b32 m0, s20
    s_nop 0
    buffer_load_dwordx4 v1, s[24:27], s21 offen lds
    s_add_u32 s20, s19, 110592
    s_add_u32 s21, s18, 110592
    s_mov_b32 m0, s20
    s_nop 0
    buffer_load_dwordx4 v1, s[24:27], s21 offen lds
    s_waitcnt vmcnt(7)
    s_barrier
    s_add_u32 s20, s19, 114688
    s_add_u32 s21, s18, 114688
    s_mov_b32 m0, s20
    s_nop 0
    buffer_load_dwordx4 v1, s[24:27], s21 offen lds
    s_add_u32 s20, s19, 118784
    s_add_u32 s21, s18, 118784
    s_mov_b32 m0, s20
    s_nop 0
    buffer_load_dwordx4 v1, s[24:27], s21 offen lds
    s_add_u32 s20, s19, 122880
    s_add_u32 s21, s18, 122880
    s_mov_b32 m0, s20
    s_nop 0
    buffer_load_dwordx4 v1, s[24:27], s21 offen lds
    s_and_b32 s20, s19, 0x400
    s_sub_u32 s21, s18, s19
    s_add_u32 s21, s21, s20
    s_add_u32 s21, s21, 126976
    s_add_u32 s20, s20, 126976
    s_mov_b32 m0, s20
    s_nop 0
    buffer_load_dwordx4 v1, s[24:27], s21 offen lds
    s_waitcnt vmcnt(4)
    s_barrier
    s_waitcnt vmcnt(0)
    s_barrier
    s_endpgm
qkvb1_kernel_comp:
    s_add_u32 s21, s16, 0
    buffer_load_dwordx4 v[16:19], v1, s[24:27], s21 offen
    s_add_u32 s21, s16, 18432
    buffer_load_dwordx4 v[20:23], v1, s[24:27], s21 offen
    s_add_u32 s21, s16, 1024
    buffer_load_dwordx4 v[24:27], v1, s[24:27], s21 offen
    s_add_u32 s21, s16, 19456
    buffer_load_dwordx4 v[28:31], v1, s[24:27], s21 offen
    s_add_u32 s21, s16, 2048
    buffer_load_dwordx4 v[32:35], v1, s[24:27], s21 offen
    s_add_u32 s21, s16, 20480
    buffer_load_dwordx4 v[36:39], v1, s[24:27], s21 offen
    s_add_u32 s21, s16, 3072
    buffer_load_dwordx4 v[40:43], v1, s[24:27], s21 offen
    s_add_u32 s21, s16, 21504
    buffer_load_dwordx4 v[44:47], v1, s[24:27], s21 offen
    s_add_u32 s21, s16, 4096
    buffer_load_dwordx4 v[48:51], v1, s[24:27], s21 offen
    s_add_u32 s21, s16, 22528
    buffer_load_dwordx4 v[52:55], v1, s[24:27], s21 offen
    s_add_u32 s21, s16, 5120
    buffer_load_dwordx4 v[56:59], v1, s[24:27], s21 offen
    s_add_u32 s21, s16, 23552
    buffer_load_dwordx4 v[60:63], v1, s[24:27], s21 offen
    s_mul_i32 s21, s17, 448
    s_add_u32 s21, s21, 0x1380000
    buffer_load_dwordx4 v[148:151], v4, s[24:27], s21 offen offset:0
    buffer_load_dwordx4 v[152:155], v4, s[24:27], s21 offen offset:64
    buffer_load_dwordx4 v[156:159], v4, s[24:27], s21 offen offset:128
    buffer_load_dwordx4 v[160:163], v4, s[24:27], s21 offen offset:192
    buffer_load_dword v164, v3, s[24:27], s21 offen offset:256
    buffer_load_dword v168, v3, s[24:27], s21 offen offset:320
    buffer_load_dwordx4 v[172:175], v4, s[24:27], s21 offen offset:384
    s_mov_b32 s21, 0x13c8000
    buffer_load_dwordx4 v[180:183], v5, s[24:27], s21 offen offset:0
    buffer_load_dwordx4 v[184:187], v5, s[24:27], s21 offen offset:16
    buffer_load_dwordx4 v[188:191], v5, s[24:27], s21 offen offset:32
    buffer_load_dwordx4 v[192:195], v5, s[24:27], s21 offen offset:768
    buffer_load_dwordx4 v[196:199], v5, s[24:27], s21 offen offset:784
    buffer_load_dwordx4 v[200:203], v5, s[24:27], s21 offen offset:800
    s_mov_b32 s35, 0x3fb8aa3b
    s_mov_b32 s36, 0x358637bd
    s_lshl_b32 s40, s12, 2
    s_add_u32 s40, s40, s14
    s_lshl_b32 s41, s13, 7
    s_add_u32 s41, s41, s40
    s_mul_i32 s41, s41, 1152
    s_add_u32 s41, s41, 0x480000
    s_add_u32 s44, s41, 73728
    v_lshrrev_b32 v240, 1, v14
    v_lshlrev_b32 v240, 9, v240
    v_lshl_add_u32 v240, v13, 4, v240
    v_and_b32 v241, 1, v14
    v_lshl_add_u32 v240, v241, 3, v240
    s_add_u32 s45, s41, 0x240000
    s_add_u32 s46, s44, 0x240000
    s_mul_i32 s42, s13, 155648
    s_mul_i32 s43, s40, 1216
    s_add_u32 s42, s42, s43
    s_add_u32 s42, s42, 0x900000
    s_add_u32 s43, s42, 77824
    v_mul_u32_u24 v242, 304, v241
    v_lshl_add_u32 v242, v13, 4, v242
    v_lshrrev_b32 v243, 1, v14
    v_lshl_add_u32 v242, v243, 3, v242
    v_mov_b32 v244, 0x240000
    v_mul_lo_u32 v244, v244, v14
    v_add3_u32 v244, v244, v3, 0
    v_add_u32 v244, 1024, v244
    v_cmp_gt_u32 vcc, 2, v14
    v_mov_b32 v245, 0x40000000
    s_nop 0
    v_cndmask_b32 v244, v245, v244, vcc
    v_bfe_u32 v246, v13, 2, 1
    v_mul_u32_u24 v246, 304, v246
    v_lshrrev_b32 v247, 3, v13
    v_lshl_add_u32 v246, v247, 3, v246
    v_and_b32 v247, 3, v13
    v_lshl_add_u32 v246, v247, 1, v246
    v_add_u32 v246, 256, v246
    v_cmp_eq_u32 vcc, 2, v14
    s_nop 1
    v_cndmask_b32 v246, v245, v246, vcc
    s_waitcnt vmcnt(0)
    v_add_f32 v180, v180, v182
    v_add_f32 v184, v184, v186
    v_add_f32 v188, v188, v190
    v_add_f32 v181, v181, v183
    v_add_f32 v185, v185, v187
    v_add_f32 v189, v189, v191
    v_add_f32 v180, v180, v184
    v_add_f32 v181, v181, v185
    v_add_f32 v180, v180, v188
    v_add_f32 v181, v181, v189
    v_add_f32 v192, v192, v194
    v_add_f32 v196, v196, v198
    v_add_f32 v200, v200, v202
    v_add_f32 v193, v193, v195
    v_add_f32 v197, v197, v199
    v_add_f32 v201, v201, v203
    v_add_f32 v192, v192, v196
    v_add_f32 v193, v193, v197
    v_add_f32 v192, v192, v200
    v_add_f32 v193, v193, v201
    s_mov_b32 s33, 0x3ae38e39
    s_mov_b32 s34, 0x3727c5ac
    v_mul_f32 v208, s33, v180
    v_mul_f32 v210, s33, v181
    v_mul_f32 v209, s33, v192
    v_mul_f32 v211, s33, v193
    v_fma_f32 v210, -v208, v208, v210
    v_fma_f32 v211, -v209, v209, v211
    v_max_f32 v210, 0, v210
    v_max_f32 v211, 0, v211
    v_add_f32 v210, s34, v210
    v_add_f32 v211, s34, v211
    v_rsq_f32 v204, v210
    v_rsq_f32 v205, v211
    s_nop 0
    v_mul_f32 v206, -v208, v204
    v_mul_f32 v207, -v209, v205
    s_lshl_b32 s29, s14, 8
    s_add_u32 s29, s29, 129024
    v_add_u32 v212, s29, v3
    ds_write_b32 v212, v204 offset:0
    ds_write_b32 v212, v206 offset:128
    ds_write_b32 v212, v205 offset:64
    ds_write_b32 v212, v207 offset:192
    v_add_u32 v213, s29, v4
    s_waitcnt lgkmcnt(0)
    ds_read_b128 v[224:227], v213 offset:0
    ds_read_b128 v[232:235], v213 offset:128
    ds_read_b128 v[228:231], v213 offset:64
    ds_read_b128 v[236:239], v213 offset:192
    s_mov_b32 s37, 0x3eae1a93
    v_cmp_eq_u32 vcc, 0, v14
    v_mul_f32 v214, s37, v204
    v_mul_f32 v216, s37, v206
    v_mul_f32 v215, s37, v205
    v_mul_f32 v217, s37, v207
    v_cndmask_b32 v218, v204, v214, vcc
    v_cndmask_b32 v220, v206, v216, vcc
    v_cndmask_b32 v219, v205, v215, vcc
    v_cndmask_b32 v221, v207, v217, vcc
    s_waitcnt lgkmcnt(0)
    s_barrier
    ds_read_b128 v[64:67], v1 offset:0
    ds_read_b128 v[68:71], v1 offset:1024
    ds_read_b128 v[72:75], v1 offset:2048
    ds_read_b128 v[76:79], v1 offset:3072
    ds_read_b128 v[80:83], v1 offset:4096
    ds_read_b128 v[84:87], v1 offset:5120
    ds_read_b128 v[88:91], v1 offset:6144
    s_waitcnt vmcnt(23)
    s_waitcnt lgkmcnt(6)
    v_mfma_f32_16x16x32_bf16 v[92:95], v[64:67], v[16:19], 0
    v_mfma_f32_16x16x32_bf16 v[96:99], v[64:67], v[20:23], 0
    ds_read_b128 v[64:67], v1 offset:7168
    s_waitcnt lgkmcnt(6)
    v_mfma_f32_16x16x32_bf16 v[100:103], v[68:71], v[16:19], 0
    v_mfma_f32_16x16x32_bf16 v[104:107], v[68:71], v[20:23], 0
    ds_read_b128 v[68:71], v1 offset:8192
    s_waitcnt lgkmcnt(6)
    v_mfma_f32_16x16x32_bf16 v[108:111], v[72:75], v[16:19], 0
    v_mfma_f32_16x16x32_bf16 v[112:115], v[72:75], v[20:23], 0
    ds_read_b128 v[72:75], v1 offset:9216
    s_waitcnt lgkmcnt(6)
    v_mfma_f32_16x16x32_bf16 v[116:119], v[76:79], v[16:19], 0
    v_mfma_f32_16x16x32_bf16 v[120:123], v[76:79], v[20:23], 0
    ds_read_b128 v[76:79], v1 offset:10240
    s_waitcnt lgkmcnt(6)
    v_mfma_f32_16x16x32_bf16 v[124:127], v[16:19], v[80:83], 0
    v_mfma_f32_16x16x32_bf16 v[128:131], v[20:23], v[80:83], 0
    ds_read_b128 v[80:83], v1 offset:11264
    s_waitcnt lgkmcnt(6)
    v_mfma_f32_16x16x32_bf16 v[132:135], v[16:19], v[84:87], 0
    v_mfma_f32_16x16x32_bf16 v[136:139], v[20:23], v[84:87], 0
    ds_read_b128 v[84:87], v1 offset:12288
    s_waitcnt lgkmcnt(6)
    v_mfma_f32_16x16x32_bf16 v[140:143], v[88:91], v[16:19], 0
    v_mfma_f32_16x16x32_bf16 v[144:147], v[88:91], v[20:23], 0
    ds_read_b128 v[88:91], v1 offset:13312
    s_add_u32 s21, s16, 6144
    buffer_load_dwordx4 v[16:19], v1, s[24:27], s21 offen
    s_add_u32 s21, s16, 24576
    buffer_load_dwordx4 v[20:23], v1, s[24:27], s21 offen
    s_waitcnt vmcnt(23)
    s_waitcnt lgkmcnt(6)
    v_mfma_f32_16x16x32_bf16 v[92:95], v[64:67], v[24:27], v[92:95]
    v_mfma_f32_16x16x32_bf16 v[96:99], v[64:67], v[28:31], v[96:99]
    ds_read_b128 v[64:67], v1 offset:14336
    s_waitcnt lgkmcnt(6)
    v_mfma_f32_16x16x32_bf16 v[100:103], v[68:71], v[24:27], v[100:103]
    v_mfma_f32_16x16x32_bf16 v[104:107], v[68:71], v[28:31], v[104:107]
    ds_read_b128 v[68:71], v1 offset:15360
    s_waitcnt lgkmcnt(6)
    v_mfma_f32_16x16x32_bf16 v[108:111], v[72:75], v[24:27], v[108:111]
    v_mfma_f32_16x16x32_bf16 v[112:115], v[72:75], v[28:31], v[112:115]
    ds_read_b128 v[72:75], v1 offset:16384
    s_waitcnt lgkmcnt(6)
    v_mfma_f32_16x16x32_bf16 v[116:119], v[76:79], v[24:27], v[116:119]
    v_mfma_f32_16x16x32_bf16 v[120:123], v[76:79], v[28:31], v[120:123]
    ds_read_b128 v[76:79], v1 offset:17408
    s_waitcnt lgkmcnt(6)
    v_mfma_f32_16x16x32_bf16 v[124:127], v[24:27], v[80:83], v[124:127]
    v_mfma_f32_16x16x32_bf16 v[128:131], v[28:31], v[80:83], v[128:131]
    ds_read_b128 v[80:83], v1 offset:18432
    s_waitcnt lgkmcnt(6)
    v_mfma_f32_16x16x32_bf16 v[132:135], v[24:27], v[84:87], v[132:135]
    v_mfma_f32_16x16x32_bf16 v[136:139], v[28:31], v[84:87], v[136:139]
    ds_read_b128 v[84:87], v1 offset:19456
    s_waitcnt lgkmcnt(6)
    v_mfma_f32_16x16x32_bf16 v[140:143], v[88:91], v[24:27], v[140:143]
    v_mfma_f32_16x16x32_bf16 v[144:147], v[88:91], v[28:31], v[144:147]
    ds_read_b128 v[88:91], v1 offset:20480
    s_add_u32 s21, s16, 7168
    buffer_load_dwordx4 v[24:27], v1, s[24:27], s21 offen
    s_add_u32 s21, s16, 25600
    buffer_load_dwordx4 v[28:31], v1, s[24:27], s21 offen
    s_waitcnt vmcnt(23)
    s_waitcnt lgkmcnt(6)
    v_mfma_f32_16x16x32_bf16 v[92:95], v[64:67], v[32:35], v[92:95]
    v_mfma_f32_16x16x32_bf16 v[96:99], v[64:67], v[36:39], v[96:99]
    ds_read_b128 v[64:67], v1 offset:21504
    s_waitcnt lgkmcnt(6)
    v_mfma_f32_16x16x32_bf16 v[100:103], v[68:71], v[32:35], v[100:103]
    v_mfma_f32_16x16x32_bf16 v[104:107], v[68:71], v[36:39], v[104:107]
    ds_read_b128 v[68:71], v1 offset:22528
    s_waitcnt lgkmcnt(6)
    v_mfma_f32_16x16x32_bf16 v[108:111], v[72:75], v[32:35], v[108:111]
    v_mfma_f32_16x16x32_bf16 v[112:115], v[72:75], v[36:39], v[112:115]
    ds_read_b128 v[72:75], v1 offset:23552
    s_waitcnt lgkmcnt(6)
    v_mfma_f32_16x16x32_bf16 v[116:119], v[76:79], v[32:35], v[116:119]
    v_mfma_f32_16x16x32_bf16 v[120:123], v[76:79], v[36:39], v[120:123]
    ds_read_b128 v[76:79], v1 offset:24576
    s_waitcnt lgkmcnt(6)
    v_mfma_f32_16x16x32_bf16 v[124:127], v[32:35], v[80:83], v[124:127]
    v_mfma_f32_16x16x32_bf16 v[128:131], v[36:39], v[80:83], v[128:131]
    ds_read_b128 v[80:83], v1 offset:25600
    s_waitcnt lgkmcnt(6)
    v_mfma_f32_16x16x32_bf16 v[132:135], v[32:35], v[84:87], v[132:135]
    v_mfma_f32_16x16x32_bf16 v[136:139], v[36:39], v[84:87], v[136:139]
    ds_read_b128 v[84:87], v1 offset:26624
    s_waitcnt lgkmcnt(6)
    v_mfma_f32_16x16x32_bf16 v[140:143], v[88:91], v[32:35], v[140:143]
    v_mfma_f32_16x16x32_bf16 v[144:147], v[88:91], v[36:39], v[144:147]
    ds_read_b128 v[88:91], v1 offset:27648
    s_add_u32 s21, s16, 8192
    buffer_load_dwordx4 v[32:35], v1, s[24:27], s21 offen
    s_add_u32 s21, s16, 26624
    buffer_load_dwordx4 v[36:39], v1, s[24:27], s21 offen
    s_waitcnt vmcnt(23)
    s_waitcnt lgkmcnt(6)
    v_mfma_f32_16x16x32_bf16 v[92:95], v[64:67], v[40:43], v[92:95]
    v_mfma_f32_16x16x32_bf16 v[96:99], v[64:67], v[44:47], v[96:99]
    s_waitcnt lgkmcnt(5)
    v_mfma_f32_16x16x32_bf16 v[100:103], v[68:71], v[40:43], v[100:103]
    v_mfma_f32_16x16x32_bf16 v[104:107], v[68:71], v[44:47], v[104:107]
    s_waitcnt lgkmcnt(4)
    v_mfma_f32_16x16x32_bf16 v[108:111], v[72:75], v[40:43], v[108:111]
    v_mfma_f32_16x16x32_bf16 v[112:115], v[72:75], v[44:47], v[112:115]
    s_waitcnt lgkmcnt(3)
    v_mfma_f32_16x16x32_bf16 v[116:119], v[76:79], v[40:43], v[116:119]
    v_mfma_f32_16x16x32_bf16 v[120:123], v[76:79], v[44:47], v[120:123]
    s_waitcnt lgkmcnt(2)
    v_mfma_f32_16x16x32_bf16 v[124:127], v[40:43], v[80:83], v[124:127]
    v_mfma_f32_16x16x32_bf16 v[128:131], v[44:47], v[80:83], v[128:131]
    s_waitcnt lgkmcnt(1)
    v_mfma_f32_16x16x32_bf16 v[132:135], v[40:43], v[84:87], v[132:135]
    v_mfma_f32_16x16x32_bf16 v[136:139], v[44:47], v[84:87], v[136:139]
    s_waitcnt lgkmcnt(0)
    v_mfma_f32_16x16x32_bf16 v[140:143], v[88:91], v[40:43], v[140:143]
    v_mfma_f32_16x16x32_bf16 v[144:147], v[88:91], v[44:47], v[144:147]
    s_add_u32 s21, s16, 9216
    buffer_load_dwordx4 v[40:43], v1, s[24:27], s21 offen
    s_add_u32 s21, s16, 27648
    buffer_load_dwordx4 v[44:47], v1, s[24:27], s21 offen
    s_barrier
    ds_read_b128 v[64:67], v1 offset:28672
    ds_read_b128 v[68:71], v1 offset:29696
    ds_read_b128 v[72:75], v1 offset:30720
    ds_read_b128 v[76:79], v1 offset:31744
    ds_read_b128 v[80:83], v1 offset:32768
    ds_read_b128 v[84:87], v1 offset:33792
    ds_read_b128 v[88:91], v1 offset:34816
    s_waitcnt vmcnt(23)
    s_waitcnt lgkmcnt(6)
    v_mfma_f32_16x16x32_bf16 v[92:95], v[64:67], v[48:51], v[92:95]
    v_mfma_f32_16x16x32_bf16 v[96:99], v[64:67], v[52:55], v[96:99]
    ds_read_b128 v[64:67], v1 offset:35840
    s_waitcnt lgkmcnt(6)
    v_mfma_f32_16x16x32_bf16 v[100:103], v[68:71], v[48:51], v[100:103]
    v_mfma_f32_16x16x32_bf16 v[104:107], v[68:71], v[52:55], v[104:107]
    ds_read_b128 v[68:71], v1 offset:36864
    s_waitcnt lgkmcnt(6)
    v_mfma_f32_16x16x32_bf16 v[108:111], v[72:75], v[48:51], v[108:111]
    v_mfma_f32_16x16x32_bf16 v[112:115], v[72:75], v[52:55], v[112:115]
    ds_read_b128 v[72:75], v1 offset:37888
    s_waitcnt lgkmcnt(6)
    v_mfma_f32_16x16x32_bf16 v[116:119], v[76:79], v[48:51], v[116:119]
    v_mfma_f32_16x16x32_bf16 v[120:123], v[76:79], v[52:55], v[120:123]
    ds_read_b128 v[76:79], v1 offset:38912
    s_waitcnt lgkmcnt(6)
    v_mfma_f32_16x16x32_bf16 v[124:127], v[48:51], v[80:83], v[124:127]
    v_mfma_f32_16x16x32_bf16 v[128:131], v[52:55], v[80:83], v[128:131]
    ds_read_b128 v[80:83], v1 offset:39936
    s_waitcnt lgkmcnt(6)
    v_mfma_f32_16x16x32_bf16 v[132:135], v[48:51], v[84:87], v[132:135]
    v_mfma_f32_16x16x32_bf16 v[136:139], v[52:55], v[84:87], v[136:139]
    ds_read_b128 v[84:87], v1 offset:40960
    s_waitcnt lgkmcnt(6)
    v_mfma_f32_16x16x32_bf16 v[140:143], v[88:91], v[48:51], v[140:143]
    v_mfma_f32_16x16x32_bf16 v[144:147], v[88:91], v[52:55], v[144:147]
    ds_read_b128 v[88:91], v1 offset:41984
    s_add_u32 s21, s16, 10240
    buffer_load_dwordx4 v[48:51], v1, s[24:27], s21 offen
    s_add_u32 s21, s16, 28672
    buffer_load_dwordx4 v[52:55], v1, s[24:27], s21 offen
    s_waitcnt vmcnt(23)
    s_waitcnt lgkmcnt(6)
    v_mfma_f32_16x16x32_bf16 v[92:95], v[64:67], v[56:59], v[92:95]
    v_mfma_f32_16x16x32_bf16 v[96:99], v[64:67], v[60:63], v[96:99]
    ds_read_b128 v[64:67], v1 offset:43008
    s_waitcnt lgkmcnt(6)
    v_mfma_f32_16x16x32_bf16 v[100:103], v[68:71], v[56:59], v[100:103]
    v_mfma_f32_16x16x32_bf16 v[104:107], v[68:71], v[60:63], v[104:107]
    ds_read_b128 v[68:71], v1 offset:44032
    s_waitcnt lgkmcnt(6)
    v_mfma_f32_16x16x32_bf16 v[108:111], v[72:75], v[56:59], v[108:111]
    v_mfma_f32_16x16x32_bf16 v[112:115], v[72:75], v[60:63], v[112:115]
    ds_read_b128 v[72:75], v1 offset:45056
    s_waitcnt lgkmcnt(6)
    v_mfma_f32_16x16x32_bf16 v[116:119], v[76:79], v[56:59], v[116:119]
    v_mfma_f32_16x16x32_bf16 v[120:123], v[76:79], v[60:63], v[120:123]
    ds_read_b128 v[76:79], v1 offset:46080
    s_waitcnt lgkmcnt(6)
    v_mfma_f32_16x16x32_bf16 v[124:127], v[56:59], v[80:83], v[124:127]
    v_mfma_f32_16x16x32_bf16 v[128:131], v[60:63], v[80:83], v[128:131]
    ds_read_b128 v[80:83], v1 offset:47104
    s_waitcnt lgkmcnt(6)
    v_mfma_f32_16x16x32_bf16 v[132:135], v[56:59], v[84:87], v[132:135]
    v_mfma_f32_16x16x32_bf16 v[136:139], v[60:63], v[84:87], v[136:139]
    ds_read_b128 v[84:87], v1 offset:48128
    s_waitcnt lgkmcnt(6)
    v_mfma_f32_16x16x32_bf16 v[140:143], v[88:91], v[56:59], v[140:143]
    v_mfma_f32_16x16x32_bf16 v[144:147], v[88:91], v[60:63], v[144:147]
    ds_read_b128 v[88:91], v1 offset:49152
    s_add_u32 s21, s16, 11264
    buffer_load_dwordx4 v[56:59], v1, s[24:27], s21 offen
    s_add_u32 s21, s16, 29696
    buffer_load_dwordx4 v[60:63], v1, s[24:27], s21 offen
    s_waitcnt vmcnt(10)
    s_waitcnt lgkmcnt(6)
    v_mfma_f32_16x16x32_bf16 v[92:95], v[64:67], v[16:19], v[92:95]
    v_mfma_f32_16x16x32_bf16 v[96:99], v[64:67], v[20:23], v[96:99]
    ds_read_b128 v[64:67], v1 offset:50176
    s_waitcnt lgkmcnt(6)
    v_mfma_f32_16x16x32_bf16 v[100:103], v[68:71], v[16:19], v[100:103]
    v_mfma_f32_16x16x32_bf16 v[104:107], v[68:71], v[20:23], v[104:107]
    ds_read_b128 v[68:71], v1 offset:51200
    s_waitcnt lgkmcnt(6)
    v_mfma_f32_16x16x32_bf16 v[108:111], v[72:75], v[16:19], v[108:111]
    v_mfma_f32_16x16x32_bf16 v[112:115], v[72:75], v[20:23], v[112:115]
    ds_read_b128 v[72:75], v1 offset:52224
    s_waitcnt lgkmcnt(6)
    v_mfma_f32_16x16x32_bf16 v[116:119], v[76:79], v[16:19], v[116:119]
    v_mfma_f32_16x16x32_bf16 v[120:123], v[76:79], v[20:23], v[120:123]
    ds_read_b128 v[76:79], v1 offset:53248
    s_waitcnt lgkmcnt(6)
    v_mfma_f32_16x16x32_bf16 v[124:127], v[16:19], v[80:83], v[124:127]
    v_mfma_f32_16x16x32_bf16 v[128:131], v[20:23], v[80:83], v[128:131]
    ds_read_b128 v[80:83], v1 offset:54272
    s_waitcnt lgkmcnt(6)
    v_mfma_f32_16x16x32_bf16 v[132:135], v[16:19], v[84:87], v[132:135]
    v_mfma_f32_16x16x32_bf16 v[136:139], v[20:23], v[84:87], v[136:139]
    ds_read_b128 v[84:87], v1 offset:55296
    s_waitcnt lgkmcnt(6)
    v_mfma_f32_16x16x32_bf16 v[140:143], v[88:91], v[16:19], v[140:143]
    v_mfma_f32_16x16x32_bf16 v[144:147], v[88:91], v[20:23], v[144:147]
    ds_read_b128 v[88:91], v1 offset:56320
    s_add_u32 s21, s16, 12288
    buffer_load_dwordx4 v[16:19], v1, s[24:27], s21 offen
    s_add_u32 s21, s16, 30720
    buffer_load_dwordx4 v[20:23], v1, s[24:27], s21 offen
    s_waitcnt vmcnt(10)
    s_waitcnt lgkmcnt(6)
    v_mfma_f32_16x16x32_bf16 v[92:95], v[64:67], v[24:27], v[92:95]
    v_mfma_f32_16x16x32_bf16 v[96:99], v[64:67], v[28:31], v[96:99]
    s_waitcnt lgkmcnt(5)
    v_mfma_f32_16x16x32_bf16 v[100:103], v[68:71], v[24:27], v[100:103]
    v_mfma_f32_16x16x32_bf16 v[104:107], v[68:71], v[28:31], v[104:107]
    s_waitcnt lgkmcnt(4)
    v_mfma_f32_16x16x32_bf16 v[108:111], v[72:75], v[24:27], v[108:111]
    v_mfma_f32_16x16x32_bf16 v[112:115], v[72:75], v[28:31], v[112:115]
    s_waitcnt lgkmcnt(3)
    v_mfma_f32_16x16x32_bf16 v[116:119], v[76:79], v[24:27], v[116:119]
    v_mfma_f32_16x16x32_bf16 v[120:123], v[76:79], v[28:31], v[120:123]
    s_waitcnt lgkmcnt(2)
    v_mfma_f32_16x16x32_bf16 v[124:127], v[24:27], v[80:83], v[124:127]
    v_mfma_f32_16x16x32_bf16 v[128:131], v[28:31], v[80:83], v[128:131]
    s_waitcnt lgkmcnt(1)
    v_mfma_f32_16x16x32_bf16 v[132:135], v[24:27], v[84:87], v[132:135]
    v_mfma_f32_16x16x32_bf16 v[136:139], v[28:31], v[84:87], v[136:139]
    s_waitcnt lgkmcnt(0)
    v_mfma_f32_16x16x32_bf16 v[140:143], v[88:91], v[24:27], v[140:143]
    v_mfma_f32_16x16x32_bf16 v[144:147], v[88:91], v[28:31], v[144:147]
    s_add_u32 s21, s16, 13312
    buffer_load_dwordx4 v[24:27], v1, s[24:27], s21 offen
    s_add_u32 s21, s16, 31744
    buffer_load_dwordx4 v[28:31], v1, s[24:27], s21 offen
    s_barrier
    ds_read_b128 v[64:67], v1 offset:57344
    ds_read_b128 v[68:71], v1 offset:58368
    ds_read_b128 v[72:75], v1 offset:59392
    ds_read_b128 v[76:79], v1 offset:60416
    ds_read_b128 v[80:83], v1 offset:61440
    ds_read_b128 v[84:87], v1 offset:62464
    ds_read_b128 v[88:91], v1 offset:63488
    s_waitcnt vmcnt(10)
    s_waitcnt lgkmcnt(6)
    v_mfma_f32_16x16x32_bf16 v[92:95], v[64:67], v[32:35], v[92:95]
    v_mfma_f32_16x16x32_bf16 v[96:99], v[64:67], v[36:39], v[96:99]
    ds_read_b128 v[64:67], v1 offset:64512
    s_waitcnt lgkmcnt(6)
    v_mfma_f32_16x16x32_bf16 v[100:103], v[68:71], v[32:35], v[100:103]
    v_mfma_f32_16x16x32_bf16 v[104:107], v[68:71], v[36:39], v[104:107]
    ds_read_b128 v[68:71], v2 offset:0
    s_waitcnt lgkmcnt(6)
    v_mfma_f32_16x16x32_bf16 v[108:111], v[72:75], v[32:35], v[108:111]
    v_mfma_f32_16x16x32_bf16 v[112:115], v[72:75], v[36:39], v[112:115]
    ds_read_b128 v[72:75], v2 offset:1024
    s_waitcnt lgkmcnt(6)
    v_mfma_f32_16x16x32_bf16 v[116:119], v[76:79], v[32:35], v[116:119]
    v_mfma_f32_16x16x32_bf16 v[120:123], v[76:79], v[36:39], v[120:123]
    ds_read_b128 v[76:79], v2 offset:2048
    s_waitcnt lgkmcnt(6)
    v_mfma_f32_16x16x32_bf16 v[124:127], v[32:35], v[80:83], v[124:127]
    v_mfma_f32_16x16x32_bf16 v[128:131], v[36:39], v[80:83], v[128:131]
    ds_read_b128 v[80:83], v2 offset:3072
    s_waitcnt lgkmcnt(6)
    v_mfma_f32_16x16x32_bf16 v[132:135], v[32:35], v[84:87], v[132:135]
    v_mfma_f32_16x16x32_bf16 v[136:139], v[36:39], v[84:87], v[136:139]
    ds_read_b128 v[84:87], v2 offset:4096
    s_waitcnt lgkmcnt(6)
    v_mfma_f32_16x16x32_bf16 v[140:143], v[88:91], v[32:35], v[140:143]
    v_mfma_f32_16x16x32_bf16 v[144:147], v[88:91], v[36:39], v[144:147]
    ds_read_b128 v[88:91], v2 offset:5120
    s_add_u32 s21, s16, 14336
    buffer_load_dwordx4 v[32:35], v1, s[24:27], s21 offen
    s_add_u32 s21, s16, 32768
    buffer_load_dwordx4 v[36:39], v1, s[24:27], s21 offen
    s_waitcnt vmcnt(10)
    s_waitcnt lgkmcnt(6)
    v_mfma_f32_16x16x32_bf16 v[92:95], v[64:67], v[40:43], v[92:95]
    v_mfma_f32_16x16x32_bf16 v[96:99], v[64:67], v[44:47], v[96:99]
    ds_read_b128 v[64:67], v2 offset:6144
    s_waitcnt lgkmcnt(6)
    v_mfma_f32_16x16x32_bf16 v[100:103], v[68:71], v[40:43], v[100:103]
    v_mfma_f32_16x16x32_bf16 v[104:107], v[68:71], v[44:47], v[104:107]
    ds_read_b128 v[68:71], v2 offset:7168
    s_waitcnt lgkmcnt(6)
    v_mfma_f32_16x16x32_bf16 v[108:111], v[72:75], v[40:43], v[108:111]
    v_mfma_f32_16x16x32_bf16 v[112:115], v[72:75], v[44:47], v[112:115]
    ds_read_b128 v[72:75], v2 offset:8192
    s_waitcnt lgkmcnt(6)
    v_mfma_f32_16x16x32_bf16 v[116:119], v[76:79], v[40:43], v[116:119]
    v_mfma_f32_16x16x32_bf16 v[120:123], v[76:79], v[44:47], v[120:123]
    ds_read_b128 v[76:79], v2 offset:9216
    s_waitcnt lgkmcnt(6)
    v_mfma_f32_16x16x32_bf16 v[124:127], v[40:43], v[80:83], v[124:127]
    v_mfma_f32_16x16x32_bf16 v[128:131], v[44:47], v[80:83], v[128:131]
    ds_read_b128 v[80:83], v2 offset:10240
    s_waitcnt lgkmcnt(6)
    v_mfma_f32_16x16x32_bf16 v[132:135], v[40:43], v[84:87], v[132:135]
    v_mfma_f32_16x16x32_bf16 v[136:139], v[44:47], v[84:87], v[136:139]
    ds_read_b128 v[84:87], v2 offset:11264
    s_waitcnt lgkmcnt(6)
    v_mfma_f32_16x16x32_bf16 v[140:143], v[88:91], v[40:43], v[140:143]
    v_mfma_f32_16x16x32_bf16 v[144:147], v[88:91], v[44:47], v[144:147]
    ds_read_b128 v[88:91], v2 offset:12288
    s_add_u32 s21, s16, 15360
    buffer_load_dwordx4 v[40:43], v1, s[24:27], s21 offen
    s_add_u32 s21, s16, 33792
    buffer_load_dwordx4 v[44:47], v1, s[24:27], s21 offen
    s_waitcnt vmcnt(10)
    s_waitcnt lgkmcnt(6)
    v_mfma_f32_16x16x32_bf16 v[92:95], v[64:67], v[48:51], v[92:95]
    v_mfma_f32_16x16x32_bf16 v[96:99], v[64:67], v[52:55], v[96:99]
    ds_read_b128 v[64:67], v2 offset:13312
    s_waitcnt lgkmcnt(6)
    v_mfma_f32_16x16x32_bf16 v[100:103], v[68:71], v[48:51], v[100:103]
    v_mfma_f32_16x16x32_bf16 v[104:107], v[68:71], v[52:55], v[104:107]
    ds_read_b128 v[68:71], v2 offset:14336
    s_waitcnt lgkmcnt(6)
    v_mfma_f32_16x16x32_bf16 v[108:111], v[72:75], v[48:51], v[108:111]
    v_mfma_f32_16x16x32_bf16 v[112:115], v[72:75], v[52:55], v[112:115]
    ds_read_b128 v[72:75], v2 offset:15360
    s_waitcnt lgkmcnt(6)
    v_mfma_f32_16x16x32_bf16 v[116:119], v[76:79], v[48:51], v[116:119]
    v_mfma_f32_16x16x32_bf16 v[120:123], v[76:79], v[52:55], v[120:123]
    ds_read_b128 v[76:79], v2 offset:16384
    s_waitcnt lgkmcnt(6)
    v_mfma_f32_16x16x32_bf16 v[124:127], v[48:51], v[80:83], v[124:127]
    v_mfma_f32_16x16x32_bf16 v[128:131], v[52:55], v[80:83], v[128:131]
    ds_read_b128 v[80:83], v2 offset:17408
    s_waitcnt lgkmcnt(6)
    v_mfma_f32_16x16x32_bf16 v[132:135], v[48:51], v[84:87], v[132:135]
    v_mfma_f32_16x16x32_bf16 v[136:139], v[52:55], v[84:87], v[136:139]
    ds_read_b128 v[84:87], v2 offset:18432
    s_waitcnt lgkmcnt(6)
    v_mfma_f32_16x16x32_bf16 v[140:143], v[88:91], v[48:51], v[140:143]
    v_mfma_f32_16x16x32_bf16 v[144:147], v[88:91], v[52:55], v[144:147]
    ds_read_b128 v[88:91], v2 offset:19456
    s_add_u32 s21, s16, 16384
    buffer_load_dwordx4 v[48:51], v1, s[24:27], s21 offen
    s_add_u32 s21, s16, 34816
    buffer_load_dwordx4 v[52:55], v1, s[24:27], s21 offen
    s_waitcnt vmcnt(10)
    s_waitcnt lgkmcnt(6)
    v_mfma_f32_16x16x32_bf16 v[92:95], v[64:67], v[56:59], v[92:95]
    v_mfma_f32_16x16x32_bf16 v[96:99], v[64:67], v[60:63], v[96:99]
    s_waitcnt lgkmcnt(5)
    v_mfma_f32_16x16x32_bf16 v[100:103], v[68:71], v[56:59], v[100:103]
    v_mfma_f32_16x16x32_bf16 v[104:107], v[68:71], v[60:63], v[104:107]
    s_waitcnt lgkmcnt(4)
    v_mfma_f32_16x16x32_bf16 v[108:111], v[72:75], v[56:59], v[108:111]
    v_mfma_f32_16x16x32_bf16 v[112:115], v[72:75], v[60:63], v[112:115]
    s_waitcnt lgkmcnt(3)
    v_mfma_f32_16x16x32_bf16 v[116:119], v[76:79], v[56:59], v[116:119]
    v_mfma_f32_16x16x32_bf16 v[120:123], v[76:79], v[60:63], v[120:123]
    s_waitcnt lgkmcnt(2)
    v_mfma_f32_16x16x32_bf16 v[124:127], v[56:59], v[80:83], v[124:127]
    v_mfma_f32_16x16x32_bf16 v[128:131], v[60:63], v[80:83], v[128:131]
    s_waitcnt lgkmcnt(1)
    v_mfma_f32_16x16x32_bf16 v[132:135], v[56:59], v[84:87], v[132:135]
    v_mfma_f32_16x16x32_bf16 v[136:139], v[60:63], v[84:87], v[136:139]
    s_waitcnt lgkmcnt(0)
    v_mfma_f32_16x16x32_bf16 v[140:143], v[88:91], v[56:59], v[140:143]
    v_mfma_f32_16x16x32_bf16 v[144:147], v[88:91], v[60:63], v[144:147]
    s_add_u32 s21, s16, 17408
    buffer_load_dwordx4 v[56:59], v1, s[24:27], s21 offen
    s_add_u32 s21, s16, 35840
    buffer_load_dwordx4 v[60:63], v1, s[24:27], s21 offen
    s_barrier
    ds_read_b128 v[64:67], v2 offset:20480
    ds_read_b128 v[68:71], v2 offset:21504
    ds_read_b128 v[72:75], v2 offset:22528
    ds_read_b128 v[76:79], v2 offset:23552
    ds_read_b128 v[80:83], v2 offset:24576
    ds_read_b128 v[84:87], v2 offset:25600
    ds_read_b128 v[88:91], v2 offset:26624
    s_waitcnt vmcnt(10)
    s_waitcnt lgkmcnt(6)
    v_mfma_f32_16x16x32_bf16 v[92:95], v[64:67], v[16:19], v[92:95]
    v_mfma_f32_16x16x32_bf16 v[96:99], v[64:67], v[20:23], v[96:99]
    ds_read_b128 v[64:67], v2 offset:27648
    s_waitcnt lgkmcnt(6)
    v_mfma_f32_16x16x32_bf16 v[100:103], v[68:71], v[16:19], v[100:103]
    v_mfma_f32_16x16x32_bf16 v[104:107], v[68:71], v[20:23], v[104:107]
    ds_read_b128 v[68:71], v2 offset:28672
    s_waitcnt lgkmcnt(6)
    v_mfma_f32_16x16x32_bf16 v[108:111], v[72:75], v[16:19], v[108:111]
    v_mfma_f32_16x16x32_bf16 v[112:115], v[72:75], v[20:23], v[112:115]
    ds_read_b128 v[72:75], v2 offset:29696
    s_waitcnt lgkmcnt(6)
    v_mfma_f32_16x16x32_bf16 v[116:119], v[76:79], v[16:19], v[116:119]
    v_mfma_f32_16x16x32_bf16 v[120:123], v[76:79], v[20:23], v[120:123]
    ds_read_b128 v[76:79], v2 offset:30720
    s_waitcnt lgkmcnt(6)
    v_mfma_f32_16x16x32_bf16 v[124:127], v[16:19], v[80:83], v[124:127]
    v_mfma_f32_16x16x32_bf16 v[128:131], v[20:23], v[80:83], v[128:131]
    ds_read_b128 v[80:83], v2 offset:31744
    s_waitcnt lgkmcnt(6)
    v_mfma_f32_16x16x32_bf16 v[132:135], v[16:19], v[84:87], v[132:135]
    v_mfma_f32_16x16x32_bf16 v[136:139], v[20:23], v[84:87], v[136:139]
    ds_read_b128 v[84:87], v2 offset:32768
    s_waitcnt lgkmcnt(6)
    v_mfma_f32_16x16x32_bf16 v[140:143], v[88:91], v[16:19], v[140:143]
    v_mfma_f32_16x16x32_bf16 v[144:147], v[88:91], v[20:23], v[144:147]
    ds_read_b128 v[88:91], v2 offset:33792
    s_waitcnt vmcnt(8)
    s_waitcnt lgkmcnt(6)
    v_mfma_f32_16x16x32_bf16 v[92:95], v[64:67], v[24:27], v[92:95]
    v_mfma_f32_16x16x32_bf16 v[96:99], v[64:67], v[28:31], v[96:99]
    ds_read_b128 v[64:67], v2 offset:34816
    s_waitcnt lgkmcnt(6)
    v_mfma_f32_16x16x32_bf16 v[100:103], v[68:71], v[24:27], v[100:103]
    v_mfma_f32_16x16x32_bf16 v[104:107], v[68:71], v[28:31], v[104:107]
    ds_read_b128 v[68:71], v2 offset:35840
    s_waitcnt lgkmcnt(6)
    v_mfma_f32_16x16x32_bf16 v[108:111], v[72:75], v[24:27], v[108:111]
    v_mfma_f32_16x16x32_bf16 v[112:115], v[72:75], v[28:31], v[112:115]
    ds_read_b128 v[72:75], v2 offset:36864
    s_waitcnt lgkmcnt(6)
    v_mfma_f32_16x16x32_bf16 v[116:119], v[76:79], v[24:27], v[116:119]
    v_mfma_f32_16x16x32_bf16 v[120:123], v[76:79], v[28:31], v[120:123]
    ds_read_b128 v[76:79], v2 offset:37888
    s_waitcnt lgkmcnt(6)
    v_mfma_f32_16x16x32_bf16 v[124:127], v[24:27], v[80:83], v[124:127]
    v_mfma_f32_16x16x32_bf16 v[128:131], v[28:31], v[80:83], v[128:131]
    ds_read_b128 v[80:83], v2 offset:38912
    s_waitcnt lgkmcnt(6)
    v_mfma_f32_16x16x32_bf16 v[132:135], v[24:27], v[84:87], v[132:135]
    v_mfma_f32_16x16x32_bf16 v[136:139], v[28:31], v[84:87], v[136:139]
    ds_read_b128 v[84:87], v2 offset:39936
    s_waitcnt lgkmcnt(6)
    v_mfma_f32_16x16x32_bf16 v[140:143], v[88:91], v[24:27], v[140:143]
    v_mfma_f32_16x16x32_bf16 v[144:147], v[88:91], v[28:31], v[144:147]
    ds_read_b128 v[88:91], v2 offset:40960
    s_waitcnt vmcnt(6)
    s_waitcnt lgkmcnt(6)
    v_mfma_f32_16x16x32_bf16 v[92:95], v[64:67], v[32:35], v[92:95]
    v_mfma_f32_16x16x32_bf16 v[96:99], v[64:67], v[36:39], v[96:99]
    ds_read_b128 v[64:67], v2 offset:41984
    s_waitcnt lgkmcnt(6)
    v_mfma_f32_16x16x32_bf16 v[100:103], v[68:71], v[32:35], v[100:103]
    v_mfma_f32_16x16x32_bf16 v[104:107], v[68:71], v[36:39], v[104:107]
    ds_read_b128 v[68:71], v2 offset:43008
    s_waitcnt lgkmcnt(6)
    v_mfma_f32_16x16x32_bf16 v[108:111], v[72:75], v[32:35], v[108:111]
    v_mfma_f32_16x16x32_bf16 v[112:115], v[72:75], v[36:39], v[112:115]
    ds_read_b128 v[72:75], v2 offset:44032
    s_waitcnt lgkmcnt(6)
    v_mfma_f32_16x16x32_bf16 v[116:119], v[76:79], v[32:35], v[116:119]
    v_mfma_f32_16x16x32_bf16 v[120:123], v[76:79], v[36:39], v[120:123]
    ds_read_b128 v[76:79], v2 offset:45056
    s_waitcnt lgkmcnt(6)
    v_mfma_f32_16x16x32_bf16 v[124:127], v[32:35], v[80:83], v[124:127]
    v_mfma_f32_16x16x32_bf16 v[128:131], v[36:39], v[80:83], v[128:131]
    ds_read_b128 v[80:83], v2 offset:46080
    s_waitcnt lgkmcnt(6)
    v_mfma_f32_16x16x32_bf16 v[132:135], v[32:35], v[84:87], v[132:135]
    v_mfma_f32_16x16x32_bf16 v[136:139], v[36:39], v[84:87], v[136:139]
    ds_read_b128 v[84:87], v2 offset:47104
    s_waitcnt lgkmcnt(6)
    v_mfma_f32_16x16x32_bf16 v[140:143], v[88:91], v[32:35], v[140:143]
    v_mfma_f32_16x16x32_bf16 v[144:147], v[88:91], v[36:39], v[144:147]
    ds_read_b128 v[88:91], v2 offset:48128
    s_waitcnt vmcnt(4)
    s_waitcnt lgkmcnt(6)
    v_mfma_f32_16x16x32_bf16 v[92:95], v[64:67], v[40:43], v[92:95]
    v_mfma_f32_16x16x32_bf16 v[96:99], v[64:67], v[44:47], v[96:99]
    s_waitcnt lgkmcnt(5)
    v_mfma_f32_16x16x32_bf16 v[100:103], v[68:71], v[40:43], v[100:103]
    v_mfma_f32_16x16x32_bf16 v[104:107], v[68:71], v[44:47], v[104:107]
    s_waitcnt lgkmcnt(4)
    v_mfma_f32_16x16x32_bf16 v[108:111], v[72:75], v[40:43], v[108:111]
    v_mfma_f32_16x16x32_bf16 v[112:115], v[72:75], v[44:47], v[112:115]
    s_waitcnt lgkmcnt(3)
    v_mfma_f32_16x16x32_bf16 v[116:119], v[76:79], v[40:43], v[116:119]
    v_mfma_f32_16x16x32_bf16 v[120:123], v[76:79], v[44:47], v[120:123]
    s_waitcnt lgkmcnt(2)
    v_mfma_f32_16x16x32_bf16 v[124:127], v[40:43], v[80:83], v[124:127]
    v_mfma_f32_16x16x32_bf16 v[128:131], v[44:47], v[80:83], v[128:131]
    s_waitcnt lgkmcnt(1)
    v_mfma_f32_16x16x32_bf16 v[132:135], v[40:43], v[84:87], v[132:135]
    v_mfma_f32_16x16x32_bf16 v[136:139], v[44:47], v[84:87], v[136:139]
    s_waitcnt lgkmcnt(0)
    v_mfma_f32_16x16x32_bf16 v[140:143], v[88:91], v[40:43], v[140:143]
    v_mfma_f32_16x16x32_bf16 v[144:147], v[88:91], v[44:47], v[144:147]
    s_barrier
    ds_read_b128 v[64:67], v2 offset:49152
    ds_read_b128 v[68:71], v2 offset:50176
    ds_read_b128 v[72:75], v2 offset:51200
    ds_read_b128 v[76:79], v2 offset:52224
    ds_read_b128 v[80:83], v2 offset:53248
    ds_read_b128 v[84:87], v2 offset:54272
    ds_read_b128 v[88:91], v2 offset:55296
    s_waitcnt vmcnt(2)
    s_waitcnt lgkmcnt(6)
    v_mfma_f32_16x16x32_bf16 v[92:95], v[64:67], v[48:51], v[92:95]
    v_mfma_f32_16x16x32_bf16 v[96:99], v[64:67], v[52:55], v[96:99]
    ds_read_b128 v[64:67], v2 offset:56320
    s_waitcnt lgkmcnt(6)
    v_mfma_f32_16x16x32_bf16 v[100:103], v[68:71], v[48:51], v[100:103]
    v_mfma_f32_16x16x32_bf16 v[104:107], v[68:71], v[52:55], v[104:107]
    ds_read_b128 v[68:71], v2 offset:57344
    s_waitcnt lgkmcnt(6)
    v_mfma_f32_16x16x32_bf16 v[108:111], v[72:75], v[48:51], v[108:111]
    v_mfma_f32_16x16x32_bf16 v[112:115], v[72:75], v[52:55], v[112:115]
    ds_read_b128 v[72:75], v2 offset:58368
    s_waitcnt lgkmcnt(6)
    v_mfma_f32_16x16x32_bf16 v[116:119], v[76:79], v[48:51], v[116:119]
    v_mfma_f32_16x16x32_bf16 v[120:123], v[76:79], v[52:55], v[120:123]
    ds_read_b128 v[76:79], v2 offset:59392
    s_waitcnt lgkmcnt(6)
    v_mfma_f32_16x16x32_bf16 v[124:127], v[48:51], v[80:83], v[124:127]
    v_mfma_f32_16x16x32_bf16 v[128:131], v[52:55], v[80:83], v[128:131]
    ds_read_b128 v[80:83], v2 offset:60416
    s_waitcnt lgkmcnt(6)
    v_mfma_f32_16x16x32_bf16 v[132:135], v[48:51], v[84:87], v[132:135]
    v_mfma_f32_16x16x32_bf16 v[136:139], v[52:55], v[84:87], v[136:139]
    ds_read_b128 v[84:87], v2 offset:61440
    s_waitcnt lgkmcnt(6)
    v_mfma_f32_16x16x32_bf16 v[140:143], v[88:91], v[48:51], v[140:143]
    v_mfma_f32_16x16x32_bf16 v[144:147], v[88:91], v[52:55], v[144:147]
    ds_read_b128 v[88:91], v2 offset:62464
    s_waitcnt vmcnt(0)
    s_waitcnt lgkmcnt(6)
    v_mfma_f32_16x16x32_bf16 v[92:95], v[64:67], v[56:59], v[92:95]
    v_mfma_f32_16x16x32_bf16 v[96:99], v[64:67], v[60:63], v[96:99]
    s_waitcnt lgkmcnt(5)
    v_mfma_f32_16x16x32_bf16 v[100:103], v[68:71], v[56:59], v[100:103]
    v_mfma_f32_16x16x32_bf16 v[104:107], v[68:71], v[60:63], v[104:107]
    s_waitcnt lgkmcnt(4)
    v_mfma_f32_16x16x32_bf16 v[108:111], v[72:75], v[56:59], v[108:111]
    v_mfma_f32_16x16x32_bf16 v[112:115], v[72:75], v[60:63], v[112:115]
    s_waitcnt lgkmcnt(3)
    v_mfma_f32_16x16x32_bf16 v[116:119], v[76:79], v[56:59], v[116:119]
    v_mfma_f32_16x16x32_bf16 v[120:123], v[76:79], v[60:63], v[120:123]
    s_waitcnt lgkmcnt(2)
    v_mfma_f32_16x16x32_bf16 v[124:127], v[56:59], v[80:83], v[124:127]
    v_mfma_f32_16x16x32_bf16 v[128:131], v[60:63], v[80:83], v[128:131]
    s_waitcnt lgkmcnt(1)
    v_mfma_f32_16x16x32_bf16 v[132:135], v[56:59], v[84:87], v[132:135]
    v_mfma_f32_16x16x32_bf16 v[136:139], v[60:63], v[84:87], v[136:139]
    s_waitcnt lgkmcnt(0)
    v_mfma_f32_16x16x32_bf16 v[140:143], v[88:91], v[56:59], v[140:143]
    v_mfma_f32_16x16x32_bf16 v[144:147], v[88:91], v[60:63], v[144:147]
    s_nop 7
    v_mul_f32 v92, v214, v92
    v_mul_f32 v93, v214, v93
    v_mul_f32 v94, v214, v94
    v_mul_f32 v95, v214, v95
    v_mul_f32 v96, v215, v96
    v_mul_f32 v97, v215, v97
    v_mul_f32 v98, v215, v98
    v_mul_f32 v99, v215, v99
    v_fma_f32 v92, v216, v148, v92
    v_fma_f32 v93, v216, v149, v93
    v_fma_f32 v94, v216, v150, v94
    v_fma_f32 v95, v216, v151, v95
    v_fma_f32 v96, v217, v148, v96
    v_fma_f32 v97, v217, v149, v97
    v_fma_f32 v98, v217, v150, v98
    v_fma_f32 v99, v217, v151, v99
    v_cvt_pk_bf16_f32 v32, v92, v93
    v_cvt_pk_bf16_f32 v33, v94, v95
    v_cvt_pk_bf16_f32 v34, v96, v97
    v_cvt_pk_bf16_f32 v35, v98, v99
    buffer_store_dwordx2 v[32:33], v240, s[24:27], s41 offen offset:0 sc1
    buffer_store_dwordx2 v[34:35], v240, s[24:27], s41 offen offset:256 sc1
    v_mul_f32 v100, v214, v100
    v_mul_f32 v101, v214, v101
    v_mul_f32 v102, v214, v102
    v_mul_f32 v103, v214, v103
    v_mul_f32 v104, v215, v104
    v_mul_f32 v105, v215, v105
    v_mul_f32 v106, v215, v106
    v_mul_f32 v107, v215, v107
    v_fma_f32 v100, v216, v152, v100
    v_fma_f32 v101, v216, v153, v101
    v_fma_f32 v102, v216, v154, v102
    v_fma_f32 v103, v216, v155, v103
    v_fma_f32 v104, v217, v152, v104
    v_fma_f32 v105, v217, v153, v105
    v_fma_f32 v106, v217, v154, v106
    v_fma_f32 v107, v217, v155, v107
    v_cvt_pk_bf16_f32 v36, v100, v101
    v_cvt_pk_bf16_f32 v37, v102, v103
    v_cvt_pk_bf16_f32 v38, v104, v105
    v_cvt_pk_bf16_f32 v39, v106, v107
    buffer_store_dwordx2 v[36:37], v240, s[24:27], s44 offen offset:0 sc1
    buffer_store_dwordx2 v[38:39], v240, s[24:27], s44 offen offset:256 sc1
    v_mul_f32 v108, v204, v108
    v_mul_f32 v109, v204, v109
    v_mul_f32 v110, v204, v110
    v_mul_f32 v111, v204, v111
    v_mul_f32 v112, v205, v112
    v_mul_f32 v113, v205, v113
    v_mul_f32 v114, v205, v114
    v_mul_f32 v115, v205, v115
    v_fma_f32 v108, v206, v156, v108
    v_fma_f32 v109, v206, v157, v109
    v_fma_f32 v110, v206, v158, v110
    v_fma_f32 v111, v206, v159, v111
    v_fma_f32 v112, v207, v156, v112
    v_fma_f32 v113, v207, v157, v113
    v_fma_f32 v114, v207, v158, v114
    v_fma_f32 v115, v207, v159, v115
    v_cvt_pk_bf16_f32 v40, v108, v109
    v_cvt_pk_bf16_f32 v41, v110, v111
    v_cvt_pk_bf16_f32 v42, v112, v113
    v_cvt_pk_bf16_f32 v43, v114, v115
    buffer_store_dwordx2 v[40:41], v240, s[24:27], s45 offen offset:0 sc1
    buffer_store_dwordx2 v[42:43], v240, s[24:27], s45 offen offset:256 sc1
    v_mul_f32 v116, v204, v116
    v_mul_f32 v117, v204, v117
    v_mul_f32 v118, v204, v118
    v_mul_f32 v119, v204, v119
    v_mul_f32 v120, v205, v120
    v_mul_f32 v121, v205, v121
    v_mul_f32 v122, v205, v122
    v_mul_f32 v123, v205, v123
    v_fma_f32 v116, v206, v160, v116
    v_fma_f32 v117, v206, v161, v117
    v_fma_f32 v118, v206, v162, v118
    v_fma_f32 v119, v206, v163, v119
    v_fma_f32 v120, v207, v160, v120
    v_fma_f32 v121, v207, v161, v121
    v_fma_f32 v122, v207, v162, v122
    v_fma_f32 v123, v207, v163, v123
    v_cvt_pk_bf16_f32 v44, v116, v117
    v_cvt_pk_bf16_f32 v45, v118, v119
    v_cvt_pk_bf16_f32 v46, v120, v121
    v_cvt_pk_bf16_f32 v47, v122, v123
    buffer_store_dwordx2 v[44:45], v240, s[24:27], s46 offen offset:0 sc1
    buffer_store_dwordx2 v[46:47], v240, s[24:27], s46 offen offset:256 sc1
    v_mul_f32 v124, v224, v124
    v_mul_f32 v125, v225, v125
    v_mul_f32 v126, v226, v126
    v_mul_f32 v127, v227, v127
    v_mul_f32 v128, v228, v128
    v_mul_f32 v129, v229, v129
    v_mul_f32 v130, v230, v130
    v_mul_f32 v131, v231, v131
    v_fma_f32 v124, v232, v164, v124
    v_fma_f32 v125, v233, v164, v125
    v_fma_f32 v126, v234, v164, v126
    v_fma_f32 v127, v235, v164, v127
    v_fma_f32 v128, v236, v164, v128
    v_fma_f32 v129, v237, v164, v129
    v_fma_f32 v130, v238, v164, v130
    v_fma_f32 v131, v239, v164, v131
    v_cvt_pk_bf16_f32 v48, v124, v125
    v_cvt_pk_bf16_f32 v49, v126, v127
    v_cvt_pk_bf16_f32 v50, v128, v129
    v_cvt_pk_bf16_f32 v51, v130, v131
    buffer_store_dwordx2 v[48:49], v242, s[24:27], s42 offen offset:0 sc1
    buffer_store_dwordx2 v[50:51], v242, s[24:27], s42 offen offset:608 sc1
    v_mul_f32 v132, v224, v132
    v_mul_f32 v133, v225, v133
    v_mul_f32 v134, v226, v134
    v_mul_f32 v135, v227, v135
    v_mul_f32 v136, v228, v136
    v_mul_f32 v137, v229, v137
    v_mul_f32 v138, v230, v138
    v_mul_f32 v139, v231, v139
    v_fma_f32 v132, v232, v168, v132
    v_fma_f32 v133, v233, v168, v133
    v_fma_f32 v134, v234, v168, v134
    v_fma_f32 v135, v235, v168, v135
    v_fma_f32 v136, v236, v168, v136
    v_fma_f32 v137, v237, v168, v137
    v_fma_f32 v138, v238, v168, v138
    v_fma_f32 v139, v239, v168, v139
    v_cvt_pk_bf16_f32 v52, v132, v133
    v_cvt_pk_bf16_f32 v53, v134, v135
    v_cvt_pk_bf16_f32 v54, v136, v137
    v_cvt_pk_bf16_f32 v55, v138, v139
    buffer_store_dwordx2 v[52:53], v242, s[24:27], s43 offen offset:0 sc1
    buffer_store_dwordx2 v[54:55], v242, s[24:27], s43 offen offset:608 sc1
    v_mul_f32 v140, v218, v140
    v_mul_f32 v141, v218, v141
    v_mul_f32 v142, v218, v142
    v_mul_f32 v143, v218, v143
    v_mul_f32 v144, v219, v144
    v_mul_f32 v145, v219, v145
    v_mul_f32 v146, v219, v146
    v_mul_f32 v147, v219, v147
    v_fma_f32 v140, v220, v172, v140
    v_fma_f32 v141, v220, v173, v141
    v_fma_f32 v142, v220, v174, v142
    v_fma_f32 v143, v220, v175, v143
    v_fma_f32 v144, v221, v172, v144
    v_fma_f32 v145, v221, v173, v145
    v_fma_f32 v146, v221, v174, v146
    v_fma_f32 v147, v221, v175, v147
    v_cvt_pk_bf16_f32 v56, v140, v141
    v_cvt_pk_bf16_f32 v57, v142, v143
    v_cvt_pk_bf16_f32 v58, v144, v145
    v_cvt_pk_bf16_f32 v59, v146, v147
    buffer_store_dword v56, v244, s[24:27], s41 offen offset:0 sc1
    buffer_store_short v56, v246, s[24:27], s42 offen offset:0 sc1
    buffer_store_short_d16_hi v56, v246, s[24:27], s42 offen offset:16 sc1
    buffer_store_dword v57, v244, s[24:27], s44 offen offset:0 sc1
    buffer_store_short v57, v246, s[24:27], s43 offen offset:0 sc1
    buffer_store_short_d16_hi v57, v246, s[24:27], s43 offen offset:16 sc1
    buffer_store_dword v58, v244, s[24:27], s41 offen offset:64 sc1
    buffer_store_short v58, v246, s[24:27], s42 offen offset:608 sc1
    buffer_store_short_d16_hi v58, v246, s[24:27], s42 offen offset:624 sc1
    buffer_store_dword v59, v244, s[24:27], s44 offen offset:64 sc1
    buffer_store_short v59, v246, s[24:27], s43 offen offset:608 sc1
    buffer_store_short_d16_hi v59, v246, s[24:27], s43 offen offset:624 sc1
qkvb1_kernel_end:
    s_endpgm
.text
.globl attn_kernel
.p2align 8
.type attn_kernel,@function
attn_kernel:
    s_cmp_ge_u32 s2, 256
    s_cbranch_scc1 attn_kernel_end
    s_load_dwordx2 s[8:9], s[0:1], 64
    s_and_b32 s10, s2, 7
    s_lshr_b32 s11, s2, 3
    s_lshl_b32 s12, s10, 2
    s_lshr_b32 s13, s11, 3
    s_add_u32 s12, s12, s13
    s_and_b32 s13, s11, 7
    v_lshrrev_b32 v1, 6, v0
    v_and_b32 v2, 63, v0
    v_readfirstlane_b32 s14, v1
    v_and_b32 v3, 31, v2
    v_lshrrev_b32 v4, 5, v2
    v_lshlrev_b32 v1, 4, v2
    s_lshl_b32 s15, s14, 10
    s_and_b32 s29, s14, 7
    s_lshr_b32 s30, s14, 3
    s_mul_i32 s16, s12, 73728
    s_add_u32 s17, s16, 0x480000
    s_add_u32 s16, s16, 0x6c0000
    s_mul_i32 s18, s12, 77824
    s_add_u32 s18, s18, 0x900000
    s_lshl_b32 s19, s13, 3
    s_add_u32 s19, s19, s29
    s_mul_i32 s20, s19, 1152
    s_add_u32 s17, s17, s20
    v_lshlrev_b32 v6, 2, v3
    v_add_u32 v6, 1024, v6
    v_cmp_eq_u32 vcc, 0, v4
    v_mov_b32 v7, 0x40000000
    s_lshl_b32 s31, s29, 10
    s_cmp_ge_u32 s14, 12
    s_cselect_b32 s32, 12288, 0
    s_sub_u32 s32, s15, s32
    s_waitcnt lgkmcnt(0)
    s_mov_b32 s24, s8
    s_mov_b32 s25, s9
    s_mov_b32 s26, 0x1480000
    s_mov_b32 s27, 0x00020000
    v_cndmask_b32 v7, v7, v6, vcc
    s_mul_i32 s20, s2, 192
    s_add_u32 s20, s20, 0x1390000
    v_mov_b32 v16, 0
    v_mov_b32 v17, 0
    v_mov_b32 v18, 0
    v_mov_b32 v19, 0
    v_cmp_gt_u32 s[36:37], 12, v0
    s_mov_b64 exec, s[36:37]
    s_cbranch_execz attn_kernel_nz
    buffer_store_dwordx4 v[16:19], v1, s[24:27], s20 offen sc1
attn_kernel_nz:
    s_mov_b64 exec, -1
    buffer_load_dwordx4 v[8:11], v1, s[24:27], s17 offen
    buffer_load_dword v12, v7, s[24:27], s17 offen
    s_add_u32 s21, s15, 0
    s_mov_b32 m0, s21
    s_add_u32 s20, s15, 0
    s_add_u32 s20, s20, s16
    buffer_load_dwordx4 v1, s[24:27], s20 offen lds
    s_add_u32 s21, s15, 73728
    s_mov_b32 m0, s21
    s_add_u32 s20, s15, 0
    s_add_u32 s20, s20, s18
    buffer_load_dwordx4 v1, s[24:27], s20 offen lds
    s_add_u32 s21, s15, 32768
    s_mov_b32 m0, s21
    s_add_u32 s20, s15, 32768
    s_add_u32 s20, s20, s16
    buffer_load_dwordx4 v1, s[24:27], s20 offen lds
    s_add_u32 s21, s15, 106496
    s_mov_b32 m0, s21
    s_add_u32 s20, s15, 32768
    s_add_u32 s20, s20, s18
    buffer_load_dwordx4 v1, s[24:27], s20 offen lds
    v_mov_b32 v13, 0
    v_mov_b32 v105, 0
    v_mov_b32 v109, 0
    v_mov_b32 v14, 0
    v_mov_b32 v106, 0
    v_mov_b32 v110, 0
    v_mov_b32 v15, 0
    v_mov_b32 v107, 0
    v_mov_b32 v111, 0
    s_mul_i32 s33, s30, 36864
    s_mul_i32 s34, s30, 38912
    s_add_u32 s34, s34, 73728
    v_mov_b32 v80, 0
    v_mov_b32 v81, 0
    v_mov_b32 v82, 0
    v_mov_b32 v83, 0
    v_mov_b32 v84, 0
    v_mov_b32 v85, 0
    v_mov_b32 v86, 0
    v_mov_b32 v87, 0
    v_mov_b32 v88, 0
    v_mov_b32 v89, 0
    v_mov_b32 v90, 0
    v_mov_b32 v91, 0
    v_mov_b32 v92, 0
    v_mov_b32 v93, 0
    v_mov_b32 v94, 0
    v_mov_b32 v95, 0
    v_mov_b32 v72, 0
    v_mov_b32 v73, 0
    v_mov_b32 v74, 0
    v_mov_b32 v75, 0
    v_mov_b32 v76, 0
    v_mov_b32 v77, 0
    v_mov_b32 v78, 0
    v_mov_b32 v79, 0
    v_mov_b32 v120, 0
    v_mov_b32 v121, 0
    v_mov_b32 v122, 0
    v_mov_b32 v123, 0
    v_mov_b32 v124, 0
    v_mov_b32 v125, 0
    v_mov_b32 v126, 0
    v_mov_b32 v127, 0
    v_add_u32 v5, s33, v1
    v_lshlrev_b32 v6, 2, v3
    v_add_u32 v6, 1024, v6
    v_add_u32 v6, s33, v6
    v_min_u32 v7, 18, v3
    v_lshlrev_b32 v7, 4, v7
    v_mul_u32_u24 v0, 304, v4
    v_add3_u32 v7, v7, v0, s34
    s_waitcnt vmcnt(0)
    s_barrier
    s_mov_b32 s23, 0x07060302
    ds_read_b128 v[96:99], v5 offset:0
    ds_read_b32 v104, v6 offset:0
    ds_read_b128 v[100:103], v5 offset:1152
    ds_read_b32 v108, v6 offset:1152
    s_waitcnt lgkmcnt(2)
    v_mfma_f32_32x32x16_bf16 v[32:47], v[96:99], v[8:11], 0
    v_mfma_f32_32x32x16_bf16 v[32:47], v[104:107], v[12:15], v[32:47]
    s_nop 15
    v_max3_f32 v0, v32, v33, v34
    v_max3_f32 v0, v0, v35, v36
    v_max3_f32 v0, v0, v37, v38
    v_max3_f32 v0, v0, v39, v40
    v_max3_f32 v0, v0, v41, v42
    v_max3_f32 v0, v0, v43, v44
    v_max3_f32 v0, v0, v45, v46
    v_max_f32 v0, v0, v47
    v_mov_b32 v64, v0
    s_nop 1
    v_permlane32_swap_b32 v0, v64
    s_nop 1
    v_max_f32 v0, v0, v64
    v_add_f32 v0, 0x42800000, v0
    v_sub_f32 v16, 0, v0
    v_sub_f32 v32, v32, v0
    v_sub_f32 v17, 0, v0
    v_sub_f32 v33, v33, v0
    v_sub_f32 v18, 0, v0
    v_sub_f32 v34, v34, v0
    v_sub_f32 v19, 0, v0
    v_sub_f32 v35, v35, v0
    v_sub_f32 v20, 0, v0
    v_sub_f32 v36, v36, v0
    v_sub_f32 v21, 0, v0
    v_sub_f32 v37, v37, v0
    v_sub_f32 v22, 0, v0
    v_sub_f32 v38, v38, v0
    v_sub_f32 v23, 0, v0
    v_sub_f32 v39, v39, v0
    v_sub_f32 v24, 0, v0
    v_sub_f32 v40, v40, v0
    v_sub_f32 v25, 0, v0
    v_sub_f32 v41, v41, v0
    v_sub_f32 v26, 0, v0
    v_sub_f32 v42, v42, v0
    v_sub_f32 v27, 0, v0
    v_sub_f32 v43, v43, v0
    v_sub_f32 v28, 0, v0
    v_sub_f32 v44, v44, v0
    v_sub_f32 v29, 0, v0
    v_sub_f32 v45, v45, v0
    v_sub_f32 v30, 0, v0
    v_sub_f32 v46, v46, v0
    v_sub_f32 v31, 0, v0
    v_sub_f32 v47, v47, v0
    s_waitcnt lgkmcnt(0)
    s_nop 1
    s_waitcnt lgkmcnt(0)
    v_mfma_f32_32x32x16_bf16 v[80:95], v[120:123], v[72:75], v[80:95]
    v_exp_f32 v32, v32
    v_exp_f32 v33, v33
    v_exp_f32 v34, v34
    v_exp_f32 v35, v35
    v_cvt_pk_bf16_f32 v64, v32, v33
    v_mfma_f32_32x32x16_bf16 v[80:95], v[124:127], v[76:79], v[80:95]
    v_exp_f32 v36, v36
    v_exp_f32 v37, v37
    v_cvt_pk_bf16_f32 v65, v34, v35
    v_exp_f32 v38, v38
    v_exp_f32 v39, v39
    v_cvt_pk_bf16_f32 v66, v36, v37
    v_mfma_f32_32x32x16_bf16 v[48:63], v[100:103], v[8:11], v[16:31]
    ds_read_b128 v[112:115], v7 offset:0
    ds_read_b128 v[116:119], v7 offset:608
    v_exp_f32 v40, v40
    v_exp_f32 v41, v41
    v_cvt_pk_bf16_f32 v67, v38, v39
    v_exp_f32 v42, v42
    v_exp_f32 v43, v43
    v_cvt_pk_bf16_f32 v68, v40, v41
    v_mfma_f32_32x32x16_bf16 v[48:63], v[108:111], v[12:15], v[48:63]
    ds_read_b128 v[96:99], v5 offset:2304
    ds_read_b32 v104, v6 offset:2304
    v_exp_f32 v44, v44
    v_exp_f32 v45, v45
    v_cvt_pk_bf16_f32 v69, v42, v43
    v_exp_f32 v46, v46
    v_exp_f32 v47, v47
    v_cvt_pk_bf16_f32 v70, v44, v45
    s_nop 1
    s_add_u32 s21, s15, 16384
    s_mov_b32 m0, s21
    s_add_u32 s20, s15, 16384
    s_add_u32 s20, s20, s16
    buffer_load_dwordx4 v1, s[24:27], s20 offen lds
    v_cvt_pk_bf16_f32 v71, v46, v47
    s_waitcnt lgkmcnt(0)
    v_mfma_f32_32x32x16_bf16 v[80:95], v[112:115], v[64:67], v[80:95]
    v_exp_f32 v48, v48
    v_exp_f32 v49, v49
    v_exp_f32 v50, v50
    v_exp_f32 v51, v51
    v_cvt_pk_bf16_f32 v72, v48, v49
    v_mfma_f32_32x32x16_bf16 v[80:95], v[116:119], v[68:71], v[80:95]
    v_exp_f32 v52, v52
    v_exp_f32 v53, v53
    v_cvt_pk_bf16_f32 v73, v50, v51
    v_exp_f32 v54, v54
    v_exp_f32 v55, v55
    v_cvt_pk_bf16_f32 v74, v52, v53
    v_mfma_f32_32x32x16_bf16 v[32:47], v[96:99], v[8:11], v[16:31]
    ds_read_b128 v[120:123], v7 offset:1216
    ds_read_b128 v[124:127], v7 offset:1824
    v_exp_f32 v56, v56
    v_exp_f32 v57, v57
    v_cvt_pk_bf16_f32 v75, v54, v55
    v_exp_f32 v58, v58
    v_exp_f32 v59, v59
    v_cvt_pk_bf16_f32 v76, v56, v57
    v_mfma_f32_32x32x16_bf16 v[32:47], v[104:107], v[12:15], v[32:47]
    ds_read_b128 v[100:103], v5 offset:3456
    ds_read_b32 v108, v6 offset:3456
    v_exp_f32 v60, v60
    v_exp_f32 v61, v61
    v_cvt_pk_bf16_f32 v77, v58, v59
    v_exp_f32 v62, v62
    v_exp_f32 v63, v63
    v_cvt_pk_bf16_f32 v78, v60, v61
    s_nop 1
    s_add_u32 s21, s15, 90112
    s_mov_b32 m0, s21
    s_add_u32 s20, s15, 16384
    s_add_u32 s20, s20, s18
    buffer_load_dwordx4 v1, s[24:27], s20 offen lds
    v_cvt_pk_bf16_f32 v79, v62, v63
    s_waitcnt lgkmcnt(0)
    v_mfma_f32_32x32x16_bf16 v[80:95], v[120:123], v[72:75], v[80:95]
    v_exp_f32 v32, v32
    v_exp_f32 v33, v33
    v_exp_f32 v34, v34
    v_exp_f32 v35, v35
    v_cvt_pk_bf16_f32 v64, v32, v33
    v_mfma_f32_32x32x16_bf16 v[80:95], v[124:127], v[76:79], v[80:95]
    v_exp_f32 v36, v36
    v_exp_f32 v37, v37
    v_cvt_pk_bf16_f32 v65, v34, v35
    v_exp_f32 v38, v38
    v_exp_f32 v39, v39
    v_cvt_pk_bf16_f32 v66, v36, v37
    v_mfma_f32_32x32x16_bf16 v[48:63], v[100:103], v[8:11], v[16:31]
    ds_read_b128 v[112:115], v7 offset:2432
    ds_read_b128 v[116:119], v7 offset:3040
    v_exp_f32 v40, v40
    v_exp_f32 v41, v41
    v_cvt_pk_bf16_f32 v67, v38, v39
    v_exp_f32 v42, v42
    v_exp_f32 v43, v43
    v_cvt_pk_bf16_f32 v68, v40, v41
    v_mfma_f32_32x32x16_bf16 v[48:63], v[108:111], v[12:15], v[48:63]
    ds_read_b128 v[96:99], v5 offset:4608
    ds_read_b32 v104, v6 offset:4608
    v_exp_f32 v44, v44
    v_exp_f32 v45, v45
    v_cvt_pk_bf16_f32 v69, v42, v43
    v_exp_f32 v46, v46
    v_exp_f32 v47, v47
    v_cvt_pk_bf16_f32 v70, v44, v45
    s_nop 1
    s_add_u32 s21, s15, 49152
    s_mov_b32 m0, s21
    s_add_u32 s20, s15, 49152
    s_add_u32 s20, s20, s16
    buffer_load_dwordx4 v1, s[24:27], s20 offen lds
    v_cvt_pk_bf16_f32 v71, v46, v47
    s_waitcnt lgkmcnt(0)
    v_mfma_f32_32x32x16_bf16 v[80:95], v[112:115], v[64:67], v[80:95]
    v_exp_f32 v48, v48
    v_exp_f32 v49, v49
    v_exp_f32 v50, v50
    v_exp_f32 v51, v51
    v_cvt_pk_bf16_f32 v72, v48, v49
    v_mfma_f32_32x32x16_bf16 v[80:95], v[116:119], v[68:71], v[80:95]
    v_exp_f32 v52, v52
    v_exp_f32 v53, v53
    v_cvt_pk_bf16_f32 v73, v50, v51
    v_exp_f32 v54, v54
    v_exp_f32 v55, v55
    v_cvt_pk_bf16_f32 v74, v52, v53
    v_mfma_f32_32x32x16_bf16 v[32:47], v[96:99], v[8:11], v[16:31]
    ds_read_b128 v[120:123], v7 offset:3648
    ds_read_b128 v[124:127], v7 offset:4256
    v_exp_f32 v56, v56
    v_exp_f32 v57, v57
    v_cvt_pk_bf16_f32 v75, v54, v55
    v_exp_f32 v58, v58
    v_exp_f32 v59, v59
    v_cvt_pk_bf16_f32 v76, v56, v57
    v_mfma_f32_32x32x16_bf16 v[32:47], v[104:107], v[12:15], v[32:47]
    ds_read_b128 v[100:103], v5 offset:5760
    ds_read_b32 v108, v6 offset:5760
    v_exp_f32 v60, v60
    v_exp_f32 v61, v61
    v_cvt_pk_bf16_f32 v77, v58, v59
    v_exp_f32 v62, v62
    v_exp_f32 v63, v63
    v_cvt_pk_bf16_f32 v78, v60, v61
    s_nop 1
    s_add_u32 s21, s15, 122880
    s_mov_b32 m0, s21
    s_add_u32 s20, s15, 49152
    s_add_u32 s20, s20, s18
    buffer_load_dwordx4 v1, s[24:27], s20 offen lds
    v_cvt_pk_bf16_f32 v79, v62, v63
    s_waitcnt lgkmcnt(0)
    v_mfma_f32_32x32x16_bf16 v[80:95], v[120:123], v[72:75], v[80:95]
    v_exp_f32 v32, v32
    v_exp_f32 v33, v33
    v_exp_f32 v34, v34
    v_exp_f32 v35, v35
    v_cvt_pk_bf16_f32 v64, v32, v33
    v_mfma_f32_32x32x16_bf16 v[80:95], v[124:127], v[76:79], v[80:95]
    v_exp_f32 v36, v36
    v_exp_f32 v37, v37
    v_cvt_pk_bf16_f32 v65, v34, v35
    v_exp_f32 v38, v38
    v_exp_f32 v39, v39
    v_cvt_pk_bf16_f32 v66, v36, v37
    v_mfma_f32_32x32x16_bf16 v[48:63], v[100:103], v[8:11], v[16:31]
    ds_read_b128 v[112:115], v7 offset:4864
    ds_read_b128 v[116:119], v7 offset:5472
    v_exp_f32 v40, v40
    v_exp_f32 v41, v41
    v_cvt_pk_bf16_f32 v67, v38, v39
    v_exp_f32 v42, v42
    v_exp_f32 v43, v43
    v_cvt_pk_bf16_f32 v68, v40, v41
    v_mfma_f32_32x32x16_bf16 v[48:63], v[108:111], v[12:15], v[48:63]
    ds_read_b128 v[96:99], v5 offset:6912
    ds_read_b32 v104, v6 offset:6912
    v_exp_f32 v44, v44
    v_exp_f32 v45, v45
    v_cvt_pk_bf16_f32 v69, v42, v43
    v_exp_f32 v46, v46
    v_exp_f32 v47, v47
    v_cvt_pk_bf16_f32 v70, v44, v45
    s_nop 1
    s_add_u32 s21, s31, 65536
    s_mov_b32 m0, s21
    s_add_u32 s20, s31, 65536
    s_add_u32 s20, s20, s16
    buffer_load_dwordx4 v1, s[24:27], s20 offen lds
    v_cvt_pk_bf16_f32 v71, v46, v47
    s_waitcnt lgkmcnt(0)
    v_mfma_f32_32x32x16_bf16 v[80:95], v[112:115], v[64:67], v[80:95]
    v_exp_f32 v48, v48
    v_exp_f32 v49, v49
    v_exp_f32 v50, v50
    v_exp_f32 v51, v51
    v_cvt_pk_bf16_f32 v72, v48, v49
    v_mfma_f32_32x32x16_bf16 v[80:95], v[116:119], v[68:71], v[80:95]
    v_exp_f32 v52, v52
    v_exp_f32 v53, v53
    v_cvt_pk_bf16_f32 v73, v50, v51
    v_exp_f32 v54, v54
    v_exp_f32 v55, v55
    v_cvt_pk_bf16_f32 v74, v52, v53
    v_mfma_f32_32x32x16_bf16 v[32:47], v[96:99], v[8:11], v[16:31]
    ds_read_b128 v[120:123], v7 offset:6080
    ds_read_b128 v[124:127], v7 offset:6688
    v_exp_f32 v56, v56
    v_exp_f32 v57, v57
    v_cvt_pk_bf16_f32 v75, v54, v55
    v_exp_f32 v58, v58
    v_exp_f32 v59, v59
    v_cvt_pk_bf16_f32 v76, v56, v57
    v_mfma_f32_32x32x16_bf16 v[32:47], v[104:107], v[12:15], v[32:47]
    ds_read_b128 v[100:103], v5 offset:8064
    ds_read_b32 v108, v6 offset:8064
    v_exp_f32 v60, v60
    v_exp_f32 v61, v61
    v_cvt_pk_bf16_f32 v77, v58, v59
    v_exp_f32 v62, v62
    v_exp_f32 v63, v63
    v_cvt_pk_bf16_f32 v78, v60, v61
    s_nop 1
    s_add_u32 s21, s32, 139264
    s_mov_b32 m0, s21
    s_add_u32 s20, s32, 65536
    s_add_u32 s20, s20, s18
    buffer_load_dwordx4 v1, s[24:27], s20 offen lds
    v_cvt_pk_bf16_f32 v79, v62, v63
    s_waitcnt lgkmcnt(0)
    v_mfma_f32_32x32x16_bf16 v[80:95], v[120:123], v[72:75], v[80:95]
    v_exp_f32 v32, v32
    v_exp_f32 v33, v33
    v_exp_f32 v34, v34
    v_exp_f32 v35, v35
    v_cvt_pk_bf16_f32 v64, v32, v33
    v_mfma_f32_32x32x16_bf16 v[80:95], v[124:127], v[76:79], v[80:95]
    v_exp_f32 v36, v36
    v_exp_f32 v37, v37
    v_cvt_pk_bf16_f32 v65, v34, v35
    v_exp_f32 v38, v38
    v_exp_f32 v39, v39
    v_cvt_pk_bf16_f32 v66, v36, v37
    v_mfma_f32_32x32x16_bf16 v[48:63], v[100:103], v[8:11], v[16:31]
    ds_read_b128 v[112:115], v7 offset:7296
    ds_read_b128 v[116:119], v7 offset:7904
    v_exp_f32 v40, v40
    v_exp_f32 v41, v41
    v_cvt_pk_bf16_f32 v67, v38, v39
    v_exp_f32 v42, v42
    v_exp_f32 v43, v43
    v_cvt_pk_bf16_f32 v68, v40, v41
    v_mfma_f32_32x32x16_bf16 v[48:63], v[108:111], v[12:15], v[48:63]
    ds_read_b128 v[96:99], v5 offset:9216
    ds_read_b32 v104, v6 offset:9216
    v_exp_f32 v44, v44
    v_exp_f32 v45, v45
    v_cvt_pk_bf16_f32 v69, v42, v43
    v_exp_f32 v46, v46
    v_exp_f32 v47, v47
    v_cvt_pk_bf16_f32 v70, v44, v45
    s_nop 1
    v_cvt_pk_bf16_f32 v71, v46, v47
    s_waitcnt lgkmcnt(0)
    v_mfma_f32_32x32x16_bf16 v[80:95], v[112:115], v[64:67], v[80:95]
    v_exp_f32 v48, v48
    v_exp_f32 v49, v49
    v_exp_f32 v50, v50
    v_exp_f32 v51, v51
    v_cvt_pk_bf16_f32 v72, v48, v49
    v_mfma_f32_32x32x16_bf16 v[80:95], v[116:119], v[68:71], v[80:95]
    v_exp_f32 v52, v52
    v_exp_f32 v53, v53
    v_cvt_pk_bf16_f32 v73, v50, v51
    v_exp_f32 v54, v54
    v_exp_f32 v55, v55
    v_cvt_pk_bf16_f32 v74, v52, v53
    v_mfma_f32_32x32x16_bf16 v[32:47], v[96:99], v[8:11], v[16:31]
    ds_read_b128 v[120:123], v7 offset:8512
    ds_read_b128 v[124:127], v7 offset:9120
    v_exp_f32 v56, v56
    v_exp_f32 v57, v57
    v_cvt_pk_bf16_f32 v75, v54, v55
    v_exp_f32 v58, v58
    v_exp_f32 v59, v59
    v_cvt_pk_bf16_f32 v76, v56, v57
    v_mfma_f32_32x32x16_bf16 v[32:47], v[104:107], v[12:15], v[32:47]
    ds_read_b128 v[100:103], v5 offset:10368
    ds_read_b32 v108, v6 offset:10368
    v_exp_f32 v60, v60
    v_exp_f32 v61, v61
    v_cvt_pk_bf16_f32 v77, v58, v59
    v_exp_f32 v62, v62
    v_exp_f32 v63, v63
    v_cvt_pk_bf16_f32 v78, v60, v61
    s_nop 1
    v_cvt_pk_bf16_f32 v79, v62, v63
    v_add_u32 v5, 9216, v5
    v_add_u32 v6, 9216, v6
    v_add_u32 v7, 9728, v7
    s_waitcnt vmcnt(0)
    s_barrier
    s_mov_b32 s22, 8
attn_kernel_loop:
    s_waitcnt lgkmcnt(0)
    v_mfma_f32_32x32x16_bf16 v[80:95], v[120:123], v[72:75], v[80:95]
    v_exp_f32 v32, v32
    v_exp_f32 v33, v33
    v_exp_f32 v34, v34
    v_exp_f32 v35, v35
    v_cvt_pk_bf16_f32 v64, v32, v33
    v_mfma_f32_32x32x16_bf16 v[80:95], v[124:127], v[76:79], v[80:95]
    v_exp_f32 v36, v36
    v_exp_f32 v37, v37
    v_cvt_pk_bf16_f32 v65, v34, v35
    v_exp_f32 v38, v38
    v_exp_f32 v39, v39
    v_cvt_pk_bf16_f32 v66, v36, v37
    v_mfma_f32_32x32x16_bf16 v[48:63], v[100:103], v[8:11], v[16:31]
    ds_read_b128 v[112:115], v7 offset:0
    ds_read_b128 v[116:119], v7 offset:608
    v_exp_f32 v40, v40
    v_exp_f32 v41, v41
    v_cvt_pk_bf16_f32 v67, v38, v39
    v_exp_f32 v42, v42
    v_exp_f32 v43, v43
    v_cvt_pk_bf16_f32 v68, v40, v41
    v_mfma_f32_32x32x16_bf16 v[48:63], v[108:111], v[12:15], v[48:63]
    ds_read_b128 v[96:99], v5 offset:2304
    ds_read_b32 v104, v6 offset:2304
    v_exp_f32 v44, v44
    v_exp_f32 v45, v45
    v_cvt_pk_bf16_f32 v69, v42, v43
    v_exp_f32 v46, v46
    v_exp_f32 v47, v47
    v_cvt_pk_bf16_f32 v70, v44, v45
    s_nop 1
    v_cvt_pk_bf16_f32 v71, v46, v47
    s_waitcnt lgkmcnt(0)
    v_mfma_f32_32x32x16_bf16 v[80:95], v[112:115], v[64:67], v[80:95]
    v_exp_f32 v48, v48
    v_exp_f32 v49, v49
    v_exp_f32 v50, v50
    v_exp_f32 v51, v51
    v_cvt_pk_bf16_f32 v72, v48, v49
    v_mfma_f32_32x32x16_bf16 v[80:95], v[116:119], v[68:71], v[80:95]
    v_exp_f32 v52, v52
    v_exp_f32 v53, v53
    v_cvt_pk_bf16_f32 v73, v50, v51
    v_exp_f32 v54, v54
    v_exp_f32 v55, v55
    v_cvt_pk_bf16_f32 v74, v52, v53
    v_mfma_f32_32x32x16_bf16 v[32:47], v[96:99], v[8:11], v[16:31]
    ds_read_b128 v[120:123], v7 offset:1216
    ds_read_b128 v[124:127], v7 offset:1824
    v_exp_f32 v56, v56
    v_exp_f32 v57, v57
    v_cvt_pk_bf16_f32 v75, v54, v55
    v_exp_f32 v58, v58
    v_exp_f32 v59, v59
    v_cvt_pk_bf16_f32 v76, v56, v57
    v_mfma_f32_32x32x16_bf16 v[32:47], v[104:107], v[12:15], v[32:47]
    ds_read_b128 v[100:103], v5 offset:3456
    ds_read_b32 v108, v6 offset:3456
    v_exp_f32 v60, v60
    v_exp_f32 v61, v61
    v_cvt_pk_bf16_f32 v77, v58, v59
    v_exp_f32 v62, v62
    v_exp_f32 v63, v63
    v_cvt_pk_bf16_f32 v78, v60, v61
    s_nop 1
    v_cvt_pk_bf16_f32 v79, v62, v63
    s_waitcnt lgkmcnt(0)
    v_mfma_f32_32x32x16_bf16 v[80:95], v[120:123], v[72:75], v[80:95]
    v_exp_f32 v32, v32
    v_exp_f32 v33, v33
    v_exp_f32 v34, v34
    v_exp_f32 v35, v35
    v_cvt_pk_bf16_f32 v64, v32, v33
    v_mfma_f32_32x32x16_bf16 v[80:95], v[124:127], v[76:79], v[80:95]
    v_exp_f32 v36, v36
    v_exp_f32 v37, v37
    v_cvt_pk_bf16_f32 v65, v34, v35
    v_exp_f32 v38, v38
    v_exp_f32 v39, v39
    v_cvt_pk_bf16_f32 v66, v36, v37
    v_mfma_f32_32x32x16_bf16 v[48:63], v[100:103], v[8:11], v[16:31]
    ds_read_b128 v[112:115], v7 offset:2432
    ds_read_b128 v[116:119], v7 offset:3040
    v_exp_f32 v40, v40
    v_exp_f32 v41, v41
    v_cvt_pk_bf16_f32 v67, v38, v39
    v_exp_f32 v42, v42
    v_exp_f32 v43, v43
    v_cvt_pk_bf16_f32 v68, v40, v41
    v_mfma_f32_32x32x16_bf16 v[48:63], v[108:111], v[12:15], v[48:63]
    ds_read_b128 v[96:99], v5 offset:4608
    ds_read_b32 v104, v6 offset:4608
    v_exp_f32 v44, v44
    v_exp_f32 v45, v45
    v_cvt_pk_bf16_f32 v69, v42, v43
    v_exp_f32 v46, v46
    v_exp_f32 v47, v47
    v_cvt_pk_bf16_f32 v70, v44, v45
    s_nop 1
    v_cvt_pk_bf16_f32 v71, v46, v47
    s_waitcnt lgkmcnt(0)
    v_mfma_f32_32x32x16_bf16 v[80:95], v[112:115], v[64:67], v[80:95]
    v_exp_f32 v48, v48
    v_exp_f32 v49, v49
    v_exp_f32 v50, v50
    v_exp_f32 v51, v51
    v_cvt_pk_bf16_f32 v72, v48, v49
    v_mfma_f32_32x32x16_bf16 v[80:95], v[116:119], v[68:71], v[80:95]
    v_exp_f32 v52, v52
    v_exp_f32 v53, v53
    v_cvt_pk_bf16_f32 v73, v50, v51
    v_exp_f32 v54, v54
    v_exp_f32 v55, v55
    v_cvt_pk_bf16_f32 v74, v52, v53
    v_mfma_f32_32x32x16_bf16 v[32:47], v[96:99], v[8:11], v[16:31]
    ds_read_b128 v[120:123], v7 offset:3648
    ds_read_b128 v[124:127], v7 offset:4256
    v_exp_f32 v56, v56
    v_exp_f32 v57, v57
    v_cvt_pk_bf16_f32 v75, v54, v55
    v_exp_f32 v58, v58
    v_exp_f32 v59, v59
    v_cvt_pk_bf16_f32 v76, v56, v57
    v_mfma_f32_32x32x16_bf16 v[32:47], v[104:107], v[12:15], v[32:47]
    ds_read_b128 v[100:103], v5 offset:5760
    ds_read_b32 v108, v6 offset:5760
    v_exp_f32 v60, v60
    v_exp_f32 v61, v61
    v_cvt_pk_bf16_f32 v77, v58, v59
    v_exp_f32 v62, v62
    v_exp_f32 v63, v63
    v_cvt_pk_bf16_f32 v78, v60, v61
    s_nop 1
    v_cvt_pk_bf16_f32 v79, v62, v63
    s_waitcnt lgkmcnt(0)
    v_mfma_f32_32x32x16_bf16 v[80:95], v[120:123], v[72:75], v[80:95]
    v_exp_f32 v32, v32
    v_exp_f32 v33, v33
    v_exp_f32 v34, v34
    v_exp_f32 v35, v35
    v_cvt_pk_bf16_f32 v64, v32, v33
    v_mfma_f32_32x32x16_bf16 v[80:95], v[124:127], v[76:79], v[80:95]
    v_exp_f32 v36, v36
    v_exp_f32 v37, v37
    v_cvt_pk_bf16_f32 v65, v34, v35
    v_exp_f32 v38, v38
    v_exp_f32 v39, v39
    v_cvt_pk_bf16_f32 v66, v36, v37
    v_mfma_f32_32x32x16_bf16 v[48:63], v[100:103], v[8:11], v[16:31]
    ds_read_b128 v[112:115], v7 offset:4864
    ds_read_b128 v[116:119], v7 offset:5472
    v_exp_f32 v40, v40
    v_exp_f32 v41, v41
    v_cvt_pk_bf16_f32 v67, v38, v39
    v_exp_f32 v42, v42
    v_exp_f32 v43, v43
    v_cvt_pk_bf16_f32 v68, v40, v41
    v_mfma_f32_32x32x16_bf16 v[48:63], v[108:111], v[12:15], v[48:63]
    ds_read_b128 v[96:99], v5 offset:6912
    ds_read_b32 v104, v6 offset:6912
    v_exp_f32 v44, v44
    v_exp_f32 v45, v45
    v_cvt_pk_bf16_f32 v69, v42, v43
    v_exp_f32 v46, v46
    v_exp_f32 v47, v47
    v_cvt_pk_bf16_f32 v70, v44, v45
    s_nop 1
    v_cvt_pk_bf16_f32 v71, v46, v47
    s_waitcnt lgkmcnt(0)
    v_mfma_f32_32x32x16_bf16 v[80:95], v[112:115], v[64:67], v[80:95]
    v_exp_f32 v48, v48
    v_exp_f32 v49, v49
    v_exp_f32 v50, v50
    v_exp_f32 v51, v51
    v_cvt_pk_bf16_f32 v72, v48, v49
    v_mfma_f32_32x32x16_bf16 v[80:95], v[116:119], v[68:71], v[80:95]
    v_exp_f32 v52, v52
    v_exp_f32 v53, v53
    v_cvt_pk_bf16_f32 v73, v50, v51
    v_exp_f32 v54, v54
    v_exp_f32 v55, v55
    v_cvt_pk_bf16_f32 v74, v52, v53
    v_mfma_f32_32x32x16_bf16 v[32:47], v[96:99], v[8:11], v[16:31]
    ds_read_b128 v[120:123], v7 offset:6080
    ds_read_b128 v[124:127], v7 offset:6688
    v_exp_f32 v56, v56
    v_exp_f32 v57, v57
    v_cvt_pk_bf16_f32 v75, v54, v55
    v_exp_f32 v58, v58
    v_exp_f32 v59, v59
    v_cvt_pk_bf16_f32 v76, v56, v57
    v_mfma_f32_32x32x16_bf16 v[32:47], v[104:107], v[12:15], v[32:47]
    ds_read_b128 v[100:103], v5 offset:8064
    ds_read_b32 v108, v6 offset:8064
    v_exp_f32 v60, v60
    v_exp_f32 v61, v61
    v_cvt_pk_bf16_f32 v77, v58, v59
    v_exp_f32 v62, v62
    v_exp_f32 v63, v63
    v_cvt_pk_bf16_f32 v78, v60, v61
    s_nop 1
    v_cvt_pk_bf16_f32 v79, v62, v63
    s_waitcnt lgkmcnt(0)
    v_mfma_f32_32x32x16_bf16 v[80:95], v[120:123], v[72:75], v[80:95]
    v_exp_f32 v32, v32
    v_exp_f32 v33, v33
    v_exp_f32 v34, v34
    v_exp_f32 v35, v35
    v_cvt_pk_bf16_f32 v64, v32, v33
    v_mfma_f32_32x32x16_bf16 v[80:95], v[124:127], v[76:79], v[80:95]
    v_exp_f32 v36, v36
    v_exp_f32 v37, v37
    v_cvt_pk_bf16_f32 v65, v34, v35
    v_exp_f32 v38, v38
    v_exp_f32 v39, v39
    v_cvt_pk_bf16_f32 v66, v36, v37
    v_mfma_f32_32x32x16_bf16 v[48:63], v[100:103], v[8:11], v[16:31]
    ds_read_b128 v[112:115], v7 offset:7296
    ds_read_b128 v[116:119], v7 offset:7904
    v_exp_f32 v40, v40
    v_exp_f32 v41, v41
    v_cvt_pk_bf16_f32 v67, v38, v39
    v_exp_f32 v42, v42
    v_exp_f32 v43, v43
    v_cvt_pk_bf16_f32 v68, v40, v41
    v_mfma_f32_32x32x16_bf16 v[48:63], v[108:111], v[12:15], v[48:63]
    ds_read_b128 v[96:99], v5 offset:9216
    ds_read_b32 v104, v6 offset:9216
    v_exp_f32 v44, v44
    v_exp_f32 v45, v45
    v_cvt_pk_bf16_f32 v69, v42, v43
    v_exp_f32 v46, v46
    v_exp_f32 v47, v47
    v_cvt_pk_bf16_f32 v70, v44, v45
    s_nop 1
    v_cvt_pk_bf16_f32 v71, v46, v47
    s_waitcnt lgkmcnt(0)
    v_mfma_f32_32x32x16_bf16 v[80:95], v[112:115], v[64:67], v[80:95]
    v_exp_f32 v48, v48
    v_exp_f32 v49, v49
    v_exp_f32 v50, v50
    v_exp_f32 v51, v51
    v_cvt_pk_bf16_f32 v72, v48, v49
    v_mfma_f32_32x32x16_bf16 v[80:95], v[116:119], v[68:71], v[80:95]
    v_exp_f32 v52, v52
    v_exp_f32 v53, v53
    v_cvt_pk_bf16_f32 v73, v50, v51
    v_exp_f32 v54, v54
    v_exp_f32 v55, v55
    v_cvt_pk_bf16_f32 v74, v52, v53
    v_mfma_f32_32x32x16_bf16 v[32:47], v[96:99], v[8:11], v[16:31]
    ds_read_b128 v[120:123], v7 offset:8512
    ds_read_b128 v[124:127], v7 offset:9120
    v_exp_f32 v56, v56
    v_exp_f32 v57, v57
    v_cvt_pk_bf16_f32 v75, v54, v55
    v_exp_f32 v58, v58
    v_exp_f32 v59, v59
    v_cvt_pk_bf16_f32 v76, v56, v57
    v_mfma_f32_32x32x16_bf16 v[32:47], v[104:107], v[12:15], v[32:47]
    ds_read_b128 v[100:103], v5 offset:10368
    ds_read_b32 v108, v6 offset:10368
    v_exp_f32 v60, v60
    v_exp_f32 v61, v61
    v_cvt_pk_bf16_f32 v77, v58, v59
    v_exp_f32 v62, v62
    v_exp_f32 v63, v63
    v_cvt_pk_bf16_f32 v78, v60, v61
    s_nop 1
    v_cvt_pk_bf16_f32 v79, v62, v63
    v_add_u32 v5, 9216, v5
    v_add_u32 v6, 9216, v6
    v_add_u32 v7, 9728, v7
    s_add_u32 s22, s22, 8
    s_cmp_lt_u32 s22, 32
    s_cbranch_scc1 attn_kernel_loop
    s_waitcnt lgkmcnt(0)
    v_mfma_f32_32x32x16_bf16 v[80:95], v[120:123], v[72:75], v[80:95]
    v_mfma_f32_32x32x16_bf16 v[80:95], v[124:127], v[76:79], v[80:95]
    s_nop 15
    v_mov_b32 v0, 0
    v_fma_f32 v0, v80, 0, v0
    v_fma_f32 v0, v81, 0, v0
    v_fma_f32 v0, v82, 0, v0
    v_fma_f32 v0, v83, 0, v0
    v_fma_f32 v0, v84, 0, v0
    v_fma_f32 v0, v85, 0, v0
    v_fma_f32 v0, v86, 0, v0
    v_fma_f32 v0, v87, 0, v0
    v_fma_f32 v0, v88, 0, v0
    v_fma_f32 v0, v89, 0, v0
    v_fma_f32 v0, v90, 0, v0
    v_cmp_neq_f32 s[36:37], 0, v0
    v_max3_f32 v0, abs(v80), abs(v81), abs(v82)
    v_max3_f32 v0, v0, abs(v83), abs(v84)
    v_max3_f32 v0, v0, abs(v85), abs(v86)
    v_max3_f32 v0, v0, abs(v87), abs(v88)
    v_max3_f32 v0, v0, abs(v89), abs(v90)
    v_cmp_le_f32 vcc, 0x7b800000, v0
    s_or_b64 vcc, vcc, s[36:37]
    s_cbranch_vccnz attn_kernel_safe
attn_kernel_fin:
    v_mov_b32 v0, v90
    s_nop 1
    v_permlane32_swap_b32 v0, v90
    s_nop 1
    v_log_f32 v90, v0
    v_rcp_f32 v0, v0
    s_nop 0
    v_sub_f32 v90, v90, v16
    v_mul_f32 v80, v80, v0
    v_mul_f32 v81, v81, v0
    v_mul_f32 v82, v82, v0
    v_mul_f32 v83, v83, v0
    v_mul_f32 v84, v84, v0
    v_mul_f32 v85, v85, v0
    v_mul_f32 v86, v86, v0
    v_mul_f32 v87, v87, v0
    v_mul_f32 v88, v88, v0
    v_mul_f32 v89, v89, v0
    s_mul_i32 s20, s29, 3072
    v_add_u32 v5, s20, v1
    s_barrier
    s_cmp_eq_u32 s30, 0
    s_cbranch_scc1 attn_kernel_h0
    ds_write_b128 v5, v[80:83] offset:0
    ds_write_b128 v5, v[84:87] offset:1024
    ds_write_b128 v5, v[88:91] offset:2048
    s_waitcnt lgkmcnt(0)
    s_barrier
    s_endpgm
attn_kernel_h0:
    s_barrier
    ds_read_b128 v[32:35], v5 offset:0
    ds_read_b128 v[36:39], v5 offset:1024
    ds_read_b128 v[40:43], v5 offset:2048
    s_waitcnt lgkmcnt(0)
    v_max_f32 v0, v90, v42
    v_sub_f32 v48, v90, v0
    v_sub_f32 v49, v42, v0
    v_exp_f32 v48, v48
    v_exp_f32 v49, v49
    s_nop 0
    v_add_f32 v0, v48, v49
    v_rcp_f32 v0, v0
    s_nop 0
    v_mul_f32 v48, v48, v0
    v_mul_f32 v49, v49, v0
    v_mul_f32 v80, v80, v48
    v_mul_f32 v81, v81, v48
    v_mul_f32 v82, v82, v48
    v_mul_f32 v83, v83, v48
    v_mul_f32 v84, v84, v48
    v_mul_f32 v85, v85, v48
    v_mul_f32 v86, v86, v48
    v_mul_f32 v87, v87, v48
    v_mul_f32 v88, v88, v48
    v_mul_f32 v89, v89, v48
    v_fma_f32 v80, v32, v49, v80
    v_fma_f32 v81, v33, v49, v81
    v_fma_f32 v82, v34, v49, v82
    v_fma_f32 v83, v35, v49, v83
    v_fma_f32 v84, v36, v49, v84
    v_fma_f32 v85, v37, v49, v85
    v_fma_f32 v86, v38, v49, v86
    v_fma_f32 v87, v39, v49, v87
    v_fma_f32 v88, v40, v49, v88
    v_fma_f32 v89, v41, v49, v89
    v_cvt_pk_bf16_f32 v64, v80, v81
    v_cvt_pk_bf16_f32 v65, v82, v83
    v_cvt_pk_bf16_f32 v66, v84, v85
    v_cvt_pk_bf16_f32 v67, v86, v87
    v_cvt_pk_bf16_f32 v68, v88, v89
    s_lshl_b32 s20, s19, 5
    s_add_u32 s20, s20, s12
    s_lshl_b32 s20, s20, 10
    s_add_u32 s20, s20, 0xb80000
    buffer_store_dwordx4 v[64:67], v1, s[24:27], s20 offen sc1
    s_lshl_b32 s20, s19, 12
    s_lshr_b32 s21, s12, 2
    s_lshl_b32 s21, s21, 9
    s_add_u32 s20, s20, s21
    s_and_b32 s21, s12, 3
    s_lshl_b32 s21, s21, 2
    s_add_u32 s20, s20, s21
    s_add_u32 s20, s20, 0xd80000
    v_cmp_eq_u32 vcc, 0, v4
    s_mov_b64 exec, vcc
    buffer_store_dword v68, v1, s[24:27], s20 offen sc1
    s_mov_b64 exec, -1
    s_endpgm
attn_kernel_safe:
    v_mov_b32 v80, 0
    v_mov_b32 v81, 0
    v_mov_b32 v82, 0
    v_mov_b32 v83, 0
    v_mov_b32 v84, 0
    v_mov_b32 v85, 0
    v_mov_b32 v86, 0
    v_mov_b32 v87, 0
    v_mov_b32 v88, 0
    v_mov_b32 v89, 0
    v_mov_b32 v90, 0
    v_mov_b32 v91, 0
    v_mov_b32 v92, 0
    v_mov_b32 v93, 0
    v_mov_b32 v94, 0
    v_mov_b32 v95, 0
    v_mov_b32 v72, 0
    v_mov_b32 v73, 0
    v_mov_b32 v74, 0
    v_mov_b32 v75, 0
    v_mov_b32 v76, 0
    v_mov_b32 v77, 0
    v_mov_b32 v78, 0
    v_mov_b32 v79, 0
    v_mov_b32 v120, 0
    v_mov_b32 v121, 0
    v_mov_b32 v122, 0
    v_mov_b32 v123, 0
    v_mov_b32 v124, 0
    v_mov_b32 v125, 0
    v_mov_b32 v126, 0
    v_mov_b32 v127, 0
    v_add_u32 v5, s33, v1
    v_lshlrev_b32 v6, 2, v3
    v_add_u32 v6, 1024, v6
    v_add_u32 v6, s33, v6
    v_min_u32 v7, 18, v3
    v_lshlrev_b32 v7, 4, v7
    v_mul_u32_u24 v0, 304, v4
    v_add3_u32 v7, v7, v0, s34
    v_mov_b32 v17, 0xff800000
    s_mov_b32 s22, 0
attn_kernel_sloop:
    ds_read_b128 v[96:99], v5 offset:0
    ds_read_b32 v104, v6 offset:0
    ds_read_b128 v[112:115], v7 offset:0
    ds_read_b128 v[116:119], v7 offset:608
    s_waitcnt lgkmcnt(2)
    v_mfma_f32_32x32x16_bf16 v[32:47], v[96:99], v[8:11], 0
    v_mfma_f32_32x32x16_bf16 v[32:47], v[104:107], v[12:15], v[32:47]
    s_nop 15
    v_max3_f32 v0, v32, v33, v34
    v_max3_f32 v0, v0, v35, v36
    v_max3_f32 v0, v0, v37, v38
    v_max3_f32 v0, v0, v39, v40
    v_max3_f32 v0, v0, v41, v42
    v_max3_f32 v0, v0, v43, v44
    v_max3_f32 v0, v0, v45, v46
    v_max_f32 v0, v0, v47
    v_mov_b32 v64, v0
    s_nop 1
    v_permlane32_swap_b32 v0, v64
    s_nop 1
    v_max_f32 v0, v0, v64
    v_max_f32 v0, v0, v17
    v_sub_f32 v18, v17, v0
    v_exp_f32 v18, v18
    v_mov_b32 v17, v0
    v_sub_f32 v32, v32, v0
    v_sub_f32 v33, v33, v0
    v_sub_f32 v34, v34, v0
    v_sub_f32 v35, v35, v0
    v_sub_f32 v36, v36, v0
    v_sub_f32 v37, v37, v0
    v_sub_f32 v38, v38, v0
    v_sub_f32 v39, v39, v0
    v_sub_f32 v40, v40, v0
    v_sub_f32 v41, v41, v0
    v_sub_f32 v42, v42, v0
    v_sub_f32 v43, v43, v0
    v_sub_f32 v44, v44, v0
    v_sub_f32 v45, v45, v0
    v_sub_f32 v46, v46, v0
    v_sub_f32 v47, v47, v0
    v_exp_f32 v32, v32
    v_exp_f32 v33, v33
    v_exp_f32 v34, v34
    v_exp_f32 v35, v35
    v_cvt_pk_bf16_f32 v64, v32, v33
    v_exp_f32 v36, v36
    v_exp_f32 v37, v37
    v_cvt_pk_bf16_f32 v65, v34, v35
    v_exp_f32 v38, v38
    v_exp_f32 v39, v39
    v_cvt_pk_bf16_f32 v66, v36, v37
    v_exp_f32 v40, v40
    v_exp_f32 v41, v41
    v_cvt_pk_bf16_f32 v67, v38, v39
    v_exp_f32 v42, v42
    v_exp_f32 v43, v43
    v_cvt_pk_bf16_f32 v68, v40, v41
    v_exp_f32 v44, v44
    v_exp_f32 v45, v45
    v_cvt_pk_bf16_f32 v69, v42, v43
    v_exp_f32 v46, v46
    v_exp_f32 v47, v47
    v_cvt_pk_bf16_f32 v70, v44, v45
    s_nop 0
    v_cvt_pk_bf16_f32 v71, v46, v47
    v_mul_f32 v80, v80, v18
    v_mul_f32 v81, v81, v18
    v_mul_f32 v82, v82, v18
    v_mul_f32 v83, v83, v18
    v_mul_f32 v84, v84, v18
    v_mul_f32 v85, v85, v18
    v_mul_f32 v86, v86, v18
    v_mul_f32 v87, v87, v18
    v_mul_f32 v88, v88, v18
    v_mul_f32 v89, v89, v18
    v_mul_f32 v90, v90, v18
    v_mul_f32 v91, v91, v18
    v_mul_f32 v92, v92, v18
    v_mul_f32 v93, v93, v18
    v_mul_f32 v94, v94, v18
    v_mul_f32 v95, v95, v18
    s_waitcnt lgkmcnt(0)
    s_nop 1
    v_mfma_f32_32x32x16_bf16 v[80:95], v[112:115], v[64:67], v[80:95]
    v_mfma_f32_32x32x16_bf16 v[80:95], v[116:119], v[68:71], v[80:95]
    s_nop 15
    v_add_u32 v5, 1152, v5
    v_add_u32 v6, 1152, v6
    v_add_u32 v7, 1216, v7
    s_add_u32 s22, s22, 1
    s_cmp_lt_u32 s22, 32
    s_cbranch_scc1 attn_kernel_sloop
    v_sub_f32 v16, 0, v17
    s_branch attn_kernel_fin
attn_kernel_end:
    s_endpgm
.text
.globl outb1_kernel
.p2align 8
.type outb1_kernel,@function
outb1_kernel:
    s_cmp_ge_u32 s2, 192
    s_cbranch_scc1 outb1_kernel_end
    s_load_dwordx2 s[8:9], s[0:1], 64
    s_and_b32 s40, s2, 7
    s_lshr_b32 s41, s2, 3
    s_lshl_b32 s12, s40, 2
    s_and_b32 s13, s41, 3
    s_add_u32 s12, s12, s13
    s_lshr_b32 s13, s41, 2
    v_lshrrev_b32 v1, 6, v0
    v_and_b32 v2, 63, v0
    v_readfirstlane_b32 s22, v1
    s_and_b32 s14, s22, 3
    v_and_b32 v3, 31, v2
    v_lshrrev_b32 v4, 5, v2
    v_lshlrev_b32 v5, 4, v2
    s_and_b32 s15, s14, 1
    s_lshr_b32 s16, s14, 1
    s_lshl_b32 s17, s12, 1
    s_add_u32 s17, s17, s15
    v_lshrrev_b32 v6, 4, v3
    v_mul_u32_u24 v6, 18432, v6
    v_and_b32 v7, 15, v3
    v_lshl_add_u32 v6, v7, 4, v6
    v_lshl_add_u32 v6, v4, 3, v6
    s_mul_i32 s18, s17, 36864
    s_mul_i32 s19, s13, 3072
    s_add_u32 s18, s18, s19
    s_add_u32 s19, s18, 0x240000
    s_add_u32 s42, s13, 6
    s_mul_i32 s42, s42, 110592
    s_add_u32 s42, s42, 0x1200000
    s_mul_i32 s43, s16, 55296
    s_mul_i32 s44, s15, 9216
    s_add_u32 s43, s43, s44
    s_add_u32 s42, s42, s43
    s_mul_i32 s44, s16, 55296
    v_add_u32 v14, s44, v5
    s_waitcnt lgkmcnt(0)
    s_mov_b32 s28, s8
    s_mov_b32 s29, s9
    s_mov_b32 s30, 0x1480000
    s_mov_b32 s31, 0x00020000
    s_cmp_lt_u32 s22, 4
    s_cbranch_scc1 outb1_kernel_comp
    s_add_u32 s44, s43, 0
    s_mov_b32 m0, s44
    s_add_u32 s46, s42, 0
    buffer_load_dwordx4 v5, s[28:31], s46 offen lds
    s_add_u32 s44, s43, 1024
    s_mov_b32 m0, s44
    s_add_u32 s46, s42, 1024
    buffer_load_dwordx4 v5, s[28:31], s46 offen lds
    s_add_u32 s44, s43, 2048
    s_mov_b32 m0, s44
    s_add_u32 s46, s42, 2048
    buffer_load_dwordx4 v5, s[28:31], s46 offen lds
    s_add_u32 s44, s43, 3072
    s_mov_b32 m0, s44
    s_add_u32 s46, s42, 3072
    buffer_load_dwordx4 v5, s[28:31], s46 offen lds
    s_add_u32 s44, s43, 4096
    s_mov_b32 m0, s44
    s_add_u32 s46, s42, 4096
    buffer_load_dwordx4 v5, s[28:31], s46 offen lds
    s_add_u32 s44, s43, 5120
    s_mov_b32 m0, s44
    s_add_u32 s46, s42, 5120
    buffer_load_dwordx4 v5, s[28:31], s46 offen lds
    s_add_u32 s44, s43, 6144
    s_mov_b32 m0, s44
    s_add_u32 s46, s42, 6144
    buffer_load_dwordx4 v5, s[28:31], s46 offen lds
    s_add_u32 s44, s43, 7168
    s_mov_b32 m0, s44
    s_add_u32 s46, s42, 7168
    buffer_load_dwordx4 v5, s[28:31], s46 offen lds
    s_add_u32 s44, s43, 8192
    s_mov_b32 m0, s44
    s_add_u32 s46, s42, 8192
    buffer_load_dwordx4 v5, s[28:31], s46 offen lds
    s_add_u32 s44, s43, 18432
    s_mov_b32 m0, s44
    s_add_u32 s46, s42, 18432
    buffer_load_dwordx4 v5, s[28:31], s46 offen lds
    s_add_u32 s44, s43, 19456
    s_mov_b32 m0, s44
    s_add_u32 s46, s42, 19456
    buffer_load_dwordx4 v5, s[28:31], s46 offen lds
    s_add_u32 s44, s43, 20480
    s_mov_b32 m0, s44
    s_add_u32 s46, s42, 20480
    buffer_load_dwordx4 v5, s[28:31], s46 offen lds
    s_add_u32 s44, s43, 21504
    s_mov_b32 m0, s44
    s_add_u32 s46, s42, 21504
    buffer_load_dwordx4 v5, s[28:31], s46 offen lds
    s_add_u32 s44, s43, 22528
    s_mov_b32 m0, s44
    s_add_u32 s46, s42, 22528
    buffer_load_dwordx4 v5, s[28:31], s46 offen lds
    s_add_u32 s44, s43, 23552
    s_mov_b32 m0, s44
    s_add_u32 s46, s42, 23552
    buffer_load_dwordx4 v5, s[28:31], s46 offen lds
    s_add_u32 s44, s43, 24576
    s_mov_b32 m0, s44
    s_add_u32 s46, s42, 24576
    buffer_load_dwordx4 v5, s[28:31], s46 offen lds
    s_add_u32 s44, s43, 25600
    s_mov_b32 m0, s44
    s_add_u32 s46, s42, 25600
    buffer_load_dwordx4 v5, s[28:31], s46 offen lds
    s_add_u32 s44, s43, 26624
    s_mov_b32 m0, s44
    s_add_u32 s46, s42, 26624
    buffer_load_dwordx4 v5, s[28:31], s46 offen lds
    s_add_u32 s44, s43, 36864
    s_mov_b32 m0, s44
    s_add_u32 s46, s42, 36864
    buffer_load_dwordx4 v5, s[28:31], s46 offen lds
    s_add_u32 s44, s43, 37888
    s_mov_b32 m0, s44
    s_add_u32 s46, s42, 37888
    buffer_load_dwordx4 v5, s[28:31], s46 offen lds
    s_add_u32 s44, s43, 38912
    s_mov_b32 m0, s44
    s_add_u32 s46, s42, 38912
    buffer_load_dwordx4 v5, s[28:31], s46 offen lds
    s_add_u32 s44, s43, 39936
    s_mov_b32 m0, s44
    s_add_u32 s46, s42, 39936
    buffer_load_dwordx4 v5, s[28:31], s46 offen lds
    s_add_u32 s44, s43, 40960
    s_mov_b32 m0, s44
    s_add_u32 s46, s42, 40960
    buffer_load_dwordx4 v5, s[28:31], s46 offen lds
    s_add_u32 s44, s43, 41984
    s_mov_b32 m0, s44
    s_add_u32 s46, s42, 41984
    buffer_load_dwordx4 v5, s[28:31], s46 offen lds
    s_add_u32 s44, s43, 43008
    s_mov_b32 m0, s44
    s_add_u32 s46, s42, 43008
    buffer_load_dwordx4 v5, s[28:31], s46 offen lds
    s_add_u32 s44, s43, 44032
    s_mov_b32 m0, s44
    s_add_u32 s46, s42, 44032
    buffer_load_dwordx4 v5, s[28:31], s46 offen lds
    s_add_u32 s44, s43, 45056
    s_mov_b32 m0, s44
    s_add_u32 s46, s42, 45056
    buffer_load_dwordx4 v5, s[28:31], s46 offen lds
    s_waitcnt vmcnt(18)
    s_barrier
    s_waitcnt vmcnt(9)
    s_barrier
    s_waitcnt vmcnt(0)
    s_barrier
    s_endpgm
outb1_kernel_comp:
    s_lshl_b32 s45, s17, 15
    s_lshl_b32 s46, s16, 14
    s_add_u32 s45, s45, s46
    s_add_u32 s45, s45, 0xb80000
    s_lshl_b32 s47, s17, 12
    s_lshl_b32 s46, s16, 11
    s_add_u32 s47, s47, s46
    s_add_u32 s47, s47, 0xd80000
    s_add_u32 s46, s45, 0
    buffer_load_dwordx4 v[16:19], v5, s[28:31], s46 offen
    s_add_u32 s46, s45, 1024
    buffer_load_dwordx4 v[20:23], v5, s[28:31], s46 offen
    s_add_u32 s46, s45, 2048
    buffer_load_dwordx4 v[24:27], v5, s[28:31], s46 offen
    s_add_u32 s46, s45, 3072
    buffer_load_dwordx4 v[28:31], v5, s[28:31], s46 offen
    s_add_u32 s46, s45, 4096
    buffer_load_dwordx4 v[32:35], v5, s[28:31], s46 offen
    s_add_u32 s46, s45, 5120
    buffer_load_dwordx4 v[36:39], v5, s[28:31], s46 offen
    s_add_u32 s46, s45, 6144
    buffer_load_dwordx4 v[40:43], v5, s[28:31], s46 offen
    s_add_u32 s46, s45, 7168
    buffer_load_dwordx4 v[44:47], v5, s[28:31], s46 offen
    s_add_u32 s46, s45, 8192
    buffer_load_dwordx4 v[48:51], v5, s[28:31], s46 offen
    s_add_u32 s46, s45, 9216
    buffer_load_dwordx4 v[52:55], v5, s[28:31], s46 offen
    s_add_u32 s46, s45, 10240
    buffer_load_dwordx4 v[56:59], v5, s[28:31], s46 offen
    s_add_u32 s46, s45, 11264
    buffer_load_dwordx4 v[60:63], v5, s[28:31], s46 offen
    s_add_u32 s46, s45, 12288
    buffer_load_dwordx4 v[64:67], v5, s[28:31], s46 offen
    s_add_u32 s46, s45, 13312
    buffer_load_dwordx4 v[68:71], v5, s[28:31], s46 offen
    s_add_u32 s46, s45, 14336
    buffer_load_dwordx4 v[72:75], v5, s[28:31], s46 offen
    s_add_u32 s46, s45, 15360
    buffer_load_dwordx4 v[76:79], v5, s[28:31], s46 offen
    buffer_load_dwordx4 v[80:83], v5, s[28:31], s47 offen offset:0
    buffer_load_dwordx4 v[88:91], v5, s[28:31], s47 offen offset:1024
    buffer_load_dwordx2 v[96:97], v6, s[28:31], s19 offen offset:0
    buffer_load_dwordx2 v[98:99], v6, s[28:31], s19 offen offset:256
    buffer_load_dwordx2 v[100:101], v6, s[28:31], s19 offen offset:512
    buffer_load_dwordx2 v[102:103], v6, s[28:31], s19 offen offset:768
    buffer_load_dwordx2 v[104:105], v6, s[28:31], s19 offen offset:1024
    buffer_load_dwordx2 v[106:107], v6, s[28:31], s19 offen offset:1280
    buffer_load_dwordx2 v[108:109], v6, s[28:31], s19 offen offset:1536
    buffer_load_dwordx2 v[110:111], v6, s[28:31], s19 offen offset:1792
    buffer_load_dwordx2 v[112:113], v6, s[28:31], s19 offen offset:2048
    buffer_load_dwordx2 v[114:115], v6, s[28:31], s19 offen offset:2304
    buffer_load_dwordx2 v[116:117], v6, s[28:31], s19 offen offset:2560
    buffer_load_dwordx2 v[118:119], v6, s[28:31], s19 offen offset:2816
    s_waitcnt vmcnt(24)
    s_barrier
    ds_read_b128 v[120:123], v14 offset:0
    ds_read_b128 v[124:127], v14 offset:1024
    ds_read_b128 v[128:131], v14 offset:2048
    ds_read_b128 v[132:135], v14 offset:3072
    ds_read_b128 v[136:139], v14 offset:4096
    ds_read_b128 v[140:143], v14 offset:5120
    s_waitcnt lgkmcnt(5)
    v_mfma_f32_32x32x16_bf16 v[144:159], v[120:123], v[16:19], 0
    ds_read_b128 v[120:123], v14 offset:6144
    s_waitcnt lgkmcnt(5)
    v_mfma_f32_32x32x16_bf16 v[160:175], v[124:127], v[16:19], 0
    ds_read_b128 v[124:127], v14 offset:7168
    s_waitcnt lgkmcnt(5)
    v_mfma_f32_32x32x16_bf16 v[176:191], v[128:131], v[16:19], 0
    ds_read_b128 v[128:131], v14 offset:8192
    s_waitcnt lgkmcnt(5)
    v_mfma_f32_32x32x16_bf16 v[144:159], v[132:135], v[20:23], v[144:159]
    ds_read_b128 v[132:135], v14 offset:9216
    s_waitcnt lgkmcnt(5)
    v_mfma_f32_32x32x16_bf16 v[160:175], v[136:139], v[20:23], v[160:175]
    ds_read_b128 v[136:139], v14 offset:10240
    s_waitcnt lgkmcnt(5)
    v_mfma_f32_32x32x16_bf16 v[176:191], v[140:143], v[20:23], v[176:191]
    ds_read_b128 v[140:143], v14 offset:11264
    s_waitcnt lgkmcnt(5)
    v_mfma_f32_32x32x16_bf16 v[144:159], v[120:123], v[24:27], v[144:159]
    ds_read_b128 v[120:123], v14 offset:12288
    s_waitcnt lgkmcnt(5)
    v_mfma_f32_32x32x16_bf16 v[160:175], v[124:127], v[24:27], v[160:175]
    ds_read_b128 v[124:127], v14 offset:13312
    s_waitcnt lgkmcnt(5)
    v_mfma_f32_32x32x16_bf16 v[176:191], v[128:131], v[24:27], v[176:191]
    ds_read_b128 v[128:131], v14 offset:14336
    s_waitcnt lgkmcnt(5)
    v_mfma_f32_32x32x16_bf16 v[144:159], v[132:135], v[28:31], v[144:159]
    ds_read_b128 v[132:135], v14 offset:15360
    s_waitcnt lgkmcnt(5)
    v_mfma_f32_32x32x16_bf16 v[160:175], v[136:139], v[28:31], v[160:175]
    ds_read_b128 v[136:139], v14 offset:16384
    s_waitcnt lgkmcnt(5)
    v_mfma_f32_32x32x16_bf16 v[176:191], v[140:143], v[28:31], v[176:191]
    ds_read_b128 v[140:143], v14 offset:17408
    s_waitcnt lgkmcnt(5)
    v_mfma_f32_32x32x16_bf16 v[144:159], v[120:123], v[32:35], v[144:159]
    s_waitcnt lgkmcnt(4)
    v_mfma_f32_32x32x16_bf16 v[160:175], v[124:127], v[32:35], v[160:175]
    s_waitcnt lgkmcnt(3)
    v_mfma_f32_32x32x16_bf16 v[176:191], v[128:131], v[32:35], v[176:191]
    s_waitcnt lgkmcnt(2)
    v_mfma_f32_32x32x16_bf16 v[144:159], v[132:135], v[36:39], v[144:159]
    s_waitcnt lgkmcnt(1)
    v_mfma_f32_32x32x16_bf16 v[160:175], v[136:139], v[36:39], v[160:175]
    s_waitcnt lgkmcnt(0)
    v_mfma_f32_32x32x16_bf16 v[176:191], v[140:143], v[36:39], v[176:191]
    s_waitcnt vmcnt(18)
    s_barrier
    ds_read_b128 v[120:123], v14 offset:18432
    ds_read_b128 v[124:127], v14 offset:19456
    ds_read_b128 v[128:131], v14 offset:20480
    ds_read_b128 v[132:135], v14 offset:21504
    ds_read_b128 v[136:139], v14 offset:22528
    ds_read_b128 v[140:143], v14 offset:23552
    s_waitcnt lgkmcnt(5)
    v_mfma_f32_32x32x16_bf16 v[144:159], v[120:123], v[40:43], v[144:159]
    ds_read_b128 v[120:123], v14 offset:24576
    s_waitcnt lgkmcnt(5)
    v_mfma_f32_32x32x16_bf16 v[160:175], v[124:127], v[40:43], v[160:175]
    ds_read_b128 v[124:127], v14 offset:25600
    s_waitcnt lgkmcnt(5)
    v_mfma_f32_32x32x16_bf16 v[176:191], v[128:131], v[40:43], v[176:191]
    ds_read_b128 v[128:131], v14 offset:26624
    s_waitcnt lgkmcnt(5)
    v_mfma_f32_32x32x16_bf16 v[144:159], v[132:135], v[44:47], v[144:159]
    ds_read_b128 v[132:135], v14 offset:27648
    s_waitcnt lgkmcnt(5)
    v_mfma_f32_32x32x16_bf16 v[160:175], v[136:139], v[44:47], v[160:175]
    ds_read_b128 v[136:139], v14 offset:28672
    s_waitcnt lgkmcnt(5)
    v_mfma_f32_32x32x16_bf16 v[176:191], v[140:143], v[44:47], v[176:191]
    ds_read_b128 v[140:143], v14 offset:29696
    s_waitcnt lgkmcnt(5)
    v_mfma_f32_32x32x16_bf16 v[144:159], v[120:123], v[48:51], v[144:159]
    ds_read_b128 v[120:123], v14 offset:30720
    s_waitcnt lgkmcnt(5)
    v_mfma_f32_32x32x16_bf16 v[160:175], v[124:127], v[48:51], v[160:175]
    ds_read_b128 v[124:127], v14 offset:31744
    s_waitcnt lgkmcnt(5)
    v_mfma_f32_32x32x16_bf16 v[176:191], v[128:131], v[48:51], v[176:191]
    ds_read_b128 v[128:131], v14 offset:32768
    s_waitcnt lgkmcnt(5)
    v_mfma_f32_32x32x16_bf16 v[144:159], v[132:135], v[52:55], v[144:159]
    ds_read_b128 v[132:135], v14 offset:33792
    s_waitcnt lgkmcnt(5)
    v_mfma_f32_32x32x16_bf16 v[160:175], v[136:139], v[52:55], v[160:175]
    ds_read_b128 v[136:139], v14 offset:34816
    s_waitcnt lgkmcnt(5)
    v_mfma_f32_32x32x16_bf16 v[176:191], v[140:143], v[52:55], v[176:191]
    ds_read_b128 v[140:143], v14 offset:35840
    s_waitcnt lgkmcnt(5)
    v_mfma_f32_32x32x16_bf16 v[144:159], v[120:123], v[56:59], v[144:159]
    s_waitcnt lgkmcnt(4)
    v_mfma_f32_32x32x16_bf16 v[160:175], v[124:127], v[56:59], v[160:175]
    s_waitcnt lgkmcnt(3)
    v_mfma_f32_32x32x16_bf16 v[176:191], v[128:131], v[56:59], v[176:191]
    s_waitcnt lgkmcnt(2)
    v_mfma_f32_32x32x16_bf16 v[144:159], v[132:135], v[60:63], v[144:159]
    s_waitcnt lgkmcnt(1)
    v_mfma_f32_32x32x16_bf16 v[160:175], v[136:139], v[60:63], v[160:175]
    s_waitcnt lgkmcnt(0)
    v_mfma_f32_32x32x16_bf16 v[176:191], v[140:143], v[60:63], v[176:191]
    s_waitcnt vmcnt(12)
    s_barrier
    ds_read_b128 v[120:123], v14 offset:36864
    ds_read_b128 v[124:127], v14 offset:37888
    ds_read_b128 v[128:131], v14 offset:38912
    ds_read_b128 v[132:135], v14 offset:39936
    ds_read_b128 v[136:139], v14 offset:40960
    ds_read_b128 v[140:143], v14 offset:41984
    s_waitcnt lgkmcnt(5)
    v_mfma_f32_32x32x16_bf16 v[144:159], v[120:123], v[64:67], v[144:159]
    ds_read_b128 v[120:123], v14 offset:43008
    s_waitcnt lgkmcnt(5)
    v_mfma_f32_32x32x16_bf16 v[160:175], v[124:127], v[64:67], v[160:175]
    ds_read_b128 v[124:127], v14 offset:44032
    s_waitcnt lgkmcnt(5)
    v_mfma_f32_32x32x16_bf16 v[176:191], v[128:131], v[64:67], v[176:191]
    ds_read_b128 v[128:131], v14 offset:45056
    s_waitcnt lgkmcnt(5)
    v_mfma_f32_32x32x16_bf16 v[144:159], v[132:135], v[68:71], v[144:159]
    ds_read_b128 v[132:135], v14 offset:46080
    s_waitcnt lgkmcnt(5)
    v_mfma_f32_32x32x16_bf16 v[160:175], v[136:139], v[68:71], v[160:175]
    ds_read_b128 v[136:139], v14 offset:47104
    s_waitcnt lgkmcnt(5)
    v_mfma_f32_32x32x16_bf16 v[176:191], v[140:143], v[68:71], v[176:191]
    ds_read_b128 v[140:143], v14 offset:48128
    s_waitcnt lgkmcnt(5)
    v_mfma_f32_32x32x16_bf16 v[144:159], v[120:123], v[72:75], v[144:159]
    ds_read_b128 v[120:123], v14 offset:49152
    s_waitcnt lgkmcnt(5)
    v_mfma_f32_32x32x16_bf16 v[160:175], v[124:127], v[72:75], v[160:175]
    ds_read_b128 v[124:127], v14 offset:50176
    s_waitcnt lgkmcnt(5)
    v_mfma_f32_32x32x16_bf16 v[176:191], v[128:131], v[72:75], v[176:191]
    ds_read_b128 v[128:131], v14 offset:51200
    s_waitcnt lgkmcnt(5)
    v_mfma_f32_32x32x16_bf16 v[144:159], v[132:135], v[76:79], v[144:159]
    ds_read_b128 v[132:135], v14 offset:52224
    s_waitcnt lgkmcnt(5)
    v_mfma_f32_32x32x16_bf16 v[160:175], v[136:139], v[76:79], v[160:175]
    ds_read_b128 v[136:139], v14 offset:53248
    s_waitcnt lgkmcnt(5)
    v_mfma_f32_32x32x16_bf16 v[176:191], v[140:143], v[76:79], v[176:191]
    ds_read_b128 v[140:143], v14 offset:54272
    s_waitcnt lgkmcnt(5)
    v_mfma_f32_32x32x16_bf16 v[144:159], v[120:123], v[80:83], v[144:159]
    s_waitcnt lgkmcnt(4)
    v_mfma_f32_32x32x16_bf16 v[160:175], v[124:127], v[80:83], v[160:175]
    s_waitcnt lgkmcnt(3)
    v_mfma_f32_32x32x16_bf16 v[176:191], v[128:131], v[80:83], v[176:191]
    s_waitcnt lgkmcnt(2)
    v_mfma_f32_32x32x16_bf16 v[144:159], v[132:135], v[88:91], v[144:159]
    s_waitcnt lgkmcnt(1)
    v_mfma_f32_32x32x16_bf16 v[160:175], v[136:139], v[88:91], v[160:175]
    s_waitcnt lgkmcnt(0)
    v_mfma_f32_32x32x16_bf16 v[176:191], v[140:143], v[88:91], v[176:191]
    s_mul_i32 s44, s15, 12288
    s_add_u32 s44, s44, 110592
    v_add_u32 v10, s44, v5
    s_cmp_eq_u32 s16, 0
    s_cbranch_scc1 outb1_kernel_k0
    s_nop 11
    ds_write_b128 v10, v[144:147] offset:0
    ds_write_b128 v10, v[148:151] offset:1024
    ds_write_b128 v10, v[152:155] offset:2048
    ds_write_b128 v10, v[156:159] offset:3072
    ds_write_b128 v10, v[160:163] offset:4096
    ds_write_b128 v10, v[164:167] offset:5120
    ds_write_b128 v10, v[168:171] offset:6144
    ds_write_b128 v10, v[172:175] offset:7168
    ds_write_b128 v10, v[176:179] offset:8192
    ds_write_b128 v10, v[180:183] offset:9216
    ds_write_b128 v10, v[184:187] offset:10240
    ds_write_b128 v10, v[188:191] offset:11264
    s_waitcnt lgkmcnt(0)
    s_barrier
    s_endpgm
outb1_kernel_k0:
    s_add_u32 s44, s18, 0x0
    s_waitcnt vmcnt(0)
    v_lshlrev_b32 v16, 16, v96
    v_and_b32 v17, 0xffff0000, v96
    v_lshlrev_b32 v18, 16, v97
    v_and_b32 v19, 0xffff0000, v97
    v_lshlrev_b32 v20, 16, v98
    v_and_b32 v21, 0xffff0000, v98
    v_lshlrev_b32 v22, 16, v99
    v_and_b32 v23, 0xffff0000, v99
    v_lshlrev_b32 v24, 16, v100
    v_and_b32 v25, 0xffff0000, v100
    v_lshlrev_b32 v26, 16, v101
    v_and_b32 v27, 0xffff0000, v101
    v_lshlrev_b32 v28, 16, v102
    v_and_b32 v29, 0xffff0000, v102
    v_lshlrev_b32 v30, 16, v103
    v_and_b32 v31, 0xffff0000, v103
    v_lshlrev_b32 v32, 16, v104
    v_and_b32 v33, 0xffff0000, v104
    v_lshlrev_b32 v34, 16, v105
    v_and_b32 v35, 0xffff0000, v105
    v_lshlrev_b32 v36, 16, v106
    v_and_b32 v37, 0xffff0000, v106
    v_lshlrev_b32 v38, 16, v107
    v_and_b32 v39, 0xffff0000, v107
    v_lshlrev_b32 v40, 16, v108
    v_and_b32 v41, 0xffff0000, v108
    v_lshlrev_b32 v42, 16, v109
    v_and_b32 v43, 0xffff0000, v109
    v_lshlrev_b32 v44, 16, v110
    v_and_b32 v45, 0xffff0000, v110
    v_lshlrev_b32 v46, 16, v111
    v_and_b32 v47, 0xffff0000, v111
    v_lshlrev_b32 v48, 16, v112
    v_and_b32 v49, 0xffff0000, v112
    v_lshlrev_b32 v50, 16, v113
    v_and_b32 v51, 0xffff0000, v113
    v_lshlrev_b32 v52, 16, v114
    v_and_b32 v53, 0xffff0000, v114
    v_lshlrev_b32 v54, 16, v115
    v_and_b32 v55, 0xffff0000, v115
    v_lshlrev_b32 v56, 16, v116
    v_and_b32 v57, 0xffff0000, v116
    v_lshlrev_b32 v58, 16, v117
    v_and_b32 v59, 0xffff0000, v117
    v_lshlrev_b32 v60, 16, v118
    v_and_b32 v61, 0xffff0000, v118
    v_lshlrev_b32 v62, 16, v119
    v_and_b32 v63, 0xffff0000, v119
    v_add_f32 v144, v144, v16
    v_add_f32 v145, v145, v17
    v_add_f32 v146, v146, v18
    v_add_f32 v147, v147, v19
    v_add_f32 v148, v148, v20
    v_add_f32 v149, v149, v21
    v_add_f32 v150, v150, v22
    v_add_f32 v151, v151, v23
    v_add_f32 v152, v152, v24
    v_add_f32 v153, v153, v25
    v_add_f32 v154, v154, v26
    v_add_f32 v155, v155, v27
    v_add_f32 v156, v156, v28
    v_add_f32 v157, v157, v29
    v_add_f32 v158, v158, v30
    v_add_f32 v159, v159, v31
    v_add_f32 v160, v160, v32
    v_add_f32 v161, v161, v33
    v_add_f32 v162, v162, v34
    v_add_f32 v163, v163, v35
    v_add_f32 v164, v164, v36
    v_add_f32 v165, v165, v37
    v_add_f32 v166, v166, v38
    v_add_f32 v167, v167, v39
    v_add_f32 v168, v168, v40
    v_add_f32 v169, v169, v41
    v_add_f32 v170, v170, v42
    v_add_f32 v171, v171, v43
    v_add_f32 v172, v172, v44
    v_add_f32 v173, v173, v45
    v_add_f32 v174, v174, v46
    v_add_f32 v175, v175, v47
    v_add_f32 v176, v176, v48
    v_add_f32 v177, v177, v49
    v_add_f32 v178, v178, v50
    v_add_f32 v179, v179, v51
    v_add_f32 v180, v180, v52
    v_add_f32 v181, v181, v53
    v_add_f32 v182, v182, v54
    v_add_f32 v183, v183, v55
    v_add_f32 v184, v184, v56
    v_add_f32 v185, v185, v57
    v_add_f32 v186, v186, v58
    v_add_f32 v187, v187, v59
    v_add_f32 v188, v188, v60
    v_add_f32 v189, v189, v61
    v_add_f32 v190, v190, v62
    v_add_f32 v191, v191, v63
    s_barrier
    ds_read_b128 v[192:195], v10 offset:0
    ds_read_b128 v[196:199], v10 offset:1024
    ds_read_b128 v[200:203], v10 offset:2048
    ds_read_b128 v[204:207], v10 offset:3072
    ds_read_b128 v[208:211], v10 offset:4096
    ds_read_b128 v[212:215], v10 offset:5120
    ds_read_b128 v[216:219], v10 offset:6144
    ds_read_b128 v[220:223], v10 offset:7168
    ds_read_b128 v[224:227], v10 offset:8192
    ds_read_b128 v[228:231], v10 offset:9216
    ds_read_b128 v[232:235], v10 offset:10240
    ds_read_b128 v[236:239], v10 offset:11264
    v_mov_b32 v8, 0
    v_mov_b32 v9, 0
    v_mov_b32 v11, 0x3f803f80
    s_waitcnt lgkmcnt(11)
    v_add_f32 v144, v144, v192
    v_add_f32 v145, v145, v193
    v_add_f32 v146, v146, v194
    v_add_f32 v147, v147, v195
    v_cvt_pk_bf16_f32 v96, v144, v145
    v_cvt_pk_bf16_f32 v97, v146, v147
    buffer_store_dwordx2 v[96:97], v6, s[28:31], s44 offen offset:0 sc1
    v_dot2_f32_bf16 v8, v96, v11, v8
    v_dot2_f32_bf16 v9, v96, v96, v9
    v_dot2_f32_bf16 v8, v97, v11, v8
    v_dot2_f32_bf16 v9, v97, v97, v9
    s_waitcnt lgkmcnt(10)
    v_add_f32 v148, v148, v196
    v_add_f32 v149, v149, v197
    v_add_f32 v150, v150, v198
    v_add_f32 v151, v151, v199
    v_cvt_pk_bf16_f32 v98, v148, v149
    v_cvt_pk_bf16_f32 v99, v150, v151
    buffer_store_dwordx2 v[98:99], v6, s[28:31], s44 offen offset:256 sc1
    v_dot2_f32_bf16 v8, v98, v11, v8
    v_dot2_f32_bf16 v9, v98, v98, v9
    v_dot2_f32_bf16 v8, v99, v11, v8
    v_dot2_f32_bf16 v9, v99, v99, v9
    s_waitcnt lgkmcnt(9)
    v_add_f32 v152, v152, v200
    v_add_f32 v153, v153, v201
    v_add_f32 v154, v154, v202
    v_add_f32 v155, v155, v203
    v_cvt_pk_bf16_f32 v100, v152, v153
    v_cvt_pk_bf16_f32 v101, v154, v155
    buffer_store_dwordx2 v[100:101], v6, s[28:31], s44 offen offset:512 sc1
    v_dot2_f32_bf16 v8, v100, v11, v8
    v_dot2_f32_bf16 v9, v100, v100, v9
    v_dot2_f32_bf16 v8, v101, v11, v8
    v_dot2_f32_bf16 v9, v101, v101, v9
    s_waitcnt lgkmcnt(8)
    v_add_f32 v156, v156, v204
    v_add_f32 v157, v157, v205
    v_add_f32 v158, v158, v206
    v_add_f32 v159, v159, v207
    v_cvt_pk_bf16_f32 v102, v156, v157
    v_cvt_pk_bf16_f32 v103, v158, v159
    buffer_store_dwordx2 v[102:103], v6, s[28:31], s44 offen offset:768 sc1
    v_dot2_f32_bf16 v8, v102, v11, v8
    v_dot2_f32_bf16 v9, v102, v102, v9
    v_dot2_f32_bf16 v8, v103, v11, v8
    v_dot2_f32_bf16 v9, v103, v103, v9
    s_waitcnt lgkmcnt(7)
    v_add_f32 v160, v160, v208
    v_add_f32 v161, v161, v209
    v_add_f32 v162, v162, v210
    v_add_f32 v163, v163, v211
    v_cvt_pk_bf16_f32 v104, v160, v161
    v_cvt_pk_bf16_f32 v105, v162, v163
    buffer_store_dwordx2 v[104:105], v6, s[28:31], s44 offen offset:1024 sc1
    v_dot2_f32_bf16 v8, v104, v11, v8
    v_dot2_f32_bf16 v9, v104, v104, v9
    v_dot2_f32_bf16 v8, v105, v11, v8
    v_dot2_f32_bf16 v9, v105, v105, v9
    s_waitcnt lgkmcnt(6)
    v_add_f32 v164, v164, v212
    v_add_f32 v165, v165, v213
    v_add_f32 v166, v166, v214
    v_add_f32 v167, v167, v215
    v_cvt_pk_bf16_f32 v106, v164, v165
    v_cvt_pk_bf16_f32 v107, v166, v167
    buffer_store_dwordx2 v[106:107], v6, s[28:31], s44 offen offset:1280 sc1
    v_dot2_f32_bf16 v8, v106, v11, v8
    v_dot2_f32_bf16 v9, v106, v106, v9
    v_dot2_f32_bf16 v8, v107, v11, v8
    v_dot2_f32_bf16 v9, v107, v107, v9
    s_waitcnt lgkmcnt(5)
    v_add_f32 v168, v168, v216
    v_add_f32 v169, v169, v217
    v_add_f32 v170, v170, v218
    v_add_f32 v171, v171, v219
    v_cvt_pk_bf16_f32 v108, v168, v169
    v_cvt_pk_bf16_f32 v109, v170, v171
    buffer_store_dwordx2 v[108:109], v6, s[28:31], s44 offen offset:1536 sc1
    v_dot2_f32_bf16 v8, v108, v11, v8
    v_dot2_f32_bf16 v9, v108, v108, v9
    v_dot2_f32_bf16 v8, v109, v11, v8
    v_dot2_f32_bf16 v9, v109, v109, v9
    s_waitcnt lgkmcnt(4)
    v_add_f32 v172, v172, v220
    v_add_f32 v173, v173, v221
    v_add_f32 v174, v174, v222
    v_add_f32 v175, v175, v223
    v_cvt_pk_bf16_f32 v110, v172, v173
    v_cvt_pk_bf16_f32 v111, v174, v175
    buffer_store_dwordx2 v[110:111], v6, s[28:31], s44 offen offset:1792 sc1
    v_dot2_f32_bf16 v8, v110, v11, v8
    v_dot2_f32_bf16 v9, v110, v110, v9
    v_dot2_f32_bf16 v8, v111, v11, v8
    v_dot2_f32_bf16 v9, v111, v111, v9
    s_waitcnt lgkmcnt(3)
    v_add_f32 v176, v176, v224
    v_add_f32 v177, v177, v225
    v_add_f32 v178, v178, v226
    v_add_f32 v179, v179, v227
    v_cvt_pk_bf16_f32 v112, v176, v177
    v_cvt_pk_bf16_f32 v113, v178, v179
    buffer_store_dwordx2 v[112:113], v6, s[28:31], s44 offen offset:2048 sc1
    v_dot2_f32_bf16 v8, v112, v11, v8
    v_dot2_f32_bf16 v9, v112, v112, v9
    v_dot2_f32_bf16 v8, v113, v11, v8
    v_dot2_f32_bf16 v9, v113, v113, v9
    s_waitcnt lgkmcnt(2)
    v_add_f32 v180, v180, v228
    v_add_f32 v181, v181, v229
    v_add_f32 v182, v182, v230
    v_add_f32 v183, v183, v231
    v_cvt_pk_bf16_f32 v114, v180, v181
    v_cvt_pk_bf16_f32 v115, v182, v183
    buffer_store_dwordx2 v[114:115], v6, s[28:31], s44 offen offset:2304 sc1
    v_dot2_f32_bf16 v8, v114, v11, v8
    v_dot2_f32_bf16 v9, v114, v114, v9
    v_dot2_f32_bf16 v8, v115, v11, v8
    v_dot2_f32_bf16 v9, v115, v115, v9
    s_waitcnt lgkmcnt(1)
    v_add_f32 v184, v184, v232
    v_add_f32 v185, v185, v233
    v_add_f32 v186, v186, v234
    v_add_f32 v187, v187, v235
    v_cvt_pk_bf16_f32 v116, v184, v185
    v_cvt_pk_bf16_f32 v117, v186, v187
    buffer_store_dwordx2 v[116:117], v6, s[28:31], s44 offen offset:2560 sc1
    v_dot2_f32_bf16 v8, v116, v11, v8
    v_dot2_f32_bf16 v9, v116, v116, v9
    v_dot2_f32_bf16 v8, v117, v11, v8
    v_dot2_f32_bf16 v9, v117, v117, v9
    s_waitcnt lgkmcnt(0)
    v_add_f32 v188, v188, v236
    v_add_f32 v189, v189, v237
    v_add_f32 v190, v190, v238
    v_add_f32 v191, v191, v239
    v_cvt_pk_bf16_f32 v118, v188, v189
    v_cvt_pk_bf16_f32 v119, v190, v191
    buffer_store_dwordx2 v[118:119], v6, s[28:31], s44 offen offset:2816 sc1
    v_dot2_f32_bf16 v8, v118, v11, v8
    v_dot2_f32_bf16 v9, v118, v118, v9
    v_dot2_f32_bf16 v8, v119, v11, v8
    v_dot2_f32_bf16 v9, v119, v119, v9
    s_nop 3
    v_mov_b32 v12, v8
    v_mov_b32 v13, v9
    s_nop 1
    v_permlane32_swap_b32 v8, v12
    v_permlane32_swap_b32 v9, v13
    s_nop 1
    v_add_f32 v8, v8, v12
    v_add_f32 v9, v9, v13
    s_lshl_b32 s44, s17, 5
    v_add_u32 v7, s44, v3
    v_mul_u32_u24 v7, 48, v7
    s_lshl_b32 s44, s13, 3
    s_add_u32 s44, s44, 0x13b0000
    v_cmp_gt_u32 vcc, 32, v2
    s_mov_b64 exec, vcc
    buffer_store_dwordx2 v[8:9], v7, s[28:31], s44 offen sc1
    s_mov_b64 exec, -1
outb1_kernel_end:
    s_endpgm
.text
.globl outb2_kernel
.p2align 8
.type outb2_kernel,@function
outb2_kernel:
    s_cmp_ge_u32 s2, 192
    s_cbranch_scc1 outb2_kernel_end
    s_load_dwordx2 s[8:9], s[0:1], 64
    s_load_dwordx2 s[10:11], s[0:1], 48
    s_and_b32 s40, s2, 7
    s_lshr_b32 s41, s2, 3
    s_lshl_b32 s12, s40, 2
    s_and_b32 s13, s41, 3
    s_add_u32 s12, s12, s13
    s_lshr_b32 s13, s41, 2
    v_lshrrev_b32 v1, 6, v0
    v_and_b32 v2, 63, v0
    v_readfirstlane_b32 s22, v1
    s_and_b32 s14, s22, 3
    v_and_b32 v3, 31, v2
    v_lshrrev_b32 v4, 5, v2
    v_lshlrev_b32 v5, 4, v2
    s_and_b32 s15, s14, 1
    s_lshr_b32 s16, s14, 1
    s_lshl_b32 s17, s12, 1
    s_add_u32 s17, s17, s15
    v_lshrrev_b32 v6, 4, v3
    v_mul_u32_u24 v6, 18432, v6
    v_and_b32 v7, 15, v3
    v_lshl_add_u32 v6, v7, 4, v6
    v_lshl_add_u32 v6, v4, 3, v6
    s_mul_i32 s18, s17, 36864
    s_mul_i32 s19, s13, 3072
    s_add_u32 s18, s18, s19
    s_add_u32 s19, s18, 0x240000
    s_add_u32 s42, s13, 6
    s_mul_i32 s42, s42, 110592
    s_add_u32 s42, s42, 0x1200000
    s_mul_i32 s43, s16, 55296
    s_mul_i32 s44, s15, 9216
    s_add_u32 s43, s43, s44
    s_add_u32 s42, s42, s43
    s_mul_i32 s44, s16, 55296
    v_add_u32 v14, s44, v5
    s_waitcnt lgkmcnt(0)
    s_mov_b32 s28, s8
    s_mov_b32 s29, s9
    s_mov_b32 s30, 0x1480000
    s_mov_b32 s31, 0x00020000
    s_mov_b32 s32, s10
    s_mov_b32 s33, s11
    s_mov_b32 s34, 0x240000
    s_mov_b32 s35, 0x00020000
    s_cmp_lt_u32 s22, 4
    s_cbranch_scc1 outb2_kernel_comp
    s_add_u32 s44, s43, 0
    s_mov_b32 m0, s44
    s_add_u32 s46, s42, 0
    buffer_load_dwordx4 v5, s[28:31], s46 offen lds
    s_add_u32 s44, s43, 1024
    s_mov_b32 m0, s44
    s_add_u32 s46, s42, 1024
    buffer_load_dwordx4 v5, s[28:31], s46 offen lds
    s_add_u32 s44, s43, 2048
    s_mov_b32 m0, s44
    s_add_u32 s46, s42, 2048
    buffer_load_dwordx4 v5, s[28:31], s46 offen lds
    s_add_u32 s44, s43, 3072
    s_mov_b32 m0, s44
    s_add_u32 s46, s42, 3072
    buffer_load_dwordx4 v5, s[28:31], s46 offen lds
    s_add_u32 s44, s43, 4096
    s_mov_b32 m0, s44
    s_add_u32 s46, s42, 4096
    buffer_load_dwordx4 v5, s[28:31], s46 offen lds
    s_add_u32 s44, s43, 5120
    s_mov_b32 m0, s44
    s_add_u32 s46, s42, 5120
    buffer_load_dwordx4 v5, s[28:31], s46 offen lds
    s_add_u32 s44, s43, 6144
    s_mov_b32 m0, s44
    s_add_u32 s46, s42, 6144
    buffer_load_dwordx4 v5, s[28:31], s46 offen lds
    s_add_u32 s44, s43, 7168
    s_mov_b32 m0, s44
    s_add_u32 s46, s42, 7168
    buffer_load_dwordx4 v5, s[28:31], s46 offen lds
    s_add_u32 s44, s43, 8192
    s_mov_b32 m0, s44
    s_add_u32 s46, s42, 8192
    buffer_load_dwordx4 v5, s[28:31], s46 offen lds
    s_add_u32 s44, s43, 18432
    s_mov_b32 m0, s44
    s_add_u32 s46, s42, 18432
    buffer_load_dwordx4 v5, s[28:31], s46 offen lds
    s_add_u32 s44, s43, 19456
    s_mov_b32 m0, s44
    s_add_u32 s46, s42, 19456
    buffer_load_dwordx4 v5, s[28:31], s46 offen lds
    s_add_u32 s44, s43, 20480
    s_mov_b32 m0, s44
    s_add_u32 s46, s42, 20480
    buffer_load_dwordx4 v5, s[28:31], s46 offen lds
    s_add_u32 s44, s43, 21504
    s_mov_b32 m0, s44
    s_add_u32 s46, s42, 21504
    buffer_load_dwordx4 v5, s[28:31], s46 offen lds
    s_add_u32 s44, s43, 22528
    s_mov_b32 m0, s44
    s_add_u32 s46, s42, 22528
    buffer_load_dwordx4 v5, s[28:31], s46 offen lds
    s_add_u32 s44, s43, 23552
    s_mov_b32 m0, s44
    s_add_u32 s46, s42, 23552
    buffer_load_dwordx4 v5, s[28:31], s46 offen lds
    s_add_u32 s44, s43, 24576
    s_mov_b32 m0, s44
    s_add_u32 s46, s42, 24576
    buffer_load_dwordx4 v5, s[28:31], s46 offen lds
    s_add_u32 s44, s43, 25600
    s_mov_b32 m0, s44
    s_add_u32 s46, s42, 25600
    buffer_load_dwordx4 v5, s[28:31], s46 offen lds
    s_add_u32 s44, s43, 26624
    s_mov_b32 m0, s44
    s_add_u32 s46, s42, 26624
    buffer_load_dwordx4 v5, s[28:31], s46 offen lds
    s_add_u32 s44, s43, 36864
    s_mov_b32 m0, s44
    s_add_u32 s46, s42, 36864
    buffer_load_dwordx4 v5, s[28:31], s46 offen lds
    s_add_u32 s44, s43, 37888
    s_mov_b32 m0, s44
    s_add_u32 s46, s42, 37888
    buffer_load_dwordx4 v5, s[28:31], s46 offen lds
    s_add_u32 s44, s43, 38912
    s_mov_b32 m0, s44
    s_add_u32 s46, s42, 38912
    buffer_load_dwordx4 v5, s[28:31], s46 offen lds
    s_add_u32 s44, s43, 39936
    s_mov_b32 m0, s44
    s_add_u32 s46, s42, 39936
    buffer_load_dwordx4 v5, s[28:31], s46 offen lds
    s_add_u32 s44, s43, 40960
    s_mov_b32 m0, s44
    s_add_u32 s46, s42, 40960
    buffer_load_dwordx4 v5, s[28:31], s46 offen lds
    s_add_u32 s44, s43, 41984
    s_mov_b32 m0, s44
    s_add_u32 s46, s42, 41984
    buffer_load_dwordx4 v5, s[28:31], s46 offen lds
    s_add_u32 s44, s43, 43008
    s_mov_b32 m0, s44
    s_add_u32 s46, s42, 43008
    buffer_load_dwordx4 v5, s[28:31], s46 offen lds
    s_add_u32 s44, s43, 44032
    s_mov_b32 m0, s44
    s_add_u32 s46, s42, 44032
    buffer_load_dwordx4 v5, s[28:31], s46 offen lds
    s_add_u32 s44, s43, 45056
    s_mov_b32 m0, s44
    s_add_u32 s46, s42, 45056
    buffer_load_dwordx4 v5, s[28:31], s46 offen lds
    s_waitcnt vmcnt(18)
    s_barrier
    s_waitcnt vmcnt(9)
    s_barrier
    s_waitcnt vmcnt(0)
    s_barrier
    s_endpgm
outb2_kernel_comp:
    s_lshl_b32 s45, s17, 15
    s_lshl_b32 s46, s16, 14
    s_add_u32 s45, s45, s46
    s_add_u32 s45, s45, 0xb80000
    s_lshl_b32 s47, s17, 12
    s_lshl_b32 s46, s16, 11
    s_add_u32 s47, s47, s46
    s_add_u32 s47, s47, 0xd80000
    s_add_u32 s46, s45, 0
    buffer_load_dwordx4 v[16:19], v5, s[28:31], s46 offen
    s_add_u32 s46, s45, 1024
    buffer_load_dwordx4 v[20:23], v5, s[28:31], s46 offen
    s_add_u32 s46, s45, 2048
    buffer_load_dwordx4 v[24:27], v5, s[28:31], s46 offen
    s_add_u32 s46, s45, 3072
    buffer_load_dwordx4 v[28:31], v5, s[28:31], s46 offen
    s_add_u32 s46, s45, 4096
    buffer_load_dwordx4 v[32:35], v5, s[28:31], s46 offen
    s_add_u32 s46, s45, 5120
    buffer_load_dwordx4 v[36:39], v5, s[28:31], s46 offen
    s_add_u32 s46, s45, 6144
    buffer_load_dwordx4 v[40:43], v5, s[28:31], s46 offen
    s_add_u32 s46, s45, 7168
    buffer_load_dwordx4 v[44:47], v5, s[28:31], s46 offen
    s_add_u32 s46, s45, 8192
    buffer_load_dwordx4 v[48:51], v5, s[28:31], s46 offen
    s_add_u32 s46, s45, 9216
    buffer_load_dwordx4 v[52:55], v5, s[28:31], s46 offen
    s_add_u32 s46, s45, 10240
    buffer_load_dwordx4 v[56:59], v5, s[28:31], s46 offen
    s_add_u32 s46, s45, 11264
    buffer_load_dwordx4 v[60:63], v5, s[28:31], s46 offen
    s_add_u32 s46, s45, 12288
    buffer_load_dwordx4 v[64:67], v5, s[28:31], s46 offen
    s_add_u32 s46, s45, 13312
    buffer_load_dwordx4 v[68:71], v5, s[28:31], s46 offen
    s_add_u32 s46, s45, 14336
    buffer_load_dwordx4 v[72:75], v5, s[28:31], s46 offen
    s_add_u32 s46, s45, 15360
    buffer_load_dwordx4 v[76:79], v5, s[28:31], s46 offen
    buffer_load_dwordx4 v[80:83], v5, s[28:31], s47 offen offset:0
    buffer_load_dwordx4 v[88:91], v5, s[28:31], s47 offen offset:1024
    buffer_load_dwordx2 v[96:97], v6, s[28:31], s19 offen offset:0
    buffer_load_dwordx2 v[98:99], v6, s[28:31], s19 offen offset:256
    buffer_load_dwordx2 v[100:101], v6, s[28:31], s19 offen offset:512
    buffer_load_dwordx2 v[102:103], v6, s[28:31], s19 offen offset:768
    buffer_load_dwordx2 v[104:105], v6, s[28:31], s19 offen offset:1024
    buffer_load_dwordx2 v[106:107], v6, s[28:31], s19 offen offset:1280
    buffer_load_dwordx2 v[108:109], v6, s[28:31], s19 offen offset:1536
    buffer_load_dwordx2 v[110:111], v6, s[28:31], s19 offen offset:1792
    buffer_load_dwordx2 v[112:113], v6, s[28:31], s19 offen offset:2048
    buffer_load_dwordx2 v[114:115], v6, s[28:31], s19 offen offset:2304
    buffer_load_dwordx2 v[116:117], v6, s[28:31], s19 offen offset:2560
    buffer_load_dwordx2 v[118:119], v6, s[28:31], s19 offen offset:2816
    s_waitcnt vmcnt(24)
    s_barrier
    ds_read_b128 v[120:123], v14 offset:0
    ds_read_b128 v[124:127], v14 offset:1024
    ds_read_b128 v[128:131], v14 offset:2048
    ds_read_b128 v[132:135], v14 offset:3072
    ds_read_b128 v[136:139], v14 offset:4096
    ds_read_b128 v[140:143], v14 offset:5120
    s_waitcnt lgkmcnt(5)
    v_mfma_f32_32x32x16_bf16 v[144:159], v[120:123], v[16:19], 0
    ds_read_b128 v[120:123], v14 offset:6144
    s_waitcnt lgkmcnt(5)
    v_mfma_f32_32x32x16_bf16 v[160:175], v[124:127], v[16:19], 0
    ds_read_b128 v[124:127], v14 offset:7168
    s_waitcnt lgkmcnt(5)
    v_mfma_f32_32x32x16_bf16 v[176:191], v[128:131], v[16:19], 0
    ds_read_b128 v[128:131], v14 offset:8192
    s_waitcnt lgkmcnt(5)
    v_mfma_f32_32x32x16_bf16 v[144:159], v[132:135], v[20:23], v[144:159]
    ds_read_b128 v[132:135], v14 offset:9216
    s_waitcnt lgkmcnt(5)
    v_mfma_f32_32x32x16_bf16 v[160:175], v[136:139], v[20:23], v[160:175]
    ds_read_b128 v[136:139], v14 offset:10240
    s_waitcnt lgkmcnt(5)
    v_mfma_f32_32x32x16_bf16 v[176:191], v[140:143], v[20:23], v[176:191]
    ds_read_b128 v[140:143], v14 offset:11264
    s_waitcnt lgkmcnt(5)
    v_mfma_f32_32x32x16_bf16 v[144:159], v[120:123], v[24:27], v[144:159]
    ds_read_b128 v[120:123], v14 offset:12288
    s_waitcnt lgkmcnt(5)
    v_mfma_f32_32x32x16_bf16 v[160:175], v[124:127], v[24:27], v[160:175]
    ds_read_b128 v[124:127], v14 offset:13312
    s_waitcnt lgkmcnt(5)
    v_mfma_f32_32x32x16_bf16 v[176:191], v[128:131], v[24:27], v[176:191]
    ds_read_b128 v[128:131], v14 offset:14336
    s_waitcnt lgkmcnt(5)
    v_mfma_f32_32x32x16_bf16 v[144:159], v[132:135], v[28:31], v[144:159]
    ds_read_b128 v[132:135], v14 offset:15360
    s_waitcnt lgkmcnt(5)
    v_mfma_f32_32x32x16_bf16 v[160:175], v[136:139], v[28:31], v[160:175]
    ds_read_b128 v[136:139], v14 offset:16384
    s_waitcnt lgkmcnt(5)
    v_mfma_f32_32x32x16_bf16 v[176:191], v[140:143], v[28:31], v[176:191]
    ds_read_b128 v[140:143], v14 offset:17408
    s_waitcnt lgkmcnt(5)
    v_mfma_f32_32x32x16_bf16 v[144:159], v[120:123], v[32:35], v[144:159]
    s_waitcnt lgkmcnt(4)
    v_mfma_f32_32x32x16_bf16 v[160:175], v[124:127], v[32:35], v[160:175]
    s_waitcnt lgkmcnt(3)
    v_mfma_f32_32x32x16_bf16 v[176:191], v[128:131], v[32:35], v[176:191]
    s_waitcnt lgkmcnt(2)
    v_mfma_f32_32x32x16_bf16 v[144:159], v[132:135], v[36:39], v[144:159]
    s_waitcnt lgkmcnt(1)
    v_mfma_f32_32x32x16_bf16 v[160:175], v[136:139], v[36:39], v[160:175]
    s_waitcnt lgkmcnt(0)
    v_mfma_f32_32x32x16_bf16 v[176:191], v[140:143], v[36:39], v[176:191]
    s_waitcnt vmcnt(18)
    s_barrier
    ds_read_b128 v[120:123], v14 offset:18432
    ds_read_b128 v[124:127], v14 offset:19456
    ds_read_b128 v[128:131], v14 offset:20480
    ds_read_b128 v[132:135], v14 offset:21504
    ds_read_b128 v[136:139], v14 offset:22528
    ds_read_b128 v[140:143], v14 offset:23552
    s_waitcnt lgkmcnt(5)
    v_mfma_f32_32x32x16_bf16 v[144:159], v[120:123], v[40:43], v[144:159]
    ds_read_b128 v[120:123], v14 offset:24576
    s_waitcnt lgkmcnt(5)
    v_mfma_f32_32x32x16_bf16 v[160:175], v[124:127], v[40:43], v[160:175]
    ds_read_b128 v[124:127], v14 offset:25600
    s_waitcnt lgkmcnt(5)
    v_mfma_f32_32x32x16_bf16 v[176:191], v[128:131], v[40:43], v[176:191]
    ds_read_b128 v[128:131], v14 offset:26624
    s_waitcnt lgkmcnt(5)
    v_mfma_f32_32x32x16_bf16 v[144:159], v[132:135], v[44:47], v[144:159]
    ds_read_b128 v[132:135], v14 offset:27648
    s_waitcnt lgkmcnt(5)
    v_mfma_f32_32x32x16_bf16 v[160:175], v[136:139], v[44:47], v[160:175]
    ds_read_b128 v[136:139], v14 offset:28672
    s_waitcnt lgkmcnt(5)
    v_mfma_f32_32x32x16_bf16 v[176:191], v[140:143], v[44:47], v[176:191]
    ds_read_b128 v[140:143], v14 offset:29696
    s_waitcnt lgkmcnt(5)
    v_mfma_f32_32x32x16_bf16 v[144:159], v[120:123], v[48:51], v[144:159]
    ds_read_b128 v[120:123], v14 offset:30720
    s_waitcnt lgkmcnt(5)
    v_mfma_f32_32x32x16_bf16 v[160:175], v[124:127], v[48:51], v[160:175]
    ds_read_b128 v[124:127], v14 offset:31744
    s_waitcnt lgkmcnt(5)
    v_mfma_f32_32x32x16_bf16 v[176:191], v[128:131], v[48:51], v[176:191]
    ds_read_b128 v[128:131], v14 offset:32768
    s_waitcnt lgkmcnt(5)
    v_mfma_f32_32x32x16_bf16 v[144:159], v[132:135], v[52:55], v[144:159]
    ds_read_b128 v[132:135], v14 offset:33792
    s_waitcnt lgkmcnt(5)
    v_mfma_f32_32x32x16_bf16 v[160:175], v[136:139], v[52:55], v[160:175]
    ds_read_b128 v[136:139], v14 offset:34816
    s_waitcnt lgkmcnt(5)
    v_mfma_f32_32x32x16_bf16 v[176:191], v[140:143], v[52:55], v[176:191]
    ds_read_b128 v[140:143], v14 offset:35840
    s_waitcnt lgkmcnt(5)
    v_mfma_f32_32x32x16_bf16 v[144:159], v[120:123], v[56:59], v[144:159]
    s_waitcnt lgkmcnt(4)
    v_mfma_f32_32x32x16_bf16 v[160:175], v[124:127], v[56:59], v[160:175]
    s_waitcnt lgkmcnt(3)
    v_mfma_f32_32x32x16_bf16 v[176:191], v[128:131], v[56:59], v[176:191]
    s_waitcnt lgkmcnt(2)
    v_mfma_f32_32x32x16_bf16 v[144:159], v[132:135], v[60:63], v[144:159]
    s_waitcnt lgkmcnt(1)
    v_mfma_f32_32x32x16_bf16 v[160:175], v[136:139], v[60:63], v[160:175]
    s_waitcnt lgkmcnt(0)
    v_mfma_f32_32x32x16_bf16 v[176:191], v[140:143], v[60:63], v[176:191]
    s_waitcnt vmcnt(12)
    s_barrier
    ds_read_b128 v[120:123], v14 offset:36864
    ds_read_b128 v[124:127], v14 offset:37888
    ds_read_b128 v[128:131], v14 offset:38912
    ds_read_b128 v[132:135], v14 offset:39936
    ds_read_b128 v[136:139], v14 offset:40960
    ds_read_b128 v[140:143], v14 offset:41984
    s_waitcnt lgkmcnt(5)
    v_mfma_f32_32x32x16_bf16 v[144:159], v[120:123], v[64:67], v[144:159]
    ds_read_b128 v[120:123], v14 offset:43008
    s_waitcnt lgkmcnt(5)
    v_mfma_f32_32x32x16_bf16 v[160:175], v[124:127], v[64:67], v[160:175]
    ds_read_b128 v[124:127], v14 offset:44032
    s_waitcnt lgkmcnt(5)
    v_mfma_f32_32x32x16_bf16 v[176:191], v[128:131], v[64:67], v[176:191]
    ds_read_b128 v[128:131], v14 offset:45056
    s_waitcnt lgkmcnt(5)
    v_mfma_f32_32x32x16_bf16 v[144:159], v[132:135], v[68:71], v[144:159]
    ds_read_b128 v[132:135], v14 offset:46080
    s_waitcnt lgkmcnt(5)
    v_mfma_f32_32x32x16_bf16 v[160:175], v[136:139], v[68:71], v[160:175]
    ds_read_b128 v[136:139], v14 offset:47104
    s_waitcnt lgkmcnt(5)
    v_mfma_f32_32x32x16_bf16 v[176:191], v[140:143], v[68:71], v[176:191]
    ds_read_b128 v[140:143], v14 offset:48128
    s_waitcnt lgkmcnt(5)
    v_mfma_f32_32x32x16_bf16 v[144:159], v[120:123], v[72:75], v[144:159]
    ds_read_b128 v[120:123], v14 offset:49152
    s_waitcnt lgkmcnt(5)
    v_mfma_f32_32x32x16_bf16 v[160:175], v[124:127], v[72:75], v[160:175]
    ds_read_b128 v[124:127], v14 offset:50176
    s_waitcnt lgkmcnt(5)
    v_mfma_f32_32x32x16_bf16 v[176:191], v[128:131], v[72:75], v[176:191]
    ds_read_b128 v[128:131], v14 offset:51200
    s_waitcnt lgkmcnt(5)
    v_mfma_f32_32x32x16_bf16 v[144:159], v[132:135], v[76:79], v[144:159]
    ds_read_b128 v[132:135], v14 offset:52224
    s_waitcnt lgkmcnt(5)
    v_mfma_f32_32x32x16_bf16 v[160:175], v[136:139], v[76:79], v[160:175]
    ds_read_b128 v[136:139], v14 offset:53248
    s_waitcnt lgkmcnt(5)
    v_mfma_f32_32x32x16_bf16 v[176:191], v[140:143], v[76:79], v[176:191]
    ds_read_b128 v[140:143], v14 offset:54272
    s_waitcnt lgkmcnt(5)
    v_mfma_f32_32x32x16_bf16 v[144:159], v[120:123], v[80:83], v[144:159]
    s_waitcnt lgkmcnt(4)
    v_mfma_f32_32x32x16_bf16 v[160:175], v[124:127], v[80:83], v[160:175]
    s_waitcnt lgkmcnt(3)
    v_mfma_f32_32x32x16_bf16 v[176:191], v[128:131], v[80:83], v[176:191]
    s_waitcnt lgkmcnt(2)
    v_mfma_f32_32x32x16_bf16 v[144:159], v[132:135], v[88:91], v[144:159]
    s_waitcnt lgkmcnt(1)
    v_mfma_f32_32x32x16_bf16 v[160:175], v[136:139], v[88:91], v[160:175]
    s_waitcnt lgkmcnt(0)
    v_mfma_f32_32x32x16_bf16 v[176:191], v[140:143], v[88:91], v[176:191]
    s_mul_i32 s44, s15, 12288
    s_add_u32 s44, s44, 110592
    v_add_u32 v10, s44, v5
    s_cmp_eq_u32 s16, 0
    s_cbranch_scc1 outb2_kernel_k0
    s_nop 11
    ds_write_b128 v10, v[144:147] offset:0
    ds_write_b128 v10, v[148:151] offset:1024
    ds_write_b128 v10, v[152:155] offset:2048
    ds_write_b128 v10, v[156:159] offset:3072
    ds_write_b128 v10, v[160:163] offset:4096
    ds_write_b128 v10, v[164:167] offset:5120
    ds_write_b128 v10, v[168:171] offset:6144
    ds_write_b128 v10, v[172:175] offset:7168
    ds_write_b128 v10, v[176:179] offset:8192
    ds_write_b128 v10, v[180:183] offset:9216
    ds_write_b128 v10, v[184:187] offset:10240
    ds_write_b128 v10, v[188:191] offset:11264
    s_waitcnt lgkmcnt(0)
    s_barrier
    s_endpgm
outb2_kernel_k0:
    s_lshl_b32 s44, s17, 5
    v_add_u32 v7, s44, v3
    v_mul_u32_u24 v7, 1152, v7
    v_lshl_add_u32 v7, v4, 3, v7
    s_mul_i32 s44, s13, 192
    s_waitcnt vmcnt(0)
    v_lshlrev_b32 v16, 16, v96
    v_and_b32 v17, 0xffff0000, v96
    v_lshlrev_b32 v18, 16, v97
    v_and_b32 v19, 0xffff0000, v97
    v_lshlrev_b32 v20, 16, v98
    v_and_b32 v21, 0xffff0000, v98
    v_lshlrev_b32 v22, 16, v99
    v_and_b32 v23, 0xffff0000, v99
    v_lshlrev_b32 v24, 16, v100
    v_and_b32 v25, 0xffff0000, v100
    v_lshlrev_b32 v26, 16, v101
    v_and_b32 v27, 0xffff0000, v101
    v_lshlrev_b32 v28, 16, v102
    v_and_b32 v29, 0xffff0000, v102
    v_lshlrev_b32 v30, 16, v103
    v_and_b32 v31, 0xffff0000, v103
    v_lshlrev_b32 v32, 16, v104
    v_and_b32 v33, 0xffff0000, v104
    v_lshlrev_b32 v34, 16, v105
    v_and_b32 v35, 0xffff0000, v105
    v_lshlrev_b32 v36, 16, v106
    v_and_b32 v37, 0xffff0000, v106
    v_lshlrev_b32 v38, 16, v107
    v_and_b32 v39, 0xffff0000, v107
    v_lshlrev_b32 v40, 16, v108
    v_and_b32 v41, 0xffff0000, v108
    v_lshlrev_b32 v42, 16, v109
    v_and_b32 v43, 0xffff0000, v109
    v_lshlrev_b32 v44, 16, v110
    v_and_b32 v45, 0xffff0000, v110
    v_lshlrev_b32 v46, 16, v111
    v_and_b32 v47, 0xffff0000, v111
    v_lshlrev_b32 v48, 16, v112
    v_and_b32 v49, 0xffff0000, v112
    v_lshlrev_b32 v50, 16, v113
    v_and_b32 v51, 0xffff0000, v113
    v_lshlrev_b32 v52, 16, v114
    v_and_b32 v53, 0xffff0000, v114
    v_lshlrev_b32 v54, 16, v115
    v_and_b32 v55, 0xffff0000, v115
    v_lshlrev_b32 v56, 16, v116
    v_and_b32 v57, 0xffff0000, v116
    v_lshlrev_b32 v58, 16, v117
    v_and_b32 v59, 0xffff0000, v117
    v_lshlrev_b32 v60, 16, v118
    v_and_b32 v61, 0xffff0000, v118
    v_lshlrev_b32 v62, 16, v119
    v_and_b32 v63, 0xffff0000, v119
    v_add_f32 v144, v144, v16
    v_add_f32 v145, v145, v17
    v_add_f32 v146, v146, v18
    v_add_f32 v147, v147, v19
    v_add_f32 v148, v148, v20
    v_add_f32 v149, v149, v21
    v_add_f32 v150, v150, v22
    v_add_f32 v151, v151, v23
    v_add_f32 v152, v152, v24
    v_add_f32 v153, v153, v25
    v_add_f32 v154, v154, v26
    v_add_f32 v155, v155, v27
    v_add_f32 v156, v156, v28
    v_add_f32 v157, v157, v29
    v_add_f32 v158, v158, v30
    v_add_f32 v159, v159, v31
    v_add_f32 v160, v160, v32
    v_add_f32 v161, v161, v33
    v_add_f32 v162, v162, v34
    v_add_f32 v163, v163, v35
    v_add_f32 v164, v164, v36
    v_add_f32 v165, v165, v37
    v_add_f32 v166, v166, v38
    v_add_f32 v167, v167, v39
    v_add_f32 v168, v168, v40
    v_add_f32 v169, v169, v41
    v_add_f32 v170, v170, v42
    v_add_f32 v171, v171, v43
    v_add_f32 v172, v172, v44
    v_add_f32 v173, v173, v45
    v_add_f32 v174, v174, v46
    v_add_f32 v175, v175, v47
    v_add_f32 v176, v176, v48
    v_add_f32 v177, v177, v49
    v_add_f32 v178, v178, v50
    v_add_f32 v179, v179, v51
    v_add_f32 v180, v180, v52
    v_add_f32 v181, v181, v53
    v_add_f32 v182, v182, v54
    v_add_f32 v183, v183, v55
    v_add_f32 v184, v184, v56
    v_add_f32 v185, v185, v57
    v_add_f32 v186, v186, v58
    v_add_f32 v187, v187, v59
    v_add_f32 v188, v188, v60
    v_add_f32 v189, v189, v61
    v_add_f32 v190, v190, v62
    v_add_f32 v191, v191, v63
    s_barrier
    ds_read_b128 v[192:195], v10 offset:0
    ds_read_b128 v[196:199], v10 offset:1024
    ds_read_b128 v[200:203], v10 offset:2048
    ds_read_b128 v[204:207], v10 offset:3072
    ds_read_b128 v[208:211], v10 offset:4096
    ds_read_b128 v[212:215], v10 offset:5120
    ds_read_b128 v[216:219], v10 offset:6144
    ds_read_b128 v[220:223], v10 offset:7168
    ds_read_b128 v[224:227], v10 offset:8192
    ds_read_b128 v[228:231], v10 offset:9216
    ds_read_b128 v[232:235], v10 offset:10240
    ds_read_b128 v[236:239], v10 offset:11264
    v_mov_b32 v8, 0
    v_mov_b32 v9, 0
    v_mov_b32 v11, 0x3f803f80
    s_waitcnt lgkmcnt(11)
    v_add_f32 v144, v144, v192
    v_add_f32 v145, v145, v193
    v_add_f32 v146, v146, v194
    v_add_f32 v147, v147, v195
    v_cvt_pk_bf16_f32 v96, v144, v145
    v_cvt_pk_bf16_f32 v97, v146, v147
    buffer_store_dwordx2 v[96:97], v7, s[32:35], s44 offen offset:0
    s_waitcnt lgkmcnt(10)
    v_add_f32 v148, v148, v196
    v_add_f32 v149, v149, v197
    v_add_f32 v150, v150, v198
    v_add_f32 v151, v151, v199
    v_cvt_pk_bf16_f32 v98, v148, v149
    v_cvt_pk_bf16_f32 v99, v150, v151
    buffer_store_dwordx2 v[98:99], v7, s[32:35], s44 offen offset:16
    s_waitcnt lgkmcnt(9)
    v_add_f32 v152, v152, v200
    v_add_f32 v153, v153, v201
    v_add_f32 v154, v154, v202
    v_add_f32 v155, v155, v203
    v_cvt_pk_bf16_f32 v100, v152, v153
    v_cvt_pk_bf16_f32 v101, v154, v155
    buffer_store_dwordx2 v[100:101], v7, s[32:35], s44 offen offset:32
    s_waitcnt lgkmcnt(8)
    v_add_f32 v156, v156, v204
    v_add_f32 v157, v157, v205
    v_add_f32 v158, v158, v206
    v_add_f32 v159, v159, v207
    v_cvt_pk_bf16_f32 v102, v156, v157
    v_cvt_pk_bf16_f32 v103, v158, v159
    buffer_store_dwordx2 v[102:103], v7, s[32:35], s44 offen offset:48
    s_waitcnt lgkmcnt(7)
    v_add_f32 v160, v160, v208
    v_add_f32 v161, v161, v209
    v_add_f32 v162, v162, v210
    v_add_f32 v163, v163, v211
    v_cvt_pk_bf16_f32 v104, v160, v161
    v_cvt_pk_bf16_f32 v105, v162, v163
    buffer_store_dwordx2 v[104:105], v7, s[32:35], s44 offen offset:64
    s_waitcnt lgkmcnt(6)
    v_add_f32 v164, v164, v212
    v_add_f32 v165, v165, v213
    v_add_f32 v166, v166, v214
    v_add_f32 v167, v167, v215
    v_cvt_pk_bf16_f32 v106, v164, v165
    v_cvt_pk_bf16_f32 v107, v166, v167
    buffer_store_dwordx2 v[106:107], v7, s[32:35], s44 offen offset:80
    s_waitcnt lgkmcnt(5)
    v_add_f32 v168, v168, v216
    v_add_f32 v169, v169, v217
    v_add_f32 v170, v170, v218
    v_add_f32 v171, v171, v219
    v_cvt_pk_bf16_f32 v108, v168, v169
    v_cvt_pk_bf16_f32 v109, v170, v171
    buffer_store_dwordx2 v[108:109], v7, s[32:35], s44 offen offset:96
    s_waitcnt lgkmcnt(4)
    v_add_f32 v172, v172, v220
    v_add_f32 v173, v173, v221
    v_add_f32 v174, v174, v222
    v_add_f32 v175, v175, v223
    v_cvt_pk_bf16_f32 v110, v172, v173
    v_cvt_pk_bf16_f32 v111, v174, v175
    buffer_store_dwordx2 v[110:111], v7, s[32:35], s44 offen offset:112
    s_waitcnt lgkmcnt(3)
    v_add_f32 v176, v176, v224
    v_add_f32 v177, v177, v225
    v_add_f32 v178, v178, v226
    v_add_f32 v179, v179, v227
    v_cvt_pk_bf16_f32 v112, v176, v177
    v_cvt_pk_bf16_f32 v113, v178, v179
    buffer_store_dwordx2 v[112:113], v7, s[32:35], s44 offen offset:128
    s_waitcnt lgkmcnt(2)
    v_add_f32 v180, v180, v228
    v_add_f32 v181, v181, v229
    v_add_f32 v182, v182, v230
    v_add_f32 v183, v183, v231
    v_cvt_pk_bf16_f32 v114, v180, v181
    v_cvt_pk_bf16_f32 v115, v182, v183
    buffer_store_dwordx2 v[114:115], v7, s[32:35], s44 offen offset:144
    s_waitcnt lgkmcnt(1)
    v_add_f32 v184, v184, v232
    v_add_f32 v185, v185, v233
    v_add_f32 v186, v186, v234
    v_add_f32 v187, v187, v235
    v_cvt_pk_bf16_f32 v116, v184, v185
    v_cvt_pk_bf16_f32 v117, v186, v187
    buffer_store_dwordx2 v[116:117], v7, s[32:35], s44 offen offset:160
    s_waitcnt lgkmcnt(0)
    v_add_f32 v188, v188, v236
    v_add_f32 v189, v189, v237
    v_add_f32 v190, v190, v238
    v_add_f32 v191, v191, v239
    v_cvt_pk_bf16_f32 v118, v188, v189
    v_cvt_pk_bf16_f32 v119, v190, v191
    buffer_store_dwordx2 v[118:119], v7, s[32:35], s44 offen offset:176
outb2_kernel_end:
    s_endpgm
.section .rodata,"a"
.p2align 6
.amdhsa_kernel prep_kernel
  .amdhsa_next_free_vgpr 160
  .amdhsa_next_free_sgpr 102
  .amdhsa_accum_offset 160
  .amdhsa_group_segment_fixed_size 0
  .amdhsa_kernarg_size 72
  .amdhsa_user_sgpr_count 2
  .amdhsa_user_sgpr_kernarg_segment_ptr 1
  .amdhsa_system_sgpr_workgroup_id_x 1
.end_amdhsa_kernel
.section .rodata,"a"
.p2align 6
.amdhsa_kernel qkva1_kernel
  .amdhsa_next_free_vgpr 252
  .amdhsa_next_free_sgpr 102
  .amdhsa_accum_offset 252
  .amdhsa_group_segment_fixed_size 0
  .amdhsa_kernarg_size 72
  .amdhsa_user_sgpr_count 2
  .amdhsa_user_sgpr_kernarg_segment_ptr 1
  .amdhsa_system_sgpr_workgroup_id_x 1
.end_amdhsa_kernel
.section .rodata,"a"
.p2align 6
.amdhsa_kernel outa1_kernel
  .amdhsa_next_free_vgpr 384
  .amdhsa_next_free_sgpr 102
  .amdhsa_accum_offset 256
  .amdhsa_group_segment_fixed_size 0
  .amdhsa_kernarg_size 72
  .amdhsa_user_sgpr_count 2
  .amdhsa_user_sgpr_kernarg_segment_ptr 1
  .amdhsa_system_sgpr_workgroup_id_x 1
.end_amdhsa_kernel
.section .rodata,"a"
.p2align 6
.amdhsa_kernel qkvb1_kernel
  .amdhsa_next_free_vgpr 252
  .amdhsa_next_free_sgpr 102
  .amdhsa_accum_offset 252
  .amdhsa_group_segment_fixed_size 0
  .amdhsa_kernarg_size 72
  .amdhsa_user_sgpr_count 2
  .amdhsa_user_sgpr_kernarg_segment_ptr 1
  .amdhsa_system_sgpr_workgroup_id_x 1
.end_amdhsa_kernel
.section .rodata,"a"
.p2align 6
.amdhsa_kernel attn_kernel
  .amdhsa_next_free_vgpr 128
  .amdhsa_next_free_sgpr 102
  .amdhsa_accum_offset 128
  .amdhsa_group_segment_fixed_size 0
  .amdhsa_kernarg_size 72
  .amdhsa_user_sgpr_count 2
  .amdhsa_user_sgpr_kernarg_segment_ptr 1
  .amdhsa_system_sgpr_workgroup_id_x 1
.end_amdhsa_kernel
.section .rodata,"a"
.p2align 6
.amdhsa_kernel outb1_kernel
  .amdhsa_next_free_vgpr 256
  .amdhsa_next_free_sgpr 102
  .amdhsa_accum_offset 256
  .amdhsa_group_segment_fixed_size 0
  .amdhsa_kernarg_size 72
  .amdhsa_user_sgpr_count 2
  .amdhsa_user_sgpr_kernarg_segment_ptr 1
  .amdhsa_system_sgpr_workgroup_id_x 1
.end_amdhsa_kernel
.section .rodata,"a"
.p2align 6
.amdhsa_kernel outb2_kernel
  .amdhsa_next_free_vgpr 256
  .amdhsa_next_free_sgpr 102
  .amdhsa_accum_offset 256
  .amdhsa_group_segment_fixed_size 0
  .amdhsa_kernarg_size 72
  .amdhsa_user_sgpr_count 2
  .amdhsa_user_sgpr_kernarg_segment_ptr 1
  .amdhsa_system_sgpr_workgroup_id_x 1
.end_amdhsa_kernel
```
